```python
import torch

def _softmax(x, axis=-1):
    return torch.softmax(x, dim=axis)
def _gelu(x):
    return torch.nn.functional.gelu(x, approximate="tanh")
def _silu(x):
    return torch.nn.functional.silu(x)
def _sigmoid(x):
    return torch.sigmoid(x)
def _layernorm(x, axis=-1, eps=1e-5):
    m = x.mean(dim=axis, keepdim=True)
    v = x.var(dim=axis, keepdim=True, unbiased=False)
    return (x - m) / torch.sqrt(v + eps)
def _scatter_add(tgt, idx, src, axis=0):
    return tgt.clone().index_add_(axis, idx, src)
def _segment_sum(src, seg, n):
    out = torch.zeros((n,) + src.shape[1:], dtype=src.dtype)
    return out.index_add_(0, seg, src)
def _pad(x, pw):
    flat = tuple(v for pair in reversed(pw) for v in pair)
    return torch.nn.functional.pad(x, flat)

kernel_name = 'recurrent_scan__sliding_block_cached__dense_activation_squared_relu__prompt'

def setup_inputs():

    _w = (lambda a: (lambda t: t.to(torch.bfloat16) if t.is_floating_point() else t)(torch.as_tensor(a)))
    def _A_setup():
        B, Sq, D = 1, 2048, 512
        Hq, Hkv, Sk, Dh = 32, 32, 2048, 128
        assert Hq % Hkv == 0, (Hq, Hkv)
        return {
            "x": _w((lambda *s: torch.randn(*s, dtype=torch.bfloat16) * 0.05)(B, Sq, D)),
            "k_cache": _w((lambda *s: torch.randn(*s, dtype=torch.bfloat16) * 0.8)(B, Hkv, Sk, Dh)),
            "v_cache": _w((lambda *s: torch.randn(*s, dtype=torch.bfloat16) * 0.2)(B, Hkv, Sk, Dh)),
            "wq": _w((lambda *s: torch.randn(*s, dtype=torch.bfloat16) * 0.8)(D, Hq * Dh) * (D ** -0.5)),
            "wo": _w((lambda *s: torch.randn(*s, dtype=torch.bfloat16) * 0.2)(Hq * Dh, D) * ((Hq * Dh) ** -0.5)),
        }
    _A_in = _A_setup()

    def _B_setup():
        B, S, D, F = 1, 2048, 512, 1376
        return {
            "x": _w((lambda *s: torch.randn(*s, dtype=torch.bfloat16) * 0.05)(B, S, D)),
            "w1": _w((lambda *s: torch.randn(*s, dtype=torch.bfloat16) * 0.1)(D, F)),
            "b1": _w((lambda *s: torch.randn(*s, dtype=torch.bfloat16) * 0.8)(F)),
            "w2": _w((lambda *s: torch.randn(*s, dtype=torch.bfloat16) * 0.1)(F, D)),
            "b2": _w((lambda *s: torch.randn(*s, dtype=torch.bfloat16) * 6.4)(D)),
        }
    _B_in = _B_setup()

    return {
        "A_x": _A_in["x"],
        "A_k_cache": _A_in["k_cache"],
        "A_v_cache": _A_in["v_cache"],
        "A_wq": _A_in["wq"],
        "A_wo": _A_in["wo"],
        "B_x": _B_in["x"],
        "B_w1": _B_in["w1"],
        "B_b1": _B_in["b1"],
        "B_w2": _B_in["w2"],
        "B_b2": _B_in["b2"],
    }

def reference(A_x, A_k_cache, A_v_cache, A_wq, A_wo, B_x, B_w1, B_b1, B_w2, B_b2):
    def _A_ref(x, k_cache, v_cache, wq, wo):
        B, Sq, D = x.shape
        Hq, Dh = 32, 128
        Hkv, Sk = k_cache.shape[1], k_cache.shape[2]
        W = min(4096, max(256, Sk // 4))
        rep = Hq // Hkv
        q = (lambda x, *d: x.permute(*d))((x @ wq).reshape(B, Sq, Hq, Dh), 0, 2, 1, 3)
        k = (lambda x, n, axis: torch.repeat_interleave(x, n, dim=axis))(k_cache[:, :, Sk - W:, :], rep, axis=1)
        v = (lambda x, n, axis: torch.repeat_interleave(x, n, dim=axis))(v_cache[:, :, Sk - W:, :], rep, axis=1)
        scores = torch.einsum("bhqd,bhkd->bhqk", q, k) * (Dh ** -0.5)
        p = _softmax(scores, axis=-1)
        o = torch.einsum("bhqk,bhkd->bhqd", p, v)
        return (lambda x, *d: x.permute(*d))(o, 0, 2, 1, 3).reshape(B, Sq, Hq * Dh) @ wo

    def _B_ref(x, w1, b1, w2, b2):
        h = torch.einsum("bsd,df->bsf", x, w1) + b1
        zero = torch.zeros_like(h)
        r = torch.where(h > zero, h, zero)
        h = r * r
        out = torch.einsum("bsf,fd->bsd", h, w2) + b2
        return out

    x = A_x
    xn = _layernorm(x, axis=-1)
    s = _A_ref(xn, A_k_cache, A_v_cache, A_wq, A_wo)
    g = _silu(_B_ref(xn, B_w1, B_b1, B_w2, B_b2))
    return x + s * g
```

```asm
; @launch grid=(256,1,1) block=(256,1,1) lds=163840
.amdgcn_target "amdgcn-amd-amdhsa--gfx950"
.text
.globl recurrent_scan__sliding_block_cached__dense_activation_squared_relu__prompt_kernel
.p2align 8
.type recurrent_scan__sliding_block_cached__dense_activation_squared_relu__prompt_kernel,@function
recurrent_scan__sliding_block_cached__dense_activation_squared_relu__prompt_kernel:
    s_cmp_ge_u32 s2, 256
    s_cbranch_scc1 k_end
    s_load_dwordx16 s[64:79], s[0:1], 0
    s_load_dwordx8 s[80:87], s[0:1], 64
    s_load_dwordx2 s[88:89], s[0:1], 96
    s_getpc_b64 s[60:61]
code_base:
    v_min_u32 v62, 31, v0
    v_lshlrev_b32 v62, 7, v62
    global_load_dword a255, v62, s[60:61]
    s_lshr_b32 s52, s2, 3
    s_and_b32 s52, s52, 3
    s_mul_i32 s52, s52, 16384
    s_add_u32 s52, s52, 4096
    v_min_u32 v62, 127, v0
    v_lshlrev_b32 v62, 7, v62
    v_add_u32 v62, s52, v62
    v_min_u32 v62, code_end-code_base-4, v62
    v_mov_b32 v63, s61
    v_add_co_u32 v62, vcc, s60, v62
    s_nop 1
    v_addc_co_u32 v63, vcc, 0, v63, vcc
    v_lshrrev_b32 v1, 6, v0
    s_and_b32 s52, s2, 7
    v_readfirstlane_b32 s3, v1
    s_lshr_b32 s53, s2, 3
    s_and_b32 s54, s52, 3
    s_lshl_b32 s54, s54, 3
    s_and_b32 s55, s53, 7
    s_add_u32 s4, s54, s55
    s_lshr_b32 s54, s52, 2
    s_lshl_b32 s54, s54, 2
    s_lshr_b32 s55, s53, 3
    s_add_u32 s5, s54, s55
    s_lshl_b32 s54, s5, 3
    s_lshl_b32 s55, s3, 1
    s_add_u32 s54, s54, s55
    s_and_b32 s55, s4, 1
    s_add_u32 s6, s54, s55
    s_xor_b32 s55, s55, 1
    s_add_u32 s7, s54, s55
    s_lshl_b32 s57, s3, 12
    s_lshl_b32 s58, s3, 11
    s_lshl_b32 s52, s5, 5
    s_add_u32 s52, s52, s4
    v_and_b32 v1, 63, v0
    v_and_b32 v3, 7, v1
    v_lshrrev_b32 v4, 3, v1
    s_lshl_b32 s53, s3, 4
    v_add_u32 v5, s53, v4
    s_lshl_b32 s54, s52, 13
    v_lshlrev_b32 v7, 10, v3
    v_lshl_add_u32 v6, v5, 4, v7
    s_lshl_b32 s55, s5, 7
    s_add_u32 s55, s55, 33619968
    v_mov_b32 v48, 0
    s_waitcnt lgkmcnt(0)
    s_mov_b32 s36, s64
    s_mov_b32 s37, s65
    s_mov_b32 s38, 2097152
    s_mov_b32 s39, 0x20000
    buffer_load_dwordx4 v[8:11], v6, s[36:39], s54 offen
    buffer_load_dwordx4 v[12:15], v6, s[36:39], s54 offen offset:128
    buffer_load_ushort v47, v7, s[36:39], s54 offen
    s_mov_b32 s8, s88
    s_mov_b32 s9, s89
    s_mov_b32 s10, 268435456
    s_mov_b32 s11, 0x20000
    buffer_load_dword v49, v48, s[8:11], s55 offen sc1
    s_lshl_b32 s59, s4, 8
    s_add_u32 s12, s70, s59
    s_addc_u32 s13, s71, 0
    s_sub_u32 s14, 4194304, s59
    s_mov_b32 s15, 0x20000
    s_mov_b32 s16, s76
    s_mov_b32 s17, s77
    s_mov_b32 s18, 1409024
    s_mov_b32 s19, 0x20000
    v_lshlrev_b32 v242, 4, v1
    s_mov_b32 s44, s78
    s_mov_b32 s45, s79
    s_mov_b32 s46, 2752
    s_mov_b32 s47, 0x20000
    v_lshrrev_b32 v249, 5, v1
    v_lshlrev_b32 v249, 4, v249
    s_and_b32 s56, s5, 3
    s_lshl_b32 s56, s56, 2
    s_add_u32 s56, s56, s3
    s_mul_i32 s56, s56, 12
    s_add_u32 s56, s56, 0
    v_lshrrev_b32 v53, 4, v242
    v_min_u32 v53, 11, v53
    v_add_u32 v53, s56, v53
    v_and_b32 v55, 1, v53
    v_lshrrev_b32 v53, 1, v53
    s_lshl_b32 s56, s4, 6
    s_lshr_b32 s62, s4, 1
    s_lshl_b32 s62, s62, 6
    s_add_u32 s62, s62, 2048
    s_sub_u32 s62, s62, s56
    v_mul_u32_u24 v54, 2752, v53
    v_lshlrev_b32 v53, 13, v53
    v_lshl_add_u32 v53, v55, 7, v53
    v_mul_u32_u24 v55, s62, v55
    v_add3_u32 v54, v54, v55, s56
    buffer_load_dword a252, v53, s[12:15], 0 offen
    buffer_load_dword a253, v54, s[16:19], 0 offen
    s_and_b32 s56, s5, 3
    s_lshl_b32 s56, s56, 2
    s_add_u32 s56, s56, s3
    s_mul_i32 s56, s56, 14
    s_add_u32 s56, s56, 192
    v_lshrrev_b32 v64, 4, v242
    v_min_u32 v64, 13, v64
    v_add_u32 v64, s56, v64
    v_and_b32 v55, 1, v64
    v_lshrrev_b32 v64, 1, v64
    s_lshl_b32 s56, s4, 6
    s_lshr_b32 s62, s4, 1
    s_lshl_b32 s62, s62, 6
    s_add_u32 s62, s62, 2048
    s_sub_u32 s62, s62, s56
    v_mul_u32_u24 v65, 2752, v64
    v_lshlrev_b32 v64, 13, v64
    v_lshl_add_u32 v64, v55, 7, v64
    v_mul_u32_u24 v55, s62, v55
    v_add3_u32 v65, v65, v55, s56
    s_and_b32 s56, s5, 3
    s_lshl_b32 s56, s56, 2
    s_add_u32 s56, s56, s3
    s_mul_i32 s56, s56, 14
    s_add_u32 s56, s56, 416
    v_lshrrev_b32 v247, 4, v242
    v_min_u32 v247, 13, v247
    v_add_u32 v247, s56, v247
    v_and_b32 v55, 1, v247
    v_lshrrev_b32 v247, 1, v247
    s_lshl_b32 s56, s4, 6
    s_lshr_b32 s62, s4, 1
    s_lshl_b32 s62, s62, 6
    s_add_u32 s62, s62, 2048
    s_sub_u32 s62, s62, s56
    v_mul_u32_u24 v248, 2752, v247
    v_lshlrev_b32 v247, 13, v247
    v_lshl_add_u32 v247, v55, 7, v247
    v_mul_u32_u24 v55, s62, v55
    v_add3_u32 v248, v248, v55, s56
    s_lshl_b32 s59, s4, 19
    s_add_u32 s59, s59, 393216
    s_add_u32 s20, s66, s59
    s_addc_u32 s21, s67, 0
    s_mov_b32 s22, 131072
    s_mov_b32 s23, 0x20000
    s_add_u32 s24, s68, s59
    s_addc_u32 s25, s69, 0
    s_mov_b32 s26, 131072
    s_mov_b32 s27, 0x20000
    s_mov_b32 s40, s84
    s_mov_b32 s41, s85
    s_mov_b32 s42, 2097152
    s_mov_b32 s43, 0x20000
    s_lshr_b32 s59, s4, 3
    s_lshl_b32 s59, s59, 20
    s_and_b32 s63, s4, 3
    s_lshl_b32 s63, s63, 8
    s_add_u32 s59, s59, s63
    s_add_u32 s28, s72, s59
    s_addc_u32 s29, s73, 0
    s_sub_u32 s30, 4194304, s59
    s_mov_b32 s31, 0x20000
    s_lshr_b32 s59, s4, 3
    s_lshl_b32 s59, s59, 6
    s_add_u32 s59, s59, s63
    s_add_u32 s32, s80, s59
    s_addc_u32 s33, s81, 0
    s_sub_u32 s34, 1409024, s59
    s_mov_b32 s35, 0x20000
    s_add_u32 s48, s82, s59
    s_addc_u32 s49, s83, 0
    s_sub_u32 s50, 1024, s59
    s_mov_b32 s51, 0x20000
    s_lshr_b32 s75, s4, 3
    s_and_b32 s59, s4, 7
    s_lshr_b32 s63, s59, 2
    s_lshl_b32 s76, s5, 1
    s_add_u32 s76, s76, s63
    s_and_b32 s77, s59, 3
    s_lshl_b32 s78, s76, 2
    s_add_u32 s78, s78, s3
    s_lshl_b32 s79, s78, 15
    s_lshl_b32 s63, s77, 8
    s_add_u32 s79, s79, s63
    s_lshl_b32 s63, s75, 6
    s_add_u32 s79, s79, s63
    s_lshl_b32 s68, s5, 12
    s_add_u32 s66, s68, 33554432
    s_add_u32 s68, s66, 32768
    s_lshl_b32 s63, s4, 7
    s_add_u32 s67, s68, s63
    s_lshl_b32 s66, s5, 14
    s_add_u32 s66, s66, 33947648
    s_lshl_b32 s63, s4, 9
    s_add_u32 s65, s66, s63
    s_lshl_b32 s63, s3, 7
    s_add_u32 s65, s65, s63
    s_lshl_b32 s63, s3, 12
    s_add_u32 s66, s66, s63
    s_lshl_b32 s69, s5, 2
    s_add_u32 s69, s69, s3
    s_lshl_b32 s69, s69, 5
    s_add_u32 s69, s69, s4
    s_lshl_b32 s69, s69, 7
    s_add_u32 s69, s69, 33685504
    s_add_u32 s71, s69, 131072
    s_lshr_b32 s70, s78, 1
    s_lshl_b32 s70, s70, 12
    s_lshl_b32 s63, s75, 10
    s_add_u32 s70, s70, s63
    s_add_u32 s70, s70, 33685504
    s_lshl_b32 s63, s75, 10
    s_sub_u32 s72, s71, s63
    s_lshl_b32 s81, s3, 10
    s_cmp_eq_u32 s3, 0
    s_cselect_b32 s67, s67, 536870912
    s_mov_b64 s[60:61], 0
    s_mov_b32 s62, 0x41800000
    s_mov_b32 s73, s55
    s_lshr_b32 s53, s52, 2
    s_lshl_b32 s53, s53, 15
    s_and_b32 s54, s52, 3
    s_lshl_b32 s54, s54, 7
    s_add_u32 s53, s53, s54
    v_lshlrev_b32 v51, 5, v3
    v_add_u32 v51, 147456, v51
    s_lshl_b32 s54, s3, 3
    v_add_u32 v52, s54, v51
    v_lshlrev_b32 v46, 4, v3
    v_lshl_add_u32 v46, v5, 9, v46
    v_add_u32 v50, 0x1000, v46
    v_min_u32 v59, 1, v242
    v_lshlrev_b32 v59, 31, v59
    buffer_load_dword a244, v59, s[8:11], s65 offen sc1
    buffer_load_dword a245, v59, s[8:11], s67 offen sc1
    buffer_load_dword a246, v59, s[8:11], s69 offen sc1
    buffer_load_dword a247, v59, s[8:11], s71 offen sc1
    s_add_u32 s59, s69, 524288
    buffer_load_dword a243, v59, s[8:11], s59 offen sc1
    s_waitcnt vmcnt(8)
    buffer_load_dword a238, v64, s[12:15], 0 offen
    buffer_load_dword a239, v65, s[16:19], 0 offen
    global_load_dword a254, v[62:63], off
    v_lshlrev_b32 v47, 16, v47
    v_lshlrev_b32 v16, 16, v8
    v_and_b32 v17, 0xffff0000, v8
    v_lshlrev_b32 v18, 16, v9
    v_and_b32 v19, 0xffff0000, v9
    v_lshlrev_b32 v20, 16, v10
    v_and_b32 v21, 0xffff0000, v10
    v_lshlrev_b32 v22, 16, v11
    v_and_b32 v23, 0xffff0000, v11
    v_lshlrev_b32 v24, 16, v12
    v_and_b32 v25, 0xffff0000, v12
    v_lshlrev_b32 v26, 16, v13
    v_and_b32 v27, 0xffff0000, v13
    v_lshlrev_b32 v28, 16, v14
    v_and_b32 v29, 0xffff0000, v14
    v_lshlrev_b32 v30, 16, v15
    v_and_b32 v31, 0xffff0000, v15
    v_sub_f32 v16, v16, v47
    v_sub_f32 v17, v17, v47
    v_sub_f32 v18, v18, v47
    v_sub_f32 v19, v19, v47
    v_sub_f32 v20, v20, v47
    v_sub_f32 v21, v21, v47
    v_sub_f32 v22, v22, v47
    v_sub_f32 v23, v23, v47
    v_sub_f32 v24, v24, v47
    v_sub_f32 v25, v25, v47
    v_sub_f32 v26, v26, v47
    v_sub_f32 v27, v27, v47
    v_sub_f32 v28, v28, v47
    v_sub_f32 v29, v29, v47
    v_sub_f32 v30, v30, v47
    v_sub_f32 v31, v31, v47
    v_add_f32 v36, v16, v17
    v_mul_f32 v40, v16, v16
    v_add_f32 v36, v36, v18
    v_fmac_f32 v40, v17, v17
    v_add_f32 v36, v36, v19
    v_fmac_f32 v40, v18, v18
    v_fmac_f32 v40, v19, v19
    v_add_f32 v37, v20, v21
    v_mul_f32 v41, v20, v20
    v_add_f32 v37, v37, v22
    v_fmac_f32 v41, v21, v21
    v_add_f32 v37, v37, v23
    v_fmac_f32 v41, v22, v22
    v_fmac_f32 v41, v23, v23
    v_add_f32 v38, v24, v25
    v_mul_f32 v42, v24, v24
    v_add_f32 v38, v38, v26
    v_fmac_f32 v42, v25, v25
    v_add_f32 v38, v38, v27
    v_fmac_f32 v42, v26, v26
    v_fmac_f32 v42, v27, v27
    v_add_f32 v39, v28, v29
    v_mul_f32 v43, v28, v28
    v_add_f32 v39, v39, v30
    v_fmac_f32 v43, v29, v29
    v_add_f32 v39, v39, v31
    v_fmac_f32 v43, v30, v30
    v_fmac_f32 v43, v31, v31
    v_add_f32 v36, v36, v37
    v_add_f32 v40, v40, v41
    v_add_f32 v38, v38, v39
    v_add_f32 v42, v42, v43
    v_add_f32 v36, v36, v38
    v_add_f32 v40, v40, v42
    s_nop 0
    v_add_f32_dpp v32, v36, v36 row_ror:8 row_mask:0xf bank_mask:0xf
    v_add_f32_dpp v33, v40, v40 row_ror:8 row_mask:0xf bank_mask:0xf
    v_mov_b32 v34, v32
    v_mov_b32 v35, v33
    s_nop 0
    v_permlane16_swap_b32 v32, v34
    v_permlane16_swap_b32 v33, v35
    v_add_f32 v32, v32, v34
    v_add_f32 v33, v33, v35
    v_mov_b32 v34, v32
    v_mov_b32 v35, v33
    s_nop 0
    v_permlane32_swap_b32 v32, v34
    v_permlane32_swap_b32 v33, v35
    v_add_f32 v32, v32, v34
    v_add_f32 v33, v33, v35
    ds_write_b64 v52, v[32:33]
    s_waitcnt vmcnt(10)
    v_readfirstlane_b32 s74, v49
    s_waitcnt lgkmcnt(0)
    s_barrier
    ds_read_b128 v[36:39], v51
    ds_read_b128 v[40:43], v51 offset:16
    s_mul_i32 s64, s74, 0x9E3779B1
    s_add_u32 s64, s64, 0x7F4A7C15
    s_add_u32 s74, s74, 1
    s_or_b32 s59, s4, s3
    s_cmp_eq_u32 s59, 0
    s_cselect_b32 s73, s73, 536870912
    v_mov_b32 v44, s64
    s_waitcnt lgkmcnt(0)
    v_add_f32 v36, v36, v38
    v_add_f32 v37, v37, v39
    v_add_f32 v40, v40, v42
    v_add_f32 v41, v41, v43
    v_add_f32 v36, v36, v40
    v_add_f32 v37, v37, v41
    v_mul_f32 v36, 0x3b000000, v36
    v_mov_b32 v38, 0x3727c5ac
    v_fmac_f32 v38, 0x3b000000, v37
    v_fma_f32 v39, -v36, v36, v38
    v_max_f32 v39, 0x3727c5ac, v39
    v_rsq_f32 v39, v39
    s_nop 0
    v_mul_f32 v39, 0x3e0293ee, v39
    v_mul_f32_e64 v36, -v36, v39
    v_fma_f32 v16, v16, v39, v36
    v_fma_f32 v17, v17, v39, v36
    v_fma_f32 v18, v18, v39, v36
    v_fma_f32 v19, v19, v39, v36
    v_fma_f32 v20, v20, v39, v36
    v_fma_f32 v21, v21, v39, v36
    v_fma_f32 v22, v22, v39, v36
    v_fma_f32 v23, v23, v39, v36
    v_fma_f32 v24, v24, v39, v36
    v_fma_f32 v25, v25, v39, v36
    v_fma_f32 v26, v26, v39, v36
    v_fma_f32 v27, v27, v39, v36
    v_fma_f32 v28, v28, v39, v36
    v_fma_f32 v29, v29, v39, v36
    v_fma_f32 v30, v30, v39, v36
    v_fma_f32 v31, v31, v39, v36
    v_cvt_pk_bf16_f32 v8, v16, v17
    v_cvt_pk_bf16_f32 v9, v18, v19
    v_cvt_pk_bf16_f32 v10, v20, v21
    v_cvt_pk_bf16_f32 v11, v22, v23
    v_cvt_pk_bf16_f32 v12, v24, v25
    v_cvt_pk_bf16_f32 v13, v26, v27
    v_cvt_pk_bf16_f32 v14, v28, v29
    v_cvt_pk_bf16_f32 v15, v30, v31
    buffer_store_dwordx4 v[8:11], v46, s[8:11], s53 offen sc1
    buffer_store_dwordx4 v[12:15], v50, s[8:11], s53 offen sc1
    s_mov_b32 s1, 0
    v_lshrrev_b32 v128, 4, v242
    v_lshrrev_b32 v129, 4, v128
    v_bfe_u32 v130, v128, 2, 2
    v_and_b32 v131, 3, v128
    v_and_b32 v134, 1, v129
    v_lshl_add_u32 v133, v129, 3, v130
    v_lshlrev_b32 v132, 1, v130
    v_xor_b32 v132, v132, v131
    v_lshlrev_b32 v135, 3, v134
    v_xor_b32 v132, v132, v135
    v_lshlrev_b32 v132, 4, v132
    v_lshl_add_u32 v224, v133, 8, v132
    v_xor_b32 v225, 64, v224
    v_xor_b32 v226, 128, v224
    v_xor_b32 v227, 192, v224
    v_lshrrev_b32 v132, 1, v131
    v_lshlrev_b32 v133, 1, v134
    v_xor_b32 v132, v132, v133
    v_lshlrev_b32 v132, 4, v132
    v_and_b32 v133, 1, v131
    v_lshl_add_u32 v132, v133, 3, v132
    v_lshl_add_u32 v133, v134, 3, v130
    v_lshl_add_u32 v132, v133, 6, v132
    v_lshrrev_b32 v133, 1, v129
    v_lshl_add_u32 v132, v133, 11, v132
    v_add_u32 v228, 65536, v132
    v_xor_b32 v229, 32, v228
    v_and_b32 v132, 0xf0, v242
    v_lshl_add_u32 v132, v134, 9, v132
    v_lshl_add_u32 v230, v133, 10, v132
    v_add_u32 v231, 256, v230
    v_and_b32 v136, 15, v128
    v_lshlrev_b32 v132, 1, v129
    v_xor_b32 v132, v132, v136
    v_lshlrev_b32 v132, 4, v132
    v_lshl_add_u32 v240, v129, 8, v132
    v_add_u32 v240, s57, v240
    v_xor_b32 v241, 128, v240
    v_lshl_add_u32 v250, v129, 13, v132
    s_lshl_b32 s59, s3, 17
    v_add_u32 v250, s59, v250
    v_add_u32 v251, 31744, v250
    v_xor_b32 v133, 128, v250
    v_add_u32 v252, 63488, v133
    v_add_u32 v253, 95232, v133
    v_xor_b32 v132, v129, v136
    v_lshlrev_b32 v132, 4, v132
    v_lshl_add_u32 v236, v129, 8, v132
    v_add_u32 v236, s57, v236
    v_xor_b32 v237, 64, v236
    v_xor_b32 v238, 128, v236
    v_xor_b32 v239, 192, v236
    v_lshl_add_u32 v232, v136, 8, v132
    v_add_u32 v232, 98304, v232
    v_xor_b32 v233, 64, v232
    v_xor_b32 v234, 128, v232
    v_xor_b32 v235, 192, v232
    v_lshrrev_b32 v132, 2, v128
    s_lshl_b32 s59, s3, 4
    v_add_u32 v132, s59, v132
    v_mul_u32_u24 v132, 2752, v132
    v_and_b32 v133, 2, v129
    v_xor_b32 v133, v133, v131
    v_lshl_add_u32 v132, v133, 4, v132
    s_lshl_b32 s59, s4, 6
    v_add_u32 v254, s59, v132
    s_lshr_b32 s59, s4, 1
    s_lshl_b32 s59, s59, 6
    s_add_u32 s59, s59, 1024
    s_cmp_ge_u32 s4, 22
    s_cselect_b32 s63, 0x40000000, 0
    s_add_u32 s59, s59, s63
    v_add_u32 v255, s59, v132
    v_lshlrev_b32 v249, 3, v129
    s_waitcnt vmcnt(0)
    buffer_store_dword v44, v59, s[8:11], s65 offen sc1
    buffer_load_dword a236, v247, s[12:15], 0 offen
    buffer_load_dword a237, v248, s[16:19], 0 offen
    s_lshl_b32 s59, s4, 6
    buffer_load_dwordx2 v[160:161], v249, s[44:47], s59 offen
    buffer_load_dwordx2 v[162:163], v249, s[44:47], s59 offen offset:32
    s_lshr_b32 s59, s4, 1
    s_lshl_b32 s59, s59, 6
    s_add_u32 s59, s59, 2048
    buffer_load_dwordx2 v[164:165], v249, s[44:47], s59 offen
    buffer_load_dwordx2 v[166:167], v249, s[44:47], s59 offen offset:32
    s_branch first_pass
pass_entry:
    v_lshrrev_b32 v128, 4, v242
    v_lshrrev_b32 v129, 4, v128
    v_bfe_u32 v130, v128, 2, 2
    v_and_b32 v131, 3, v128
    v_and_b32 v134, 1, v129
    v_lshl_add_u32 v133, v129, 3, v130
    v_lshlrev_b32 v132, 1, v130
    v_xor_b32 v132, v132, v131
    v_lshlrev_b32 v135, 3, v134
    v_xor_b32 v132, v132, v135
    v_lshlrev_b32 v132, 4, v132
    v_lshl_add_u32 v224, v133, 8, v132
    v_xor_b32 v225, 64, v224
    v_xor_b32 v226, 128, v224
    v_xor_b32 v227, 192, v224
    v_lshrrev_b32 v132, 1, v131
    v_lshlrev_b32 v133, 1, v134
    v_xor_b32 v132, v132, v133
    v_lshlrev_b32 v132, 4, v132
    v_and_b32 v133, 1, v131
    v_lshl_add_u32 v132, v133, 3, v132
    v_lshl_add_u32 v133, v134, 3, v130
    v_lshl_add_u32 v132, v133, 6, v132
    v_lshrrev_b32 v133, 1, v129
    v_lshl_add_u32 v132, v133, 11, v132
    v_add_u32 v228, 65536, v132
    v_xor_b32 v229, 32, v228
    v_and_b32 v132, 0xf0, v242
    v_lshl_add_u32 v132, v134, 9, v132
    v_lshl_add_u32 v230, v133, 10, v132
    v_add_u32 v231, 256, v230
    v_and_b32 v136, 15, v128
    v_lshlrev_b32 v132, 1, v129
    v_xor_b32 v132, v132, v136
    v_lshlrev_b32 v132, 4, v132
    v_lshl_add_u32 v240, v129, 8, v132
    v_add_u32 v240, s57, v240
    v_xor_b32 v241, 128, v240
    v_lshl_add_u32 v250, v129, 13, v132
    s_lshl_b32 s59, s3, 17
    v_add_u32 v250, s59, v250
    v_add_u32 v251, 31744, v250
    v_xor_b32 v133, 128, v250
    v_add_u32 v252, 63488, v133
    v_add_u32 v253, 95232, v133
    v_xor_b32 v132, v129, v136
    v_lshlrev_b32 v132, 4, v132
    v_lshl_add_u32 v236, v129, 8, v132
    v_add_u32 v236, s57, v236
    v_xor_b32 v237, 64, v236
    v_xor_b32 v238, 128, v236
    v_xor_b32 v239, 192, v236
    v_lshl_add_u32 v232, v136, 8, v132
    v_add_u32 v232, 98304, v232
    v_xor_b32 v233, 64, v232
    v_xor_b32 v234, 128, v232
    v_xor_b32 v235, 192, v232
    v_lshrrev_b32 v132, 2, v128
    s_lshl_b32 s59, s3, 4
    v_add_u32 v132, s59, v132
    v_mul_u32_u24 v132, 2752, v132
    v_and_b32 v133, 2, v129
    v_xor_b32 v133, v133, v131
    v_lshl_add_u32 v132, v133, 4, v132
    s_lshl_b32 s59, s4, 6
    v_add_u32 v254, s59, v132
    s_lshr_b32 s59, s4, 1
    s_lshl_b32 s59, s59, 6
    s_add_u32 s59, s59, 1024
    s_cmp_ge_u32 s4, 22
    s_cselect_b32 s63, 0x40000000, 0
    s_add_u32 s59, s59, s63
    v_add_u32 v255, s59, v132
    v_lshlrev_b32 v249, 3, v129
    s_lshl_b32 s59, s4, 6
    buffer_load_dwordx2 v[160:161], v249, s[44:47], s59 offen
    buffer_load_dwordx2 v[162:163], v249, s[44:47], s59 offen offset:32
    s_lshr_b32 s59, s4, 1
    s_lshl_b32 s59, s59, 6
    s_add_u32 s59, s59, 2048
    buffer_load_dwordx2 v[164:165], v249, s[44:47], s59 offen
    buffer_load_dwordx2 v[166:167], v249, s[44:47], s59 offen offset:32
    s_waitcnt vmcnt(0)
first_pass:
    s_add_u32 m0, s57, 0
    s_mov_b32 s54, 0
    buffer_load_dwordx4 v250, s[12:15], s54 offen offset:0 lds
    buffer_load_dwordx4 v251, s[12:15], s54 offen offset:1024 lds
    buffer_load_dwordx4 v252, s[12:15], s54 offen offset:2048 lds
    buffer_load_dwordx4 v253, s[12:15], s54 offen offset:3072 lds
    s_add_u32 m0, s58, 65536
    s_mov_b32 s55, 0
    buffer_load_dwordx4 v254, s[16:19], s55 offen lds
    buffer_load_dwordx4 v255, s[16:19], s55 offen offset:1024 lds
    s_add_u32 m0, s57, 16384
    s_mov_b32 s54, 524288
    buffer_load_dwordx4 v250, s[12:15], s54 offen offset:0 lds
    buffer_load_dwordx4 v251, s[12:15], s54 offen offset:1024 lds
    buffer_load_dwordx4 v252, s[12:15], s54 offen offset:2048 lds
    buffer_load_dwordx4 v253, s[12:15], s54 offen offset:3072 lds
    s_add_u32 m0, s58, 73728
    s_mov_b32 s55, 176128
    buffer_load_dwordx4 v254, s[16:19], s55 offen lds
    buffer_load_dwordx4 v255, s[16:19], s55 offen offset:1024 lds
    v_and_b32 v60, 496, v242
    v_lshlrev_b32 v60, 3, v60
    s_lshl_b32 s52, s6, 15
    s_lshl_b32 s53, s7, 15
    buffer_load_dword v61, v60, s[8:11], s66 offen sc1
    s_add_u32 m0, s57, 32768
    s_mov_b32 s54, 1048576
    buffer_load_dwordx4 v250, s[12:15], s54 offen offset:0 lds
    buffer_load_dwordx4 v251, s[12:15], s54 offen offset:1024 lds
    buffer_load_dwordx4 v252, s[12:15], s54 offen offset:2048 lds
    buffer_load_dwordx4 v253, s[12:15], s54 offen offset:3072 lds
    s_add_u32 m0, s58, 81920
    s_mov_b32 s55, 352256
    buffer_load_dwordx4 v254, s[16:19], s55 offen lds
    buffer_load_dwordx4 v255, s[16:19], s55 offen offset:1024 lds
    s_waitcnt vmcnt(19)
    s_mov_b32 s59, 0x3e0293ee
    v_lshlrev_b32 v128, 16, v160
    v_and_b32 v129, 0xffff0000, v160
    v_lshlrev_b32 v130, 16, v161
    v_and_b32 v131, 0xffff0000, v161
    v_lshlrev_b32 v132, 16, v162
    v_and_b32 v133, 0xffff0000, v162
    v_lshlrev_b32 v134, 16, v163
    v_and_b32 v135, 0xffff0000, v163
    v_mul_f32 v128, s59, v128
    v_mul_f32 v129, s59, v129
    v_mul_f32 v130, s59, v130
    v_mul_f32 v131, s59, v131
    v_mul_f32 v132, s59, v132
    v_mul_f32 v133, s59, v133
    v_mul_f32 v134, s59, v134
    v_mul_f32 v135, s59, v135
    v_mov_b32 v136, v128
    v_mov_b32 v137, v129
    v_mov_b32 v138, v130
    v_mov_b32 v139, v131
    v_mov_b32 v140, v132
    v_mov_b32 v141, v133
    v_mov_b32 v142, v134
    v_mov_b32 v143, v135
    v_mov_b32 v144, v128
    v_mov_b32 v145, v129
    v_mov_b32 v146, v130
    v_mov_b32 v147, v131
    v_mov_b32 v148, v132
    v_mov_b32 v149, v133
    v_mov_b32 v150, v134
    v_mov_b32 v151, v135
    v_mov_b32 v152, v128
    v_mov_b32 v153, v129
    v_mov_b32 v154, v130
    v_mov_b32 v155, v131
    v_mov_b32 v156, v132
    v_mov_b32 v157, v133
    v_mov_b32 v158, v134
    v_mov_b32 v159, v135
    v_lshlrev_b32 v208, 16, v164
    v_and_b32 v209, 0xffff0000, v164
    v_lshlrev_b32 v210, 16, v165
    v_and_b32 v211, 0xffff0000, v165
    v_lshlrev_b32 v212, 16, v166
    v_and_b32 v213, 0xffff0000, v166
    v_lshlrev_b32 v214, 16, v167
    v_and_b32 v215, 0xffff0000, v167
    v_mul_f32 v208, s59, v208
    v_mul_f32 v209, s59, v209
    v_mul_f32 v210, s59, v210
    v_mul_f32 v211, s59, v211
    v_mul_f32 v212, s59, v212
    v_mul_f32 v213, s59, v213
    v_mul_f32 v214, s59, v214
    v_mul_f32 v215, s59, v215
    v_mov_b32 v216, v208
    v_mov_b32 v217, v209
    v_mov_b32 v218, v210
    v_mov_b32 v219, v211
    v_mov_b32 v220, v212
    v_mov_b32 v221, v213
    v_mov_b32 v222, v214
    v_mov_b32 v223, v215
    s_waitcnt vmcnt(6)
    v_cmp_ne_u32 vcc, s64, v61
    s_cbranch_vccnz h1_spin
h1_ok:
    buffer_load_dwordx4 a[0:3], v230, s[8:11], s52 offen offset:0 sc1
    buffer_load_dwordx4 a[4:7], v231, s[8:11], s52 offen offset:0 sc1
    buffer_load_dwordx4 a[8:11], v230, s[8:11], s53 offen offset:0 sc1
    buffer_load_dwordx4 a[12:15], v231, s[8:11], s53 offen offset:0 sc1
    buffer_load_dwordx4 a[16:19], v230, s[8:11], s52 offen offset:2048 sc1
    buffer_load_dwordx4 a[20:23], v231, s[8:11], s52 offen offset:2048 sc1
    buffer_load_dwordx4 a[24:27], v230, s[8:11], s53 offen offset:2048 sc1
    buffer_load_dwordx4 a[28:31], v231, s[8:11], s53 offen offset:2048 sc1
    s_barrier
    ds_read_b64_tr_b16 v[160:161], v224 offset:0
    ds_read_b64_tr_b16 v[162:163], v224 offset:1024
    ds_read_b64_tr_b16 v[164:165], v224 offset:8
    ds_read_b64_tr_b16 v[166:167], v224 offset:1032
    ds_read_b64_tr_b16 v[168:169], v225 offset:0
    ds_read_b64_tr_b16 v[170:171], v225 offset:1024
    ds_read_b64_tr_b16 v[172:173], v225 offset:8
    ds_read_b64_tr_b16 v[174:175], v225 offset:1032
    ds_read_b64_tr_b16 v[176:177], v226 offset:0
    ds_read_b64_tr_b16 v[178:179], v226 offset:1024
    ds_read_b64_tr_b16 v[180:181], v226 offset:8
    ds_read_b64_tr_b16 v[182:183], v226 offset:1032
    ds_read_b64_tr_b16 v[184:185], v227 offset:0
    ds_read_b64_tr_b16 v[186:187], v227 offset:1024
    ds_read_b64_tr_b16 v[188:189], v227 offset:8
    ds_read_b64_tr_b16 v[190:191], v227 offset:1032
    ds_read_b64_tr_b16 v[192:193], v228 offset:0
    ds_read_b64_tr_b16 v[194:195], v228 offset:256
    ds_read_b64_tr_b16 v[196:197], v229 offset:0
    ds_read_b64_tr_b16 v[198:199], v229 offset:256
    ds_read_b64_tr_b16 v[200:201], v228 offset:1024
    ds_read_b64_tr_b16 v[202:203], v228 offset:1280
    ds_read_b64_tr_b16 v[204:205], v229 offset:1024
    ds_read_b64_tr_b16 v[206:207], v229 offset:1280
    s_waitcnt vmcnt(4) lgkmcnt(15)
    v_mfma_f32_16x16x32_bf16 v[0:3], v[160:163], a[0:3], 0
    s_add_u32 s52, s52, 4096
    buffer_load_dwordx4 a[32:35], v230, s[8:11], s52 offen offset:0 sc1
    v_mfma_f32_16x16x32_bf16 v[32:35], v[160:163], a[4:7], 0
    v_mfma_f32_16x16x32_bf16 v[64:67], v[160:163], a[8:11], 0
    s_and_b32 s82, s5, 3
    v_mfma_f32_16x16x32_bf16 v[96:99], v[160:163], a[12:15], 0
    s_lshl_b32 s82, s82, 2
    v_mfma_f32_16x16x32_bf16 v[4:7], v[164:167], a[0:3], 0
    s_add_u32 s82, s82, s3
    ds_read_b64_tr_b16 v[160:161], v224 offset:8192
    v_mfma_f32_16x16x32_bf16 v[36:39], v[164:167], a[4:7], 0
    s_mul_i32 s82, s82, 24
    ds_read_b64_tr_b16 v[162:163], v224 offset:9216
    v_mfma_f32_16x16x32_bf16 v[68:71], v[164:167], a[8:11], 0
    s_add_u32 s82, s82, 640
    buffer_load_dwordx4 a[36:39], v231, s[8:11], s52 offen offset:0 sc1
    v_mfma_f32_16x16x32_bf16 v[100:103], v[164:167], a[12:15], 0
    v_lshrrev_b32 v247, 4, v242
    v_mfma_f32_16x16x32_bf16 v[8:11], v[168:171], a[0:3], 0
    ds_read_b64_tr_b16 v[164:165], v224 offset:8200
    v_min_u32 v247, 23, v247
    v_mfma_f32_16x16x32_bf16 v[40:43], v[168:171], a[4:7], 0
    ds_read_b64_tr_b16 v[166:167], v224 offset:9224
    v_add_u32 v247, s82, v247
    v_mfma_f32_16x16x32_bf16 v[72:75], v[168:171], a[8:11], 0
    s_add_u32 s53, s53, 4096
    buffer_load_dwordx4 a[40:43], v230, s[8:11], s53 offen offset:0 sc1
    v_and_b32 v249, 1, v247
    v_mfma_f32_16x16x32_bf16 v[104:107], v[168:171], a[12:15], 0
    v_lshrrev_b32 v247, 1, v247
    v_mfma_f32_16x16x32_bf16 v[12:15], v[172:175], a[0:3], 0
    s_lshl_b32 s82, s4, 6
    ds_read_b64_tr_b16 v[168:169], v225 offset:8192
    v_mfma_f32_16x16x32_bf16 v[44:47], v[172:175], a[4:7], 0
    s_lshr_b32 s59, s4, 1
    ds_read_b64_tr_b16 v[170:171], v225 offset:9216
    v_mfma_f32_16x16x32_bf16 v[76:79], v[172:175], a[8:11], 0
    s_lshl_b32 s59, s59, 6
    buffer_load_dwordx4 a[44:47], v231, s[8:11], s53 offen offset:0 sc1
    v_mfma_f32_16x16x32_bf16 v[108:111], v[172:175], a[12:15], 0
    s_waitcnt lgkmcnt(14)
    s_add_u32 s59, s59, 2048
    v_mfma_f32_16x16x32_bf16 v[16:19], v[176:179], a[0:3], 0
    s_sub_u32 s59, s59, s82
    ds_read_b64_tr_b16 v[172:173], v225 offset:8200
    v_mfma_f32_16x16x32_bf16 v[48:51], v[176:179], a[4:7], 0
    ds_read_b64_tr_b16 v[174:175], v225 offset:9224
    v_mul_u32_u24 v248, 2752, v247
    v_mfma_f32_16x16x32_bf16 v[80:83], v[176:179], a[8:11], 0
    buffer_load_dwordx4 a[48:51], v230, s[8:11], s52 offen offset:2048 sc1
    v_lshlrev_b32 v247, 13, v247
    v_mfma_f32_16x16x32_bf16 v[112:115], v[176:179], a[12:15], 0
    v_lshl_add_u32 v247, v249, 7, v247
    v_mfma_f32_16x16x32_bf16 v[20:23], v[180:183], a[0:3], 0
    ds_read_b64_tr_b16 v[176:177], v226 offset:8192
    v_mul_u32_u24 v249, s59, v249
    v_mfma_f32_16x16x32_bf16 v[52:55], v[180:183], a[4:7], 0
    ds_read_b64_tr_b16 v[178:179], v226 offset:9216
    v_add3_u32 v248, v248, v249, s82
    v_mfma_f32_16x16x32_bf16 v[84:87], v[180:183], a[8:11], 0
    buffer_load_dwordx4 a[52:55], v231, s[8:11], s52 offen offset:2048 sc1
    v_mfma_f32_16x16x32_bf16 v[116:119], v[180:183], a[12:15], 0
    v_mfma_f32_16x16x32_bf16 v[24:27], v[184:187], a[0:3], 0
    ds_read_b64_tr_b16 v[180:181], v226 offset:8200
    v_mfma_f32_16x16x32_bf16 v[56:59], v[184:187], a[4:7], 0
    ds_read_b64_tr_b16 v[182:183], v226 offset:9224
    v_mfma_f32_16x16x32_bf16 v[88:91], v[184:187], a[8:11], 0
    buffer_load_dwordx4 a[56:59], v230, s[8:11], s53 offen offset:2048 sc1
    v_mfma_f32_16x16x32_bf16 v[120:123], v[184:187], a[12:15], 0
    v_mfma_f32_16x16x32_bf16 v[28:31], v[188:191], a[0:3], 0
    ds_read_b64_tr_b16 v[184:185], v227 offset:8192
    v_mfma_f32_16x16x32_bf16 v[60:63], v[188:191], a[4:7], 0
    ds_read_b64_tr_b16 v[186:187], v227 offset:9216
    v_mfma_f32_16x16x32_bf16 v[92:95], v[188:191], a[8:11], 0
    buffer_load_dwordx4 a[60:63], v231, s[8:11], s53 offen offset:2048 sc1
    v_mfma_f32_16x16x32_bf16 v[124:127], v[188:191], a[12:15], 0
    s_waitcnt lgkmcnt(14)
    v_mfma_f32_16x16x32_bf16 v[128:131], v[192:195], a[0:3], v[128:131]
    ds_read_b64_tr_b16 v[188:189], v227 offset:8200
    v_mfma_f32_16x16x32_bf16 v[136:139], v[192:195], a[4:7], v[136:139]
    ds_read_b64_tr_b16 v[190:191], v227 offset:9224
    v_mfma_f32_16x16x32_bf16 v[144:147], v[192:195], a[8:11], v[144:147]
    s_add_u32 s52, s52, 4096
    buffer_load_dwordx4 a[64:67], v230, s[8:11], s52 offen offset:0 sc1
    v_mfma_f32_16x16x32_bf16 v[152:155], v[192:195], a[12:15], v[152:155]
    v_mfma_f32_16x16x32_bf16 v[132:135], v[196:199], a[0:3], v[132:135]
    ds_read_b64_tr_b16 v[192:193], v228 offset:4096
    v_mfma_f32_16x16x32_bf16 v[140:143], v[196:199], a[4:7], v[140:143]
    ds_read_b64_tr_b16 v[194:195], v228 offset:4352
    v_mfma_f32_16x16x32_bf16 v[148:151], v[196:199], a[8:11], v[148:151]
    buffer_load_dwordx4 a[68:71], v231, s[8:11], s52 offen offset:0 sc1
    v_mfma_f32_16x16x32_bf16 v[156:159], v[196:199], a[12:15], v[156:159]
    v_mfma_f32_16x16x32_bf16 v[208:211], v[200:203], a[0:3], v[208:211]
    ds_read_b64_tr_b16 v[196:197], v229 offset:4096
    v_mfma_f32_16x16x32_bf16 v[216:219], v[200:203], a[4:7], v[216:219]
    ds_read_b64_tr_b16 v[198:199], v229 offset:4352
    v_mfma_f32_16x16x32_bf16 v[212:215], v[204:207], a[0:3], v[212:215]
    ds_read_b64_tr_b16 v[200:201], v228 offset:5120
    v_mfma_f32_16x16x32_bf16 v[220:223], v[204:207], a[4:7], v[220:223]
    s_waitcnt vmcnt(10) lgkmcnt(13)
    s_barrier
    ds_read_b64_tr_b16 v[202:203], v228 offset:5376
    v_mfma_f32_16x16x32_bf16 v[0:3], v[160:163], a[16:19], v[0:3]
    ds_read_b64_tr_b16 v[204:205], v229 offset:5120
    v_mfma_f32_16x16x32_bf16 v[32:35], v[160:163], a[20:23], v[32:35]
    ds_read_b64_tr_b16 v[206:207], v229 offset:5376
    v_mfma_f32_16x16x32_bf16 v[64:67], v[160:163], a[24:27], v[64:67]
    s_add_u32 s53, s53, 4096
    buffer_load_dwordx4 a[72:75], v230, s[8:11], s53 offen offset:0 sc1
    v_mfma_f32_16x16x32_bf16 v[96:99], v[160:163], a[28:31], v[96:99]
    buffer_load_dwordx4 a[76:79], v231, s[8:11], s53 offen offset:0 sc1
    v_mfma_f32_16x16x32_bf16 v[4:7], v[164:167], a[16:19], v[4:7]
    ds_read_b64_tr_b16 v[160:161], v224 offset:16384
    v_mfma_f32_16x16x32_bf16 v[36:39], v[164:167], a[20:23], v[36:39]
    ds_read_b64_tr_b16 v[162:163], v224 offset:17408
    v_mfma_f32_16x16x32_bf16 v[68:71], v[164:167], a[24:27], v[68:71]
    v_mfma_f32_16x16x32_bf16 v[100:103], v[164:167], a[28:31], v[100:103]
    s_add_u32 m0, s57, 49152
    s_mov_b32 s54, 1572864
    buffer_load_dwordx4 v250, s[12:15], s54 offen offset:0 lds
    v_mfma_f32_16x16x32_bf16 v[8:11], v[168:171], a[16:19], v[8:11]
    ds_read_b64_tr_b16 v[164:165], v224 offset:16392
    v_mfma_f32_16x16x32_bf16 v[40:43], v[168:171], a[20:23], v[40:43]
    ds_read_b64_tr_b16 v[166:167], v224 offset:17416
    v_mfma_f32_16x16x32_bf16 v[72:75], v[168:171], a[24:27], v[72:75]
    v_mfma_f32_16x16x32_bf16 v[104:107], v[168:171], a[28:31], v[104:107]
    v_mfma_f32_16x16x32_bf16 v[12:15], v[172:175], a[16:19], v[12:15]
    ds_read_b64_tr_b16 v[168:169], v225 offset:16384
    v_mfma_f32_16x16x32_bf16 v[44:47], v[172:175], a[20:23], v[44:47]
    ds_read_b64_tr_b16 v[170:171], v225 offset:17408
    v_mfma_f32_16x16x32_bf16 v[76:79], v[172:175], a[24:27], v[76:79]
    buffer_load_dwordx4 v251, s[12:15], s54 offen offset:1024 lds
    v_mfma_f32_16x16x32_bf16 v[108:111], v[172:175], a[28:31], v[108:111]
    s_waitcnt lgkmcnt(14)
    v_mfma_f32_16x16x32_bf16 v[16:19], v[176:179], a[16:19], v[16:19]
    ds_read_b64_tr_b16 v[172:173], v225 offset:16392
    v_mfma_f32_16x16x32_bf16 v[48:51], v[176:179], a[20:23], v[48:51]
    ds_read_b64_tr_b16 v[174:175], v225 offset:17416
    v_mfma_f32_16x16x32_bf16 v[80:83], v[176:179], a[24:27], v[80:83]
    buffer_load_dwordx4 v252, s[12:15], s54 offen offset:2048 lds
    v_mfma_f32_16x16x32_bf16 v[112:115], v[176:179], a[28:31], v[112:115]
    v_mfma_f32_16x16x32_bf16 v[20:23], v[180:183], a[16:19], v[20:23]
    ds_read_b64_tr_b16 v[176:177], v226 offset:16384
    v_mfma_f32_16x16x32_bf16 v[52:55], v[180:183], a[20:23], v[52:55]
    ds_read_b64_tr_b16 v[178:179], v226 offset:17408
    v_mfma_f32_16x16x32_bf16 v[84:87], v[180:183], a[24:27], v[84:87]
    buffer_load_dwordx4 v253, s[12:15], s54 offen offset:3072 lds
    v_mfma_f32_16x16x32_bf16 v[116:119], v[180:183], a[28:31], v[116:119]
    v_mfma_f32_16x16x32_bf16 v[24:27], v[184:187], a[16:19], v[24:27]
    ds_read_b64_tr_b16 v[180:181], v226 offset:16392
    v_mfma_f32_16x16x32_bf16 v[56:59], v[184:187], a[20:23], v[56:59]
    ds_read_b64_tr_b16 v[182:183], v226 offset:17416
    v_mfma_f32_16x16x32_bf16 v[88:91], v[184:187], a[24:27], v[88:91]
    v_mfma_f32_16x16x32_bf16 v[120:123], v[184:187], a[28:31], v[120:123]
    s_add_u32 m0, s58, 90112
    s_mov_b32 s55, 528384
    buffer_load_dwordx4 v254, s[16:19], s55 offen lds
    v_mfma_f32_16x16x32_bf16 v[28:31], v[188:191], a[16:19], v[28:31]
    ds_read_b64_tr_b16 v[184:185], v227 offset:16384
    v_mfma_f32_16x16x32_bf16 v[60:63], v[188:191], a[20:23], v[60:63]
    ds_read_b64_tr_b16 v[186:187], v227 offset:17408
    v_mfma_f32_16x16x32_bf16 v[92:95], v[188:191], a[24:27], v[92:95]
    v_mfma_f32_16x16x32_bf16 v[124:127], v[188:191], a[28:31], v[124:127]
    s_waitcnt lgkmcnt(14)
    v_mfma_f32_16x16x32_bf16 v[128:131], v[192:195], a[16:19], v[128:131]
    ds_read_b64_tr_b16 v[188:189], v227 offset:16392
    v_mfma_f32_16x16x32_bf16 v[136:139], v[192:195], a[20:23], v[136:139]
    ds_read_b64_tr_b16 v[190:191], v227 offset:17416
    v_mfma_f32_16x16x32_bf16 v[144:147], v[192:195], a[24:27], v[144:147]
    buffer_load_dwordx4 v255, s[16:19], s55 offen offset:1024 lds
    v_mfma_f32_16x16x32_bf16 v[152:155], v[192:195], a[28:31], v[152:155]
    v_mfma_f32_16x16x32_bf16 v[132:135], v[196:199], a[16:19], v[132:135]
    ds_read_b64_tr_b16 v[192:193], v228 offset:8192
    v_mfma_f32_16x16x32_bf16 v[140:143], v[196:199], a[20:23], v[140:143]
    ds_read_b64_tr_b16 v[194:195], v228 offset:8448
    v_mfma_f32_16x16x32_bf16 v[148:151], v[196:199], a[24:27], v[148:151]
    buffer_load_dwordx4 a[80:83], v230, s[8:11], s52 offen offset:2048 sc1
    v_mfma_f32_16x16x32_bf16 v[156:159], v[196:199], a[28:31], v[156:159]
    v_mfma_f32_16x16x32_bf16 v[208:211], v[200:203], a[16:19], v[208:211]
    ds_read_b64_tr_b16 v[196:197], v229 offset:8192
    v_mfma_f32_16x16x32_bf16 v[216:219], v[200:203], a[20:23], v[216:219]
    ds_read_b64_tr_b16 v[198:199], v229 offset:8448
    v_mfma_f32_16x16x32_bf16 v[212:215], v[204:207], a[16:19], v[212:215]
    ds_read_b64_tr_b16 v[200:201], v228 offset:9216
    v_mfma_f32_16x16x32_bf16 v[220:223], v[204:207], a[20:23], v[220:223]
    s_waitcnt vmcnt(15) lgkmcnt(13)
    ds_read_b64_tr_b16 v[202:203], v228 offset:9472
    v_mfma_f32_16x16x32_bf16 v[0:3], v[160:163], a[32:35], v[0:3]
    ds_read_b64_tr_b16 v[204:205], v229 offset:9216
    v_mfma_f32_16x16x32_bf16 v[32:35], v[160:163], a[36:39], v[32:35]
    ds_read_b64_tr_b16 v[206:207], v229 offset:9472
    v_mfma_f32_16x16x32_bf16 v[64:67], v[160:163], a[40:43], v[64:67]
    buffer_load_dwordx4 a[84:87], v231, s[8:11], s52 offen offset:2048 sc1
    v_mfma_f32_16x16x32_bf16 v[96:99], v[160:163], a[44:47], v[96:99]
    buffer_load_dwordx4 a[88:91], v230, s[8:11], s53 offen offset:2048 sc1
    v_mfma_f32_16x16x32_bf16 v[4:7], v[164:167], a[32:35], v[4:7]
    ds_read_b64_tr_b16 v[160:161], v224 offset:24576
    v_mfma_f32_16x16x32_bf16 v[36:39], v[164:167], a[36:39], v[36:39]
    ds_read_b64_tr_b16 v[162:163], v224 offset:25600
    v_mfma_f32_16x16x32_bf16 v[68:71], v[164:167], a[40:43], v[68:71]
    v_mfma_f32_16x16x32_bf16 v[100:103], v[164:167], a[44:47], v[100:103]
    v_mfma_f32_16x16x32_bf16 v[8:11], v[168:171], a[32:35], v[8:11]
    ds_read_b64_tr_b16 v[164:165], v224 offset:24584
    v_mfma_f32_16x16x32_bf16 v[40:43], v[168:171], a[36:39], v[40:43]
    ds_read_b64_tr_b16 v[166:167], v224 offset:25608
    v_mfma_f32_16x16x32_bf16 v[72:75], v[168:171], a[40:43], v[72:75]
    buffer_load_dwordx4 a[92:95], v231, s[8:11], s53 offen offset:2048 sc1
    v_mfma_f32_16x16x32_bf16 v[104:107], v[168:171], a[44:47], v[104:107]
    v_mfma_f32_16x16x32_bf16 v[12:15], v[172:175], a[32:35], v[12:15]
    ds_read_b64_tr_b16 v[168:169], v225 offset:24576
    v_mfma_f32_16x16x32_bf16 v[44:47], v[172:175], a[36:39], v[44:47]
    ds_read_b64_tr_b16 v[170:171], v225 offset:25600
    v_mfma_f32_16x16x32_bf16 v[76:79], v[172:175], a[40:43], v[76:79]
    s_add_u32 s52, s52, 4096
    buffer_load_dwordx4 a[96:99], v230, s[8:11], s52 offen offset:0 sc1
    v_mfma_f32_16x16x32_bf16 v[108:111], v[172:175], a[44:47], v[108:111]
    s_waitcnt lgkmcnt(14)
    v_mfma_f32_16x16x32_bf16 v[16:19], v[176:179], a[32:35], v[16:19]
    ds_read_b64_tr_b16 v[172:173], v225 offset:24584
    v_mfma_f32_16x16x32_bf16 v[48:51], v[176:179], a[36:39], v[48:51]
    ds_read_b64_tr_b16 v[174:175], v225 offset:25608
    v_mfma_f32_16x16x32_bf16 v[80:83], v[176:179], a[40:43], v[80:83]
    buffer_load_dwordx4 a[100:103], v231, s[8:11], s52 offen offset:0 sc1
    v_mfma_f32_16x16x32_bf16 v[112:115], v[176:179], a[44:47], v[112:115]
    v_mfma_f32_16x16x32_bf16 v[20:23], v[180:183], a[32:35], v[20:23]
    ds_read_b64_tr_b16 v[176:177], v226 offset:24576
    v_mfma_f32_16x16x32_bf16 v[52:55], v[180:183], a[36:39], v[52:55]
    ds_read_b64_tr_b16 v[178:179], v226 offset:25600
    v_mfma_f32_16x16x32_bf16 v[84:87], v[180:183], a[40:43], v[84:87]
    v_mfma_f32_16x16x32_bf16 v[116:119], v[180:183], a[44:47], v[116:119]
    s_add_u32 s53, s53, 4096
    buffer_load_dwordx4 a[104:107], v230, s[8:11], s53 offen offset:0 sc1
    v_mfma_f32_16x16x32_bf16 v[24:27], v[184:187], a[32:35], v[24:27]
    ds_read_b64_tr_b16 v[180:181], v226 offset:24584
    v_mfma_f32_16x16x32_bf16 v[56:59], v[184:187], a[36:39], v[56:59]
    ds_read_b64_tr_b16 v[182:183], v226 offset:25608
    v_mfma_f32_16x16x32_bf16 v[88:91], v[184:187], a[40:43], v[88:91]
    v_mfma_f32_16x16x32_bf16 v[120:123], v[184:187], a[44:47], v[120:123]
    v_mfma_f32_16x16x32_bf16 v[28:31], v[188:191], a[32:35], v[28:31]
    ds_read_b64_tr_b16 v[184:185], v227 offset:24576
    v_mfma_f32_16x16x32_bf16 v[60:63], v[188:191], a[36:39], v[60:63]
    ds_read_b64_tr_b16 v[186:187], v227 offset:25600
    v_mfma_f32_16x16x32_bf16 v[92:95], v[188:191], a[40:43], v[92:95]
    buffer_load_dwordx4 a[108:111], v231, s[8:11], s53 offen offset:0 sc1
    v_mfma_f32_16x16x32_bf16 v[124:127], v[188:191], a[44:47], v[124:127]
    s_waitcnt lgkmcnt(14)
    v_mfma_f32_16x16x32_bf16 v[128:131], v[192:195], a[32:35], v[128:131]
    ds_read_b64_tr_b16 v[188:189], v227 offset:24584
    v_mfma_f32_16x16x32_bf16 v[136:139], v[192:195], a[36:39], v[136:139]
    ds_read_b64_tr_b16 v[190:191], v227 offset:25608
    v_mfma_f32_16x16x32_bf16 v[144:147], v[192:195], a[40:43], v[144:147]
    v_mfma_f32_16x16x32_bf16 v[152:155], v[192:195], a[44:47], v[152:155]
    v_mfma_f32_16x16x32_bf16 v[132:135], v[196:199], a[32:35], v[132:135]
    ds_read_b64_tr_b16 v[192:193], v228 offset:12288
    v_mfma_f32_16x16x32_bf16 v[140:143], v[196:199], a[36:39], v[140:143]
    ds_read_b64_tr_b16 v[194:195], v228 offset:12544
    v_mfma_f32_16x16x32_bf16 v[148:151], v[196:199], a[40:43], v[148:151]
    v_mfma_f32_16x16x32_bf16 v[156:159], v[196:199], a[44:47], v[156:159]
    v_mfma_f32_16x16x32_bf16 v[208:211], v[200:203], a[32:35], v[208:211]
    ds_read_b64_tr_b16 v[196:197], v229 offset:12288
    v_mfma_f32_16x16x32_bf16 v[216:219], v[200:203], a[36:39], v[216:219]
    ds_read_b64_tr_b16 v[198:199], v229 offset:12544
    v_mfma_f32_16x16x32_bf16 v[212:215], v[204:207], a[32:35], v[212:215]
    ds_read_b64_tr_b16 v[200:201], v228 offset:13312
    v_mfma_f32_16x16x32_bf16 v[220:223], v[204:207], a[36:39], v[220:223]
    s_waitcnt vmcnt(18) lgkmcnt(13)
    s_barrier
    ds_read_b64_tr_b16 v[202:203], v228 offset:13568
    v_mfma_f32_16x16x32_bf16 v[0:3], v[160:163], a[48:51], v[0:3]
    ds_read_b64_tr_b16 v[204:205], v229 offset:13312
    v_mfma_f32_16x16x32_bf16 v[32:35], v[160:163], a[52:55], v[32:35]
    ds_read_b64_tr_b16 v[206:207], v229 offset:13568
    v_mfma_f32_16x16x32_bf16 v[64:67], v[160:163], a[56:59], v[64:67]
    s_add_u32 m0, s57, 0
    s_mov_b32 s54, 2097152
    buffer_load_dwordx4 v250, s[12:15], s54 offen offset:0 lds
    v_mfma_f32_16x16x32_bf16 v[96:99], v[160:163], a[60:63], v[96:99]
    v_mfma_f32_16x16x32_bf16 v[4:7], v[164:167], a[48:51], v[4:7]
    ds_read_b64_tr_b16 v[160:161], v224 offset:32768
    v_mfma_f32_16x16x32_bf16 v[36:39], v[164:167], a[52:55], v[36:39]
    ds_read_b64_tr_b16 v[162:163], v224 offset:33792
    v_mfma_f32_16x16x32_bf16 v[68:71], v[164:167], a[56:59], v[68:71]
    buffer_load_dwordx4 v251, s[12:15], s54 offen offset:1024 lds
    v_mfma_f32_16x16x32_bf16 v[100:103], v[164:167], a[60:63], v[100:103]
    v_mfma_f32_16x16x32_bf16 v[8:11], v[168:171], a[48:51], v[8:11]
    ds_read_b64_tr_b16 v[164:165], v224 offset:32776
    v_mfma_f32_16x16x32_bf16 v[40:43], v[168:171], a[52:55], v[40:43]
    ds_read_b64_tr_b16 v[166:167], v224 offset:33800
    v_mfma_f32_16x16x32_bf16 v[72:75], v[168:171], a[56:59], v[72:75]
    buffer_load_dwordx4 v252, s[12:15], s54 offen offset:2048 lds
    v_mfma_f32_16x16x32_bf16 v[104:107], v[168:171], a[60:63], v[104:107]
    v_mfma_f32_16x16x32_bf16 v[12:15], v[172:175], a[48:51], v[12:15]
    ds_read_b64_tr_b16 v[168:169], v225 offset:32768
    v_mfma_f32_16x16x32_bf16 v[44:47], v[172:175], a[52:55], v[44:47]
    ds_read_b64_tr_b16 v[170:171], v225 offset:33792
    v_mfma_f32_16x16x32_bf16 v[76:79], v[172:175], a[56:59], v[76:79]
    v_mfma_f32_16x16x32_bf16 v[108:111], v[172:175], a[60:63], v[108:111]
    s_waitcnt lgkmcnt(14)
    buffer_load_dwordx4 v253, s[12:15], s54 offen offset:3072 lds
    v_mfma_f32_16x16x32_bf16 v[16:19], v[176:179], a[48:51], v[16:19]
    ds_read_b64_tr_b16 v[172:173], v225 offset:32776
    v_mfma_f32_16x16x32_bf16 v[48:51], v[176:179], a[52:55], v[48:51]
    ds_read_b64_tr_b16 v[174:175], v225 offset:33800
    v_mfma_f32_16x16x32_bf16 v[80:83], v[176:179], a[56:59], v[80:83]
    v_mfma_f32_16x16x32_bf16 v[112:115], v[176:179], a[60:63], v[112:115]
    v_mfma_f32_16x16x32_bf16 v[20:23], v[180:183], a[48:51], v[20:23]
    ds_read_b64_tr_b16 v[176:177], v226 offset:32768
    v_mfma_f32_16x16x32_bf16 v[52:55], v[180:183], a[52:55], v[52:55]
    ds_read_b64_tr_b16 v[178:179], v226 offset:33792
    v_mfma_f32_16x16x32_bf16 v[84:87], v[180:183], a[56:59], v[84:87]
    s_add_u32 m0, s58, 65536
    s_mov_b32 s55, 704512
    buffer_load_dwordx4 v254, s[16:19], s55 offen lds
    v_mfma_f32_16x16x32_bf16 v[116:119], v[180:183], a[60:63], v[116:119]
    v_mfma_f32_16x16x32_bf16 v[24:27], v[184:187], a[48:51], v[24:27]
    ds_read_b64_tr_b16 v[180:181], v226 offset:32776
    v_mfma_f32_16x16x32_bf16 v[56:59], v[184:187], a[52:55], v[56:59]
    ds_read_b64_tr_b16 v[182:183], v226 offset:33800
    v_mfma_f32_16x16x32_bf16 v[88:91], v[184:187], a[56:59], v[88:91]
    buffer_load_dwordx4 v255, s[16:19], s55 offen offset:1024 lds
    v_mfma_f32_16x16x32_bf16 v[120:123], v[184:187], a[60:63], v[120:123]
    v_mfma_f32_16x16x32_bf16 v[28:31], v[188:191], a[48:51], v[28:31]
    ds_read_b64_tr_b16 v[184:185], v227 offset:32768
    v_mfma_f32_16x16x32_bf16 v[60:63], v[188:191], a[52:55], v[60:63]
    ds_read_b64_tr_b16 v[186:187], v227 offset:33792
    v_mfma_f32_16x16x32_bf16 v[92:95], v[188:191], a[56:59], v[92:95]
    buffer_load_dwordx4 a[112:115], v230, s[8:11], s52 offen offset:2048 sc1
    v_mfma_f32_16x16x32_bf16 v[124:127], v[188:191], a[60:63], v[124:127]
    s_waitcnt lgkmcnt(14)
    v_mfma_f32_16x16x32_bf16 v[128:131], v[192:195], a[48:51], v[128:131]
    ds_read_b64_tr_b16 v[188:189], v227 offset:32776
    v_mfma_f32_16x16x32_bf16 v[136:139], v[192:195], a[52:55], v[136:139]
    ds_read_b64_tr_b16 v[190:191], v227 offset:33800
    v_mfma_f32_16x16x32_bf16 v[144:147], v[192:195], a[56:59], v[144:147]
    v_mfma_f32_16x16x32_bf16 v[152:155], v[192:195], a[60:63], v[152:155]
    buffer_load_dwordx4 a[116:119], v231, s[8:11], s52 offen offset:2048 sc1
    v_mfma_f32_16x16x32_bf16 v[132:135], v[196:199], a[48:51], v[132:135]
    ds_read_b64_tr_b16 v[192:193], v228 offset:16384
    v_mfma_f32_16x16x32_bf16 v[140:143], v[196:199], a[52:55], v[140:143]
    ds_read_b64_tr_b16 v[194:195], v228 offset:16640
    v_mfma_f32_16x16x32_bf16 v[148:151], v[196:199], a[56:59], v[148:151]
    v_mfma_f32_16x16x32_bf16 v[156:159], v[196:199], a[60:63], v[156:159]
    v_mfma_f32_16x16x32_bf16 v[208:211], v[200:203], a[48:51], v[208:211]
    ds_read_b64_tr_b16 v[196:197], v229 offset:16384
    v_mfma_f32_16x16x32_bf16 v[216:219], v[200:203], a[52:55], v[216:219]
    ds_read_b64_tr_b16 v[198:199], v229 offset:16640
    v_mfma_f32_16x16x32_bf16 v[212:215], v[204:207], a[48:51], v[212:215]
    ds_read_b64_tr_b16 v[200:201], v228 offset:17408
    v_mfma_f32_16x16x32_bf16 v[220:223], v[204:207], a[52:55], v[220:223]
    s_waitcnt vmcnt(22) lgkmcnt(13)
    ds_read_b64_tr_b16 v[202:203], v228 offset:17664
    v_mfma_f32_16x16x32_bf16 v[0:3], v[160:163], a[64:67], v[0:3]
    ds_read_b64_tr_b16 v[204:205], v229 offset:17408
    v_mfma_f32_16x16x32_bf16 v[32:35], v[160:163], a[68:71], v[32:35]
    ds_read_b64_tr_b16 v[206:207], v229 offset:17664
    v_mfma_f32_16x16x32_bf16 v[64:67], v[160:163], a[72:75], v[64:67]
    buffer_load_dwordx4 a[120:123], v230, s[8:11], s53 offen offset:2048 sc1
    v_mfma_f32_16x16x32_bf16 v[96:99], v[160:163], a[76:79], v[96:99]
    buffer_load_dwordx4 a[124:127], v231, s[8:11], s53 offen offset:2048 sc1
    v_mfma_f32_16x16x32_bf16 v[4:7], v[164:167], a[64:67], v[4:7]
    ds_read_b64_tr_b16 v[160:161], v224 offset:40960
    v_mfma_f32_16x16x32_bf16 v[36:39], v[164:167], a[68:71], v[36:39]
    ds_read_b64_tr_b16 v[162:163], v224 offset:41984
    v_mfma_f32_16x16x32_bf16 v[68:71], v[164:167], a[72:75], v[68:71]
    v_mfma_f32_16x16x32_bf16 v[100:103], v[164:167], a[76:79], v[100:103]
    v_mfma_f32_16x16x32_bf16 v[8:11], v[168:171], a[64:67], v[8:11]
    ds_read_b64_tr_b16 v[164:165], v224 offset:40968
    v_mfma_f32_16x16x32_bf16 v[40:43], v[168:171], a[68:71], v[40:43]
    ds_read_b64_tr_b16 v[166:167], v224 offset:41992
    v_mfma_f32_16x16x32_bf16 v[72:75], v[168:171], a[72:75], v[72:75]
    s_add_u32 s52, s52, 4096
    buffer_load_dwordx4 a[128:131], v230, s[8:11], s52 offen offset:0 sc1
    v_mfma_f32_16x16x32_bf16 v[104:107], v[168:171], a[76:79], v[104:107]
    v_mfma_f32_16x16x32_bf16 v[12:15], v[172:175], a[64:67], v[12:15]
    ds_read_b64_tr_b16 v[168:169], v225 offset:40960
    v_mfma_f32_16x16x32_bf16 v[44:47], v[172:175], a[68:71], v[44:47]
    ds_read_b64_tr_b16 v[170:171], v225 offset:41984
    v_mfma_f32_16x16x32_bf16 v[76:79], v[172:175], a[72:75], v[76:79]
    buffer_load_dwordx4 a[132:135], v231, s[8:11], s52 offen offset:0 sc1
    v_mfma_f32_16x16x32_bf16 v[108:111], v[172:175], a[76:79], v[108:111]
    s_waitcnt lgkmcnt(14)
    v_mfma_f32_16x16x32_bf16 v[16:19], v[176:179], a[64:67], v[16:19]
    ds_read_b64_tr_b16 v[172:173], v225 offset:40968
    v_mfma_f32_16x16x32_bf16 v[48:51], v[176:179], a[68:71], v[48:51]
    ds_read_b64_tr_b16 v[174:175], v225 offset:41992
    v_mfma_f32_16x16x32_bf16 v[80:83], v[176:179], a[72:75], v[80:83]
    s_add_u32 s53, s53, 4096
    buffer_load_dwordx4 a[136:139], v230, s[8:11], s53 offen offset:0 sc1
    v_mfma_f32_16x16x32_bf16 v[112:115], v[176:179], a[76:79], v[112:115]
    v_mfma_f32_16x16x32_bf16 v[20:23], v[180:183], a[64:67], v[20:23]
    ds_read_b64_tr_b16 v[176:177], v226 offset:40960
    v_mfma_f32_16x16x32_bf16 v[52:55], v[180:183], a[68:71], v[52:55]
    ds_read_b64_tr_b16 v[178:179], v226 offset:41984
    v_mfma_f32_16x16x32_bf16 v[84:87], v[180:183], a[72:75], v[84:87]
    v_mfma_f32_16x16x32_bf16 v[116:119], v[180:183], a[76:79], v[116:119]
    buffer_load_dwordx4 a[140:143], v231, s[8:11], s53 offen offset:0 sc1
    v_mfma_f32_16x16x32_bf16 v[24:27], v[184:187], a[64:67], v[24:27]
    ds_read_b64_tr_b16 v[180:181], v226 offset:40968
    v_mfma_f32_16x16x32_bf16 v[56:59], v[184:187], a[68:71], v[56:59]
    ds_read_b64_tr_b16 v[182:183], v226 offset:41992
    v_mfma_f32_16x16x32_bf16 v[88:91], v[184:187], a[72:75], v[88:91]
    v_mfma_f32_16x16x32_bf16 v[120:123], v[184:187], a[76:79], v[120:123]
    v_mfma_f32_16x16x32_bf16 v[28:31], v[188:191], a[64:67], v[28:31]
    ds_read_b64_tr_b16 v[184:185], v227 offset:40960
    v_mfma_f32_16x16x32_bf16 v[60:63], v[188:191], a[68:71], v[60:63]
    ds_read_b64_tr_b16 v[186:187], v227 offset:41984
    v_mfma_f32_16x16x32_bf16 v[92:95], v[188:191], a[72:75], v[92:95]
    v_mfma_f32_16x16x32_bf16 v[124:127], v[188:191], a[76:79], v[124:127]
    s_waitcnt lgkmcnt(14)
    v_mfma_f32_16x16x32_bf16 v[128:131], v[192:195], a[64:67], v[128:131]
    ds_read_b64_tr_b16 v[188:189], v227 offset:40968
    v_mfma_f32_16x16x32_bf16 v[136:139], v[192:195], a[68:71], v[136:139]
    ds_read_b64_tr_b16 v[190:191], v227 offset:41992
    v_mfma_f32_16x16x32_bf16 v[144:147], v[192:195], a[72:75], v[144:147]
    v_mfma_f32_16x16x32_bf16 v[152:155], v[192:195], a[76:79], v[152:155]
    v_mfma_f32_16x16x32_bf16 v[132:135], v[196:199], a[64:67], v[132:135]
    ds_read_b64_tr_b16 v[192:193], v228 offset:20480
    v_mfma_f32_16x16x32_bf16 v[140:143], v[196:199], a[68:71], v[140:143]
    ds_read_b64_tr_b16 v[194:195], v228 offset:20736
    v_mfma_f32_16x16x32_bf16 v[148:151], v[196:199], a[72:75], v[148:151]
    v_mfma_f32_16x16x32_bf16 v[156:159], v[196:199], a[76:79], v[156:159]
    v_mfma_f32_16x16x32_bf16 v[208:211], v[200:203], a[64:67], v[208:211]
    ds_read_b64_tr_b16 v[196:197], v229 offset:20480
    v_mfma_f32_16x16x32_bf16 v[216:219], v[200:203], a[68:71], v[216:219]
    ds_read_b64_tr_b16 v[198:199], v229 offset:20736
    v_mfma_f32_16x16x32_bf16 v[212:215], v[204:207], a[64:67], v[212:215]
    ds_read_b64_tr_b16 v[200:201], v228 offset:21504
    v_mfma_f32_16x16x32_bf16 v[220:223], v[204:207], a[68:71], v[220:223]
    s_waitcnt vmcnt(18) lgkmcnt(13)
    s_barrier
    ds_read_b64_tr_b16 v[202:203], v228 offset:21760
    v_mfma_f32_16x16x32_bf16 v[0:3], v[160:163], a[80:83], v[0:3]
    ds_read_b64_tr_b16 v[204:205], v229 offset:21504
    v_mfma_f32_16x16x32_bf16 v[32:35], v[160:163], a[84:87], v[32:35]
    ds_read_b64_tr_b16 v[206:207], v229 offset:21760
    v_mfma_f32_16x16x32_bf16 v[64:67], v[160:163], a[88:91], v[64:67]
    buffer_load_dword a250, v247, s[12:15], 0 offen
    v_mfma_f32_16x16x32_bf16 v[96:99], v[160:163], a[92:95], v[96:99]
    buffer_load_dword a251, v248, s[16:19], 0 offen
    v_mfma_f32_16x16x32_bf16 v[4:7], v[164:167], a[80:83], v[4:7]
    ds_read_b64_tr_b16 v[160:161], v224 offset:49152
    v_mfma_f32_16x16x32_bf16 v[36:39], v[164:167], a[84:87], v[36:39]
    ds_read_b64_tr_b16 v[162:163], v224 offset:50176
    v_mfma_f32_16x16x32_bf16 v[68:71], v[164:167], a[88:91], v[68:71]
    s_add_u32 m0, s57, 16384
    s_mov_b32 s54, 2621440
    buffer_load_dwordx4 v250, s[12:15], s54 offen offset:0 lds
    v_mfma_f32_16x16x32_bf16 v[100:103], v[164:167], a[92:95], v[100:103]
    v_mfma_f32_16x16x32_bf16 v[8:11], v[168:171], a[80:83], v[8:11]
    ds_read_b64_tr_b16 v[164:165], v224 offset:49160
    v_mfma_f32_16x16x32_bf16 v[40:43], v[168:171], a[84:87], v[40:43]
    ds_read_b64_tr_b16 v[166:167], v224 offset:50184
    v_mfma_f32_16x16x32_bf16 v[72:75], v[168:171], a[88:91], v[72:75]
    buffer_load_dwordx4 v251, s[12:15], s54 offen offset:1024 lds
    v_mfma_f32_16x16x32_bf16 v[104:107], v[168:171], a[92:95], v[104:107]
    v_mfma_f32_16x16x32_bf16 v[12:15], v[172:175], a[80:83], v[12:15]
    ds_read_b64_tr_b16 v[168:169], v225 offset:49152
    v_mfma_f32_16x16x32_bf16 v[44:47], v[172:175], a[84:87], v[44:47]
    ds_read_b64_tr_b16 v[170:171], v225 offset:50176
    v_mfma_f32_16x16x32_bf16 v[76:79], v[172:175], a[88:91], v[76:79]
    buffer_load_dwordx4 v252, s[12:15], s54 offen offset:2048 lds
    v_mfma_f32_16x16x32_bf16 v[108:111], v[172:175], a[92:95], v[108:111]
    s_waitcnt lgkmcnt(14)
    v_mfma_f32_16x16x32_bf16 v[16:19], v[176:179], a[80:83], v[16:19]
    ds_read_b64_tr_b16 v[172:173], v225 offset:49160
    v_mfma_f32_16x16x32_bf16 v[48:51], v[176:179], a[84:87], v[48:51]
    ds_read_b64_tr_b16 v[174:175], v225 offset:50184
    v_mfma_f32_16x16x32_bf16 v[80:83], v[176:179], a[88:91], v[80:83]
    v_mfma_f32_16x16x32_bf16 v[112:115], v[176:179], a[92:95], v[112:115]
    buffer_load_dwordx4 v253, s[12:15], s54 offen offset:3072 lds
    v_mfma_f32_16x16x32_bf16 v[20:23], v[180:183], a[80:83], v[20:23]
    ds_read_b64_tr_b16 v[176:177], v226 offset:49152
    v_mfma_f32_16x16x32_bf16 v[52:55], v[180:183], a[84:87], v[52:55]
    ds_read_b64_tr_b16 v[178:179], v226 offset:50176
    v_mfma_f32_16x16x32_bf16 v[84:87], v[180:183], a[88:91], v[84:87]
    v_mfma_f32_16x16x32_bf16 v[116:119], v[180:183], a[92:95], v[116:119]
    v_mfma_f32_16x16x32_bf16 v[24:27], v[184:187], a[80:83], v[24:27]
    ds_read_b64_tr_b16 v[180:181], v226 offset:49160
    v_mfma_f32_16x16x32_bf16 v[56:59], v[184:187], a[84:87], v[56:59]
    ds_read_b64_tr_b16 v[182:183], v226 offset:50184
    v_mfma_f32_16x16x32_bf16 v[88:91], v[184:187], a[88:91], v[88:91]
    s_add_u32 m0, s58, 73728
    s_mov_b32 s55, 880640
    buffer_load_dwordx4 v254, s[16:19], s55 offen lds
    v_mfma_f32_16x16x32_bf16 v[120:123], v[184:187], a[92:95], v[120:123]
    v_mfma_f32_16x16x32_bf16 v[28:31], v[188:191], a[80:83], v[28:31]
    ds_read_b64_tr_b16 v[184:185], v227 offset:49152
    v_mfma_f32_16x16x32_bf16 v[60:63], v[188:191], a[84:87], v[60:63]
    ds_read_b64_tr_b16 v[186:187], v227 offset:50176
    v_mfma_f32_16x16x32_bf16 v[92:95], v[188:191], a[88:91], v[92:95]
    buffer_load_dwordx4 v255, s[16:19], s55 offen offset:1024 lds
    v_mfma_f32_16x16x32_bf16 v[124:127], v[188:191], a[92:95], v[124:127]
    s_waitcnt lgkmcnt(14)
    v_mfma_f32_16x16x32_bf16 v[128:131], v[192:195], a[80:83], v[128:131]
    ds_read_b64_tr_b16 v[188:189], v227 offset:49160
    v_mfma_f32_16x16x32_bf16 v[136:139], v[192:195], a[84:87], v[136:139]
    ds_read_b64_tr_b16 v[190:191], v227 offset:50184
    v_mfma_f32_16x16x32_bf16 v[144:147], v[192:195], a[88:91], v[144:147]
    v_mfma_f32_16x16x32_bf16 v[152:155], v[192:195], a[92:95], v[152:155]
    v_mfma_f32_16x16x32_bf16 v[132:135], v[196:199], a[80:83], v[132:135]
    ds_read_b64_tr_b16 v[192:193], v228 offset:24576
    v_mfma_f32_16x16x32_bf16 v[140:143], v[196:199], a[84:87], v[140:143]
    ds_read_b64_tr_b16 v[194:195], v228 offset:24832
    v_mfma_f32_16x16x32_bf16 v[148:151], v[196:199], a[88:91], v[148:151]
    v_mfma_f32_16x16x32_bf16 v[156:159], v[196:199], a[92:95], v[156:159]
    v_mfma_f32_16x16x32_bf16 v[208:211], v[200:203], a[80:83], v[208:211]
    ds_read_b64_tr_b16 v[196:197], v229 offset:24576
    v_mfma_f32_16x16x32_bf16 v[216:219], v[200:203], a[84:87], v[216:219]
    ds_read_b64_tr_b16 v[198:199], v229 offset:24832
    v_mfma_f32_16x16x32_bf16 v[212:215], v[204:207], a[80:83], v[212:215]
    ds_read_b64_tr_b16 v[200:201], v228 offset:25600
    v_mfma_f32_16x16x32_bf16 v[220:223], v[204:207], a[84:87], v[220:223]
    s_waitcnt vmcnt(22) lgkmcnt(13)
    ds_read_b64_tr_b16 v[202:203], v228 offset:25856
    v_mfma_f32_16x16x32_bf16 v[0:3], v[160:163], a[96:99], v[0:3]
    ds_read_b64_tr_b16 v[204:205], v229 offset:25600
    v_mfma_f32_16x16x32_bf16 v[32:35], v[160:163], a[100:103], v[32:35]
    ds_read_b64_tr_b16 v[206:207], v229 offset:25856
    v_mfma_f32_16x16x32_bf16 v[64:67], v[160:163], a[104:107], v[64:67]
    v_mfma_f32_16x16x32_bf16 v[96:99], v[160:163], a[108:111], v[96:99]
    v_mfma_f32_16x16x32_bf16 v[4:7], v[164:167], a[96:99], v[4:7]
    ds_read_b64_tr_b16 v[160:161], v224 offset:57344
    v_mfma_f32_16x16x32_bf16 v[36:39], v[164:167], a[100:103], v[36:39]
    ds_read_b64_tr_b16 v[162:163], v224 offset:58368
    v_mfma_f32_16x16x32_bf16 v[68:71], v[164:167], a[104:107], v[68:71]
    v_mfma_f32_16x16x32_bf16 v[100:103], v[164:167], a[108:111], v[100:103]
    v_mfma_f32_16x16x32_bf16 v[8:11], v[168:171], a[96:99], v[8:11]
    ds_read_b64_tr_b16 v[164:165], v224 offset:57352
    v_mfma_f32_16x16x32_bf16 v[40:43], v[168:171], a[100:103], v[40:43]
    ds_read_b64_tr_b16 v[166:167], v224 offset:58376
    v_mfma_f32_16x16x32_bf16 v[72:75], v[168:171], a[104:107], v[72:75]
    v_mfma_f32_16x16x32_bf16 v[104:107], v[168:171], a[108:111], v[104:107]
    v_mfma_f32_16x16x32_bf16 v[12:15], v[172:175], a[96:99], v[12:15]
    ds_read_b64_tr_b16 v[168:169], v225 offset:57344
    v_mfma_f32_16x16x32_bf16 v[44:47], v[172:175], a[100:103], v[44:47]
    ds_read_b64_tr_b16 v[170:171], v225 offset:58368
    v_mfma_f32_16x16x32_bf16 v[76:79], v[172:175], a[104:107], v[76:79]
    v_mfma_f32_16x16x32_bf16 v[108:111], v[172:175], a[108:111], v[108:111]
    s_waitcnt lgkmcnt(14)
    v_mfma_f32_16x16x32_bf16 v[16:19], v[176:179], a[96:99], v[16:19]
    ds_read_b64_tr_b16 v[172:173], v225 offset:57352
    v_mfma_f32_16x16x32_bf16 v[48:51], v[176:179], a[100:103], v[48:51]
    ds_read_b64_tr_b16 v[174:175], v225 offset:58376
    v_mfma_f32_16x16x32_bf16 v[80:83], v[176:179], a[104:107], v[80:83]
    v_mfma_f32_16x16x32_bf16 v[112:115], v[176:179], a[108:111], v[112:115]
    v_mfma_f32_16x16x32_bf16 v[20:23], v[180:183], a[96:99], v[20:23]
    ds_read_b64_tr_b16 v[176:177], v226 offset:57344
    v_mfma_f32_16x16x32_bf16 v[52:55], v[180:183], a[100:103], v[52:55]
    ds_read_b64_tr_b16 v[178:179], v226 offset:58368
    v_mfma_f32_16x16x32_bf16 v[84:87], v[180:183], a[104:107], v[84:87]
    v_mfma_f32_16x16x32_bf16 v[116:119], v[180:183], a[108:111], v[116:119]
    v_mfma_f32_16x16x32_bf16 v[24:27], v[184:187], a[96:99], v[24:27]
    ds_read_b64_tr_b16 v[180:181], v226 offset:57352
    v_mfma_f32_16x16x32_bf16 v[56:59], v[184:187], a[100:103], v[56:59]
    ds_read_b64_tr_b16 v[182:183], v226 offset:58376
    v_mfma_f32_16x16x32_bf16 v[88:91], v[184:187], a[104:107], v[88:91]
    v_mfma_f32_16x16x32_bf16 v[120:123], v[184:187], a[108:111], v[120:123]
    v_mfma_f32_16x16x32_bf16 v[28:31], v[188:191], a[96:99], v[28:31]
    ds_read_b64_tr_b16 v[184:185], v227 offset:57344
    v_mfma_f32_16x16x32_bf16 v[60:63], v[188:191], a[100:103], v[60:63]
    ds_read_b64_tr_b16 v[186:187], v227 offset:58368
    v_mfma_f32_16x16x32_bf16 v[92:95], v[188:191], a[104:107], v[92:95]
    buffer_load_dwordx4 a[144:147], v230, s[8:11], s52 offen offset:2048 sc1
    v_mfma_f32_16x16x32_bf16 v[124:127], v[188:191], a[108:111], v[124:127]
    s_waitcnt lgkmcnt(14)
    v_mfma_f32_16x16x32_bf16 v[128:131], v[192:195], a[96:99], v[128:131]
    ds_read_b64_tr_b16 v[188:189], v227 offset:57352
    v_mfma_f32_16x16x32_bf16 v[136:139], v[192:195], a[100:103], v[136:139]
    ds_read_b64_tr_b16 v[190:191], v227 offset:58376
    v_mfma_f32_16x16x32_bf16 v[144:147], v[192:195], a[104:107], v[144:147]
    v_mfma_f32_16x16x32_bf16 v[152:155], v[192:195], a[108:111], v[152:155]
    buffer_load_dwordx4 a[148:151], v231, s[8:11], s52 offen offset:2048 sc1
    v_mfma_f32_16x16x32_bf16 v[132:135], v[196:199], a[96:99], v[132:135]
    ds_read_b64_tr_b16 v[192:193], v228 offset:28672
    v_mfma_f32_16x16x32_bf16 v[140:143], v[196:199], a[100:103], v[140:143]
    ds_read_b64_tr_b16 v[194:195], v228 offset:28928
    v_mfma_f32_16x16x32_bf16 v[148:151], v[196:199], a[104:107], v[148:151]
    v_mfma_f32_16x16x32_bf16 v[156:159], v[196:199], a[108:111], v[156:159]
    v_mfma_f32_16x16x32_bf16 v[208:211], v[200:203], a[96:99], v[208:211]
    ds_read_b64_tr_b16 v[196:197], v229 offset:28672
    v_mfma_f32_16x16x32_bf16 v[216:219], v[200:203], a[100:103], v[216:219]
    ds_read_b64_tr_b16 v[198:199], v229 offset:28928
    v_mfma_f32_16x16x32_bf16 v[212:215], v[204:207], a[96:99], v[212:215]
    ds_read_b64_tr_b16 v[200:201], v228 offset:29696
    v_mfma_f32_16x16x32_bf16 v[220:223], v[204:207], a[100:103], v[220:223]
    s_waitcnt vmcnt(14) lgkmcnt(13)
    s_barrier
    ds_read_b64_tr_b16 v[202:203], v228 offset:29952
    v_mfma_f32_16x16x32_bf16 v[0:3], v[160:163], a[112:115], v[0:3]
    ds_read_b64_tr_b16 v[204:205], v229 offset:29696
    v_mfma_f32_16x16x32_bf16 v[32:35], v[160:163], a[116:119], v[32:35]
    ds_read_b64_tr_b16 v[206:207], v229 offset:29952
    v_mfma_f32_16x16x32_bf16 v[64:67], v[160:163], a[120:123], v[64:67]
    buffer_load_dwordx4 a[152:155], v230, s[8:11], s53 offen offset:2048 sc1
    v_mfma_f32_16x16x32_bf16 v[96:99], v[160:163], a[124:127], v[96:99]
    buffer_load_dwordx4 a[156:159], v231, s[8:11], s53 offen offset:2048 sc1
    v_mfma_f32_16x16x32_bf16 v[4:7], v[164:167], a[112:115], v[4:7]
    ds_read_b64_tr_b16 v[160:161], v224 offset:0
    v_mfma_f32_16x16x32_bf16 v[36:39], v[164:167], a[116:119], v[36:39]
    ds_read_b64_tr_b16 v[162:163], v224 offset:1024
    v_mfma_f32_16x16x32_bf16 v[68:71], v[164:167], a[120:123], v[68:71]
    v_mfma_f32_16x16x32_bf16 v[100:103], v[164:167], a[124:127], v[100:103]
    v_mfma_f32_16x16x32_bf16 v[8:11], v[168:171], a[112:115], v[8:11]
    ds_read_b64_tr_b16 v[164:165], v224 offset:8
    v_mfma_f32_16x16x32_bf16 v[40:43], v[168:171], a[116:119], v[40:43]
    ds_read_b64_tr_b16 v[166:167], v224 offset:1032
    v_mfma_f32_16x16x32_bf16 v[72:75], v[168:171], a[120:123], v[72:75]
    s_add_u32 s52, s52, 4096
    buffer_load_dwordx4 a[160:163], v230, s[8:11], s52 offen offset:0 sc1
    v_mfma_f32_16x16x32_bf16 v[104:107], v[168:171], a[124:127], v[104:107]
    v_mfma_f32_16x16x32_bf16 v[12:15], v[172:175], a[112:115], v[12:15]
    ds_read_b64_tr_b16 v[168:169], v225 offset:0
    v_mfma_f32_16x16x32_bf16 v[44:47], v[172:175], a[116:119], v[44:47]
    ds_read_b64_tr_b16 v[170:171], v225 offset:1024
    v_mfma_f32_16x16x32_bf16 v[76:79], v[172:175], a[120:123], v[76:79]
    buffer_load_dwordx4 a[164:167], v231, s[8:11], s52 offen offset:0 sc1
    v_mfma_f32_16x16x32_bf16 v[108:111], v[172:175], a[124:127], v[108:111]
    s_waitcnt lgkmcnt(14)
    v_mfma_f32_16x16x32_bf16 v[16:19], v[176:179], a[112:115], v[16:19]
    ds_read_b64_tr_b16 v[172:173], v225 offset:8
    v_mfma_f32_16x16x32_bf16 v[48:51], v[176:179], a[116:119], v[48:51]
    ds_read_b64_tr_b16 v[174:175], v225 offset:1032
    v_mfma_f32_16x16x32_bf16 v[80:83], v[176:179], a[120:123], v[80:83]
    s_add_u32 s53, s53, 4096
    buffer_load_dwordx4 a[168:171], v230, s[8:11], s53 offen offset:0 sc1
    v_mfma_f32_16x16x32_bf16 v[112:115], v[176:179], a[124:127], v[112:115]
    v_mfma_f32_16x16x32_bf16 v[20:23], v[180:183], a[112:115], v[20:23]
    ds_read_b64_tr_b16 v[176:177], v226 offset:0
    v_mfma_f32_16x16x32_bf16 v[52:55], v[180:183], a[116:119], v[52:55]
    ds_read_b64_tr_b16 v[178:179], v226 offset:1024
    v_mfma_f32_16x16x32_bf16 v[84:87], v[180:183], a[120:123], v[84:87]
    v_mfma_f32_16x16x32_bf16 v[116:119], v[180:183], a[124:127], v[116:119]
    buffer_load_dwordx4 a[172:175], v231, s[8:11], s53 offen offset:0 sc1
    v_mfma_f32_16x16x32_bf16 v[24:27], v[184:187], a[112:115], v[24:27]
    ds_read_b64_tr_b16 v[180:181], v226 offset:8
    v_mfma_f32_16x16x32_bf16 v[56:59], v[184:187], a[116:119], v[56:59]
    ds_read_b64_tr_b16 v[182:183], v226 offset:1032
    v_mfma_f32_16x16x32_bf16 v[88:91], v[184:187], a[120:123], v[88:91]
    v_mfma_f32_16x16x32_bf16 v[120:123], v[184:187], a[124:127], v[120:123]
    v_mfma_f32_16x16x32_bf16 v[28:31], v[188:191], a[112:115], v[28:31]
    ds_read_b64_tr_b16 v[184:185], v227 offset:0
    v_mfma_f32_16x16x32_bf16 v[60:63], v[188:191], a[116:119], v[60:63]
    ds_read_b64_tr_b16 v[186:187], v227 offset:1024
    v_mfma_f32_16x16x32_bf16 v[92:95], v[188:191], a[120:123], v[92:95]
    s_add_u32 m0, s57, 32768
    s_mov_b32 s54, 3145728
    buffer_load_dwordx4 v250, s[12:15], s54 offen offset:0 lds
    v_mfma_f32_16x16x32_bf16 v[124:127], v[188:191], a[124:127], v[124:127]
    s_waitcnt lgkmcnt(14)
    v_mfma_f32_16x16x32_bf16 v[128:131], v[192:195], a[112:115], v[128:131]
    ds_read_b64_tr_b16 v[188:189], v227 offset:8
    v_mfma_f32_16x16x32_bf16 v[136:139], v[192:195], a[116:119], v[136:139]
    ds_read_b64_tr_b16 v[190:191], v227 offset:1032
    v_mfma_f32_16x16x32_bf16 v[144:147], v[192:195], a[120:123], v[144:147]
    buffer_load_dwordx4 v251, s[12:15], s54 offen offset:1024 lds
    v_mfma_f32_16x16x32_bf16 v[152:155], v[192:195], a[124:127], v[152:155]
    v_mfma_f32_16x16x32_bf16 v[132:135], v[196:199], a[112:115], v[132:135]
    ds_read_b64_tr_b16 v[192:193], v228 offset:0
    v_mfma_f32_16x16x32_bf16 v[140:143], v[196:199], a[116:119], v[140:143]
    ds_read_b64_tr_b16 v[194:195], v228 offset:256
    v_mfma_f32_16x16x32_bf16 v[148:151], v[196:199], a[120:123], v[148:151]
    buffer_load_dwordx4 v252, s[12:15], s54 offen offset:2048 lds
    v_mfma_f32_16x16x32_bf16 v[156:159], v[196:199], a[124:127], v[156:159]
    v_mfma_f32_16x16x32_bf16 v[208:211], v[200:203], a[112:115], v[208:211]
    ds_read_b64_tr_b16 v[196:197], v229 offset:0
    v_mfma_f32_16x16x32_bf16 v[216:219], v[200:203], a[116:119], v[216:219]
    ds_read_b64_tr_b16 v[198:199], v229 offset:256
    v_mfma_f32_16x16x32_bf16 v[212:215], v[204:207], a[112:115], v[212:215]
    ds_read_b64_tr_b16 v[200:201], v228 offset:1024
    v_mfma_f32_16x16x32_bf16 v[220:223], v[204:207], a[116:119], v[220:223]
    s_waitcnt vmcnt(19) lgkmcnt(13)
    ds_read_b64_tr_b16 v[202:203], v228 offset:1280
    v_mfma_f32_16x16x32_bf16 v[0:3], v[160:163], a[128:131], v[0:3]
    ds_read_b64_tr_b16 v[204:205], v229 offset:1024
    v_mfma_f32_16x16x32_bf16 v[32:35], v[160:163], a[132:135], v[32:35]
    ds_read_b64_tr_b16 v[206:207], v229 offset:1280
    v_mfma_f32_16x16x32_bf16 v[64:67], v[160:163], a[136:139], v[64:67]
    buffer_load_dwordx4 v253, s[12:15], s54 offen offset:3072 lds
    v_mfma_f32_16x16x32_bf16 v[96:99], v[160:163], a[140:143], v[96:99]
    v_mfma_f32_16x16x32_bf16 v[4:7], v[164:167], a[128:131], v[4:7]
    ds_read_b64_tr_b16 v[160:161], v224 offset:8192
    v_mfma_f32_16x16x32_bf16 v[36:39], v[164:167], a[132:135], v[36:39]
    ds_read_b64_tr_b16 v[162:163], v224 offset:9216
    v_mfma_f32_16x16x32_bf16 v[68:71], v[164:167], a[136:139], v[68:71]
    s_add_u32 m0, s58, 81920
    s_mov_b32 s55, 1056768
    buffer_load_dwordx4 v254, s[16:19], s55 offen lds
    v_mfma_f32_16x16x32_bf16 v[100:103], v[164:167], a[140:143], v[100:103]
    v_mfma_f32_16x16x32_bf16 v[8:11], v[168:171], a[128:131], v[8:11]
    ds_read_b64_tr_b16 v[164:165], v224 offset:8200
    v_mfma_f32_16x16x32_bf16 v[40:43], v[168:171], a[132:135], v[40:43]
    ds_read_b64_tr_b16 v[166:167], v224 offset:9224
    v_mfma_f32_16x16x32_bf16 v[72:75], v[168:171], a[136:139], v[72:75]
    buffer_load_dwordx4 v255, s[16:19], s55 offen offset:1024 lds
    v_mfma_f32_16x16x32_bf16 v[104:107], v[168:171], a[140:143], v[104:107]
    v_mfma_f32_16x16x32_bf16 v[12:15], v[172:175], a[128:131], v[12:15]
    ds_read_b64_tr_b16 v[168:169], v225 offset:8192
    v_mfma_f32_16x16x32_bf16 v[44:47], v[172:175], a[132:135], v[44:47]
    ds_read_b64_tr_b16 v[170:171], v225 offset:9216
    v_mfma_f32_16x16x32_bf16 v[76:79], v[172:175], a[136:139], v[76:79]
    buffer_load_dwordx4 a[176:179], v230, s[8:11], s52 offen offset:2048 sc1
    v_mfma_f32_16x16x32_bf16 v[108:111], v[172:175], a[140:143], v[108:111]
    s_waitcnt lgkmcnt(14)
    v_mfma_f32_16x16x32_bf16 v[16:19], v[176:179], a[128:131], v[16:19]
    ds_read_b64_tr_b16 v[172:173], v225 offset:8200
    v_mfma_f32_16x16x32_bf16 v[48:51], v[176:179], a[132:135], v[48:51]
    ds_read_b64_tr_b16 v[174:175], v225 offset:9224
    v_mfma_f32_16x16x32_bf16 v[80:83], v[176:179], a[136:139], v[80:83]
    v_mfma_f32_16x16x32_bf16 v[112:115], v[176:179], a[140:143], v[112:115]
    buffer_load_dwordx4 a[180:183], v231, s[8:11], s52 offen offset:2048 sc1
    v_mfma_f32_16x16x32_bf16 v[20:23], v[180:183], a[128:131], v[20:23]
    ds_read_b64_tr_b16 v[176:177], v226 offset:8192
    v_mfma_f32_16x16x32_bf16 v[52:55], v[180:183], a[132:135], v[52:55]
    ds_read_b64_tr_b16 v[178:179], v226 offset:9216
    v_mfma_f32_16x16x32_bf16 v[84:87], v[180:183], a[136:139], v[84:87]
    v_mfma_f32_16x16x32_bf16 v[116:119], v[180:183], a[140:143], v[116:119]
    v_mfma_f32_16x16x32_bf16 v[24:27], v[184:187], a[128:131], v[24:27]
    ds_read_b64_tr_b16 v[180:181], v226 offset:8200
    v_mfma_f32_16x16x32_bf16 v[56:59], v[184:187], a[132:135], v[56:59]
    ds_read_b64_tr_b16 v[182:183], v226 offset:9224
    v_mfma_f32_16x16x32_bf16 v[88:91], v[184:187], a[136:139], v[88:91]
    buffer_load_dwordx4 a[184:187], v230, s[8:11], s53 offen offset:2048 sc1
    v_mfma_f32_16x16x32_bf16 v[120:123], v[184:187], a[140:143], v[120:123]
    v_mfma_f32_16x16x32_bf16 v[28:31], v[188:191], a[128:131], v[28:31]
    ds_read_b64_tr_b16 v[184:185], v227 offset:8192
    v_mfma_f32_16x16x32_bf16 v[60:63], v[188:191], a[132:135], v[60:63]
    ds_read_b64_tr_b16 v[186:187], v227 offset:9216
    v_mfma_f32_16x16x32_bf16 v[92:95], v[188:191], a[136:139], v[92:95]
    buffer_load_dwordx4 a[188:191], v231, s[8:11], s53 offen offset:2048 sc1
    v_mfma_f32_16x16x32_bf16 v[124:127], v[188:191], a[140:143], v[124:127]
    s_waitcnt lgkmcnt(14)
    v_mfma_f32_16x16x32_bf16 v[128:131], v[192:195], a[128:131], v[128:131]
    ds_read_b64_tr_b16 v[188:189], v227 offset:8200
    v_mfma_f32_16x16x32_bf16 v[136:139], v[192:195], a[132:135], v[136:139]
    ds_read_b64_tr_b16 v[190:191], v227 offset:9224
    v_mfma_f32_16x16x32_bf16 v[144:147], v[192:195], a[136:139], v[144:147]
    s_add_u32 s52, s52, 4096
    buffer_load_dwordx4 a[192:195], v230, s[8:11], s52 offen offset:0 sc1
    v_mfma_f32_16x16x32_bf16 v[152:155], v[192:195], a[140:143], v[152:155]
    v_mfma_f32_16x16x32_bf16 v[132:135], v[196:199], a[128:131], v[132:135]
    ds_read_b64_tr_b16 v[192:193], v228 offset:4096
    v_mfma_f32_16x16x32_bf16 v[140:143], v[196:199], a[132:135], v[140:143]
    ds_read_b64_tr_b16 v[194:195], v228 offset:4352
    v_mfma_f32_16x16x32_bf16 v[148:151], v[196:199], a[136:139], v[148:151]
    v_mfma_f32_16x16x32_bf16 v[156:159], v[196:199], a[140:143], v[156:159]
    buffer_load_dwordx4 a[196:199], v231, s[8:11], s52 offen offset:0 sc1
    v_mfma_f32_16x16x32_bf16 v[208:211], v[200:203], a[128:131], v[208:211]
    ds_read_b64_tr_b16 v[196:197], v229 offset:4096
    v_mfma_f32_16x16x32_bf16 v[216:219], v[200:203], a[132:135], v[216:219]
    ds_read_b64_tr_b16 v[198:199], v229 offset:4352
    v_mfma_f32_16x16x32_bf16 v[212:215], v[204:207], a[128:131], v[212:215]
    ds_read_b64_tr_b16 v[200:201], v228 offset:5120
    v_mfma_f32_16x16x32_bf16 v[220:223], v[204:207], a[132:135], v[220:223]
    s_waitcnt vmcnt(16) lgkmcnt(13)
    s_barrier
    ds_read_b64_tr_b16 v[202:203], v228 offset:5376
    v_mfma_f32_16x16x32_bf16 v[0:3], v[160:163], a[144:147], v[0:3]
    ds_read_b64_tr_b16 v[204:205], v229 offset:5120
    v_mfma_f32_16x16x32_bf16 v[32:35], v[160:163], a[148:151], v[32:35]
    ds_read_b64_tr_b16 v[206:207], v229 offset:5376
    v_mfma_f32_16x16x32_bf16 v[64:67], v[160:163], a[152:155], v[64:67]
    s_add_u32 s53, s53, 4096
    buffer_load_dwordx4 a[200:203], v230, s[8:11], s53 offen offset:0 sc1
    v_mfma_f32_16x16x32_bf16 v[96:99], v[160:163], a[156:159], v[96:99]
    v_mfma_f32_16x16x32_bf16 v[4:7], v[164:167], a[144:147], v[4:7]
    ds_read_b64_tr_b16 v[160:161], v224 offset:16384
    v_mfma_f32_16x16x32_bf16 v[36:39], v[164:167], a[148:151], v[36:39]
    ds_read_b64_tr_b16 v[162:163], v224 offset:17408
    v_mfma_f32_16x16x32_bf16 v[68:71], v[164:167], a[152:155], v[68:71]
    buffer_load_dwordx4 a[204:207], v231, s[8:11], s53 offen offset:0 sc1
    v_mfma_f32_16x16x32_bf16 v[100:103], v[164:167], a[156:159], v[100:103]
    v_mfma_f32_16x16x32_bf16 v[8:11], v[168:171], a[144:147], v[8:11]
    ds_read_b64_tr_b16 v[164:165], v224 offset:16392
    v_mfma_f32_16x16x32_bf16 v[40:43], v[168:171], a[148:151], v[40:43]
    ds_read_b64_tr_b16 v[166:167], v224 offset:17416
    v_mfma_f32_16x16x32_bf16 v[72:75], v[168:171], a[152:155], v[72:75]
    s_add_u32 m0, s57, 49152
    s_mov_b32 s54, 3670016
    buffer_load_dwordx4 v250, s[12:15], s54 offen offset:0 lds
    v_mfma_f32_16x16x32_bf16 v[104:107], v[168:171], a[156:159], v[104:107]
    v_mfma_f32_16x16x32_bf16 v[12:15], v[172:175], a[144:147], v[12:15]
    ds_read_b64_tr_b16 v[168:169], v225 offset:16384
    v_mfma_f32_16x16x32_bf16 v[44:47], v[172:175], a[148:151], v[44:47]
    ds_read_b64_tr_b16 v[170:171], v225 offset:17408
    v_mfma_f32_16x16x32_bf16 v[76:79], v[172:175], a[152:155], v[76:79]
    v_mfma_f32_16x16x32_bf16 v[108:111], v[172:175], a[156:159], v[108:111]
    s_waitcnt lgkmcnt(14)
    buffer_load_dwordx4 v251, s[12:15], s54 offen offset:1024 lds
    v_mfma_f32_16x16x32_bf16 v[16:19], v[176:179], a[144:147], v[16:19]
    ds_read_b64_tr_b16 v[172:173], v225 offset:16392
    v_mfma_f32_16x16x32_bf16 v[48:51], v[176:179], a[148:151], v[48:51]
    ds_read_b64_tr_b16 v[174:175], v225 offset:17416
    v_mfma_f32_16x16x32_bf16 v[80:83], v[176:179], a[152:155], v[80:83]
    v_mfma_f32_16x16x32_bf16 v[112:115], v[176:179], a[156:159], v[112:115]
    v_mfma_f32_16x16x32_bf16 v[20:23], v[180:183], a[144:147], v[20:23]
    ds_read_b64_tr_b16 v[176:177], v226 offset:16384
    v_mfma_f32_16x16x32_bf16 v[52:55], v[180:183], a[148:151], v[52:55]
    ds_read_b64_tr_b16 v[178:179], v226 offset:17408
    v_mfma_f32_16x16x32_bf16 v[84:87], v[180:183], a[152:155], v[84:87]
    buffer_load_dwordx4 v252, s[12:15], s54 offen offset:2048 lds
    v_mfma_f32_16x16x32_bf16 v[116:119], v[180:183], a[156:159], v[116:119]
    v_mfma_f32_16x16x32_bf16 v[24:27], v[184:187], a[144:147], v[24:27]
    ds_read_b64_tr_b16 v[180:181], v226 offset:16392
    v_mfma_f32_16x16x32_bf16 v[56:59], v[184:187], a[148:151], v[56:59]
    ds_read_b64_tr_b16 v[182:183], v226 offset:17416
    v_mfma_f32_16x16x32_bf16 v[88:91], v[184:187], a[152:155], v[88:91]
    buffer_load_dwordx4 v253, s[12:15], s54 offen offset:3072 lds
    v_mfma_f32_16x16x32_bf16 v[120:123], v[184:187], a[156:159], v[120:123]
    v_mfma_f32_16x16x32_bf16 v[28:31], v[188:191], a[144:147], v[28:31]
    ds_read_b64_tr_b16 v[184:185], v227 offset:16384
    v_mfma_f32_16x16x32_bf16 v[60:63], v[188:191], a[148:151], v[60:63]
    ds_read_b64_tr_b16 v[186:187], v227 offset:17408
    v_mfma_f32_16x16x32_bf16 v[92:95], v[188:191], a[152:155], v[92:95]
    s_add_u32 m0, s58, 90112
    s_mov_b32 s55, 1232896
    buffer_load_dwordx4 v254, s[16:19], s55 offen lds
    v_mfma_f32_16x16x32_bf16 v[124:127], v[188:191], a[156:159], v[124:127]
    s_waitcnt lgkmcnt(14)
    v_mfma_f32_16x16x32_bf16 v[128:131], v[192:195], a[144:147], v[128:131]
    ds_read_b64_tr_b16 v[188:189], v227 offset:16392
    v_mfma_f32_16x16x32_bf16 v[136:139], v[192:195], a[148:151], v[136:139]
    ds_read_b64_tr_b16 v[190:191], v227 offset:17416
    v_mfma_f32_16x16x32_bf16 v[144:147], v[192:195], a[152:155], v[144:147]
    v_mfma_f32_16x16x32_bf16 v[152:155], v[192:195], a[156:159], v[152:155]
    buffer_load_dwordx4 v255, s[16:19], s55 offen offset:1024 lds
    v_mfma_f32_16x16x32_bf16 v[132:135], v[196:199], a[144:147], v[132:135]
    ds_read_b64_tr_b16 v[192:193], v228 offset:8192
    v_mfma_f32_16x16x32_bf16 v[140:143], v[196:199], a[148:151], v[140:143]
    ds_read_b64_tr_b16 v[194:195], v228 offset:8448
    v_mfma_f32_16x16x32_bf16 v[148:151], v[196:199], a[152:155], v[148:151]
    v_mfma_f32_16x16x32_bf16 v[156:159], v[196:199], a[156:159], v[156:159]
    v_mfma_f32_16x16x32_bf16 v[208:211], v[200:203], a[144:147], v[208:211]
    ds_read_b64_tr_b16 v[196:197], v229 offset:8192
    v_mfma_f32_16x16x32_bf16 v[216:219], v[200:203], a[148:151], v[216:219]
    ds_read_b64_tr_b16 v[198:199], v229 offset:8448
    v_mfma_f32_16x16x32_bf16 v[212:215], v[204:207], a[144:147], v[212:215]
    ds_read_b64_tr_b16 v[200:201], v228 offset:9216
    v_mfma_f32_16x16x32_bf16 v[220:223], v[204:207], a[148:151], v[220:223]
    s_waitcnt vmcnt(20) lgkmcnt(13)
    ds_read_b64_tr_b16 v[202:203], v228 offset:9472
    v_mfma_f32_16x16x32_bf16 v[0:3], v[160:163], a[160:163], v[0:3]
    ds_read_b64_tr_b16 v[204:205], v229 offset:9216
    v_mfma_f32_16x16x32_bf16 v[32:35], v[160:163], a[164:167], v[32:35]
    ds_read_b64_tr_b16 v[206:207], v229 offset:9472
    v_mfma_f32_16x16x32_bf16 v[64:67], v[160:163], a[168:171], v[64:67]
    buffer_load_dwordx4 a[208:211], v230, s[8:11], s52 offen offset:2048 sc1
    v_mfma_f32_16x16x32_bf16 v[96:99], v[160:163], a[172:175], v[96:99]
    buffer_load_dwordx4 a[212:215], v231, s[8:11], s52 offen offset:2048 sc1
    v_mfma_f32_16x16x32_bf16 v[4:7], v[164:167], a[160:163], v[4:7]
    ds_read_b64_tr_b16 v[160:161], v224 offset:24576
    v_mfma_f32_16x16x32_bf16 v[36:39], v[164:167], a[164:167], v[36:39]
    ds_read_b64_tr_b16 v[162:163], v224 offset:25600
    v_mfma_f32_16x16x32_bf16 v[68:71], v[164:167], a[168:171], v[68:71]
    v_mfma_f32_16x16x32_bf16 v[100:103], v[164:167], a[172:175], v[100:103]
    v_mfma_f32_16x16x32_bf16 v[8:11], v[168:171], a[160:163], v[8:11]
    ds_read_b64_tr_b16 v[164:165], v224 offset:24584
    v_mfma_f32_16x16x32_bf16 v[40:43], v[168:171], a[164:167], v[40:43]
    ds_read_b64_tr_b16 v[166:167], v224 offset:25608
    v_mfma_f32_16x16x32_bf16 v[72:75], v[168:171], a[168:171], v[72:75]
    buffer_load_dwordx4 a[216:219], v230, s[8:11], s53 offen offset:2048 sc1
    v_mfma_f32_16x16x32_bf16 v[104:107], v[168:171], a[172:175], v[104:107]
    v_mfma_f32_16x16x32_bf16 v[12:15], v[172:175], a[160:163], v[12:15]
    ds_read_b64_tr_b16 v[168:169], v225 offset:24576
    v_mfma_f32_16x16x32_bf16 v[44:47], v[172:175], a[164:167], v[44:47]
    ds_read_b64_tr_b16 v[170:171], v225 offset:25600
    v_mfma_f32_16x16x32_bf16 v[76:79], v[172:175], a[168:171], v[76:79]
    buffer_load_dwordx4 a[220:223], v231, s[8:11], s53 offen offset:2048 sc1
    v_mfma_f32_16x16x32_bf16 v[108:111], v[172:175], a[172:175], v[108:111]
    s_waitcnt lgkmcnt(14)
    v_mfma_f32_16x16x32_bf16 v[16:19], v[176:179], a[160:163], v[16:19]
    ds_read_b64_tr_b16 v[172:173], v225 offset:24584
    v_mfma_f32_16x16x32_bf16 v[48:51], v[176:179], a[164:167], v[48:51]
    ds_read_b64_tr_b16 v[174:175], v225 offset:25608
    v_mfma_f32_16x16x32_bf16 v[80:83], v[176:179], a[168:171], v[80:83]
    s_add_u32 s52, s52, 4096
    buffer_load_dwordx4 a[224:227], v230, s[8:11], s52 offen offset:0 sc1
    v_mfma_f32_16x16x32_bf16 v[112:115], v[176:179], a[172:175], v[112:115]
    v_mfma_f32_16x16x32_bf16 v[20:23], v[180:183], a[160:163], v[20:23]
    ds_read_b64_tr_b16 v[176:177], v226 offset:24576
    v_mfma_f32_16x16x32_bf16 v[52:55], v[180:183], a[164:167], v[52:55]
    ds_read_b64_tr_b16 v[178:179], v226 offset:25600
    v_mfma_f32_16x16x32_bf16 v[84:87], v[180:183], a[168:171], v[84:87]
    v_mfma_f32_16x16x32_bf16 v[116:119], v[180:183], a[172:175], v[116:119]
    buffer_load_dwordx4 a[228:231], v231, s[8:11], s52 offen offset:0 sc1
    v_mfma_f32_16x16x32_bf16 v[24:27], v[184:187], a[160:163], v[24:27]
    ds_read_b64_tr_b16 v[180:181], v226 offset:24584
    v_mfma_f32_16x16x32_bf16 v[56:59], v[184:187], a[164:167], v[56:59]
    ds_read_b64_tr_b16 v[182:183], v226 offset:25608
    v_mfma_f32_16x16x32_bf16 v[88:91], v[184:187], a[168:171], v[88:91]
    v_mfma_f32_16x16x32_bf16 v[120:123], v[184:187], a[172:175], v[120:123]
    v_mfma_f32_16x16x32_bf16 v[28:31], v[188:191], a[160:163], v[28:31]
    ds_read_b64_tr_b16 v[184:185], v227 offset:24576
    v_mfma_f32_16x16x32_bf16 v[60:63], v[188:191], a[164:167], v[60:63]
    ds_read_b64_tr_b16 v[186:187], v227 offset:25600
    v_mfma_f32_16x16x32_bf16 v[92:95], v[188:191], a[168:171], v[92:95]
    s_add_u32 s53, s53, 4096
    buffer_load_dwordx4 a[232:235], v230, s[8:11], s53 offen offset:0 sc1
    v_mfma_f32_16x16x32_bf16 v[124:127], v[188:191], a[172:175], v[124:127]
    s_waitcnt lgkmcnt(14)
    v_mfma_f32_16x16x32_bf16 v[128:131], v[192:195], a[160:163], v[128:131]
    ds_read_b64_tr_b16 v[188:189], v227 offset:24584
    v_mfma_f32_16x16x32_bf16 v[136:139], v[192:195], a[164:167], v[136:139]
    ds_read_b64_tr_b16 v[190:191], v227 offset:25608
    v_mfma_f32_16x16x32_bf16 v[144:147], v[192:195], a[168:171], v[144:147]
    buffer_load_dwordx4 a[236:239], v231, s[8:11], s53 offen offset:0 sc1
    v_mfma_f32_16x16x32_bf16 v[152:155], v[192:195], a[172:175], v[152:155]
    v_mfma_f32_16x16x32_bf16 v[132:135], v[196:199], a[160:163], v[132:135]
    ds_read_b64_tr_b16 v[192:193], v228 offset:12288
    v_mfma_f32_16x16x32_bf16 v[140:143], v[196:199], a[164:167], v[140:143]
    ds_read_b64_tr_b16 v[194:195], v228 offset:12544
    v_mfma_f32_16x16x32_bf16 v[148:151], v[196:199], a[168:171], v[148:151]
    buffer_load_dwordx4 a[240:243], v230, s[8:11], s52 offen offset:2048 sc1
    v_mfma_f32_16x16x32_bf16 v[156:159], v[196:199], a[172:175], v[156:159]
    v_mfma_f32_16x16x32_bf16 v[208:211], v[200:203], a[160:163], v[208:211]
    ds_read_b64_tr_b16 v[196:197], v229 offset:12288
    v_mfma_f32_16x16x32_bf16 v[216:219], v[200:203], a[164:167], v[216:219]
    ds_read_b64_tr_b16 v[198:199], v229 offset:12544
    v_mfma_f32_16x16x32_bf16 v[212:215], v[204:207], a[160:163], v[212:215]
    ds_read_b64_tr_b16 v[200:201], v228 offset:13312
    v_mfma_f32_16x16x32_bf16 v[220:223], v[204:207], a[164:167], v[220:223]
    s_waitcnt vmcnt(19) lgkmcnt(13)
    s_barrier
    ds_read_b64_tr_b16 v[202:203], v228 offset:13568
    v_mfma_f32_16x16x32_bf16 v[0:3], v[160:163], a[176:179], v[0:3]
    ds_read_b64_tr_b16 v[204:205], v229 offset:13312
    v_mfma_f32_16x16x32_bf16 v[32:35], v[160:163], a[180:183], v[32:35]
    ds_read_b64_tr_b16 v[206:207], v229 offset:13568
    v_mfma_f32_16x16x32_bf16 v[64:67], v[160:163], a[184:187], v[64:67]
    s_and_b32 s82, s5, 3
    buffer_load_dwordx4 a[244:247], v231, s[8:11], s52 offen offset:2048 sc1
    v_mfma_f32_16x16x32_bf16 v[96:99], v[160:163], a[188:191], v[96:99]
    s_lshl_b32 s82, s82, 2
    v_mfma_f32_16x16x32_bf16 v[4:7], v[164:167], a[176:179], v[4:7]
    s_add_u32 s82, s82, s3
    ds_read_b64_tr_b16 v[160:161], v224 offset:32768
    v_mfma_f32_16x16x32_bf16 v[36:39], v[164:167], a[180:183], v[36:39]
    s_mul_i32 s82, s82, 3072
    ds_read_b64_tr_b16 v[162:163], v224 offset:33792
    v_mfma_f32_16x16x32_bf16 v[68:71], v[164:167], a[184:187], v[68:71]
    s_add_u32 s82, s82, 16384
    buffer_load_dwordx4 a[248:251], v230, s[8:11], s53 offen offset:2048 sc1
    v_mfma_f32_16x16x32_bf16 v[100:103], v[164:167], a[188:191], v[100:103]
    v_min_u32 v249, 368, v242
    v_mfma_f32_16x16x32_bf16 v[8:11], v[168:171], a[176:179], v[8:11]
    ds_read_b64_tr_b16 v[164:165], v224 offset:32776
    v_lshlrev_b32 v249, 3, v249
    v_mfma_f32_16x16x32_bf16 v[40:43], v[168:171], a[180:183], v[40:43]
    ds_read_b64_tr_b16 v[166:167], v224 offset:33800
    v_min_u32 v248, 672, v242
    v_mfma_f32_16x16x32_bf16 v[72:75], v[168:171], a[184:187], v[72:75]
    buffer_load_dwordx4 a[252:255], v231, s[8:11], s53 offen offset:2048 sc1
    v_lshlrev_b32 v248, 6, v248
    v_mfma_f32_16x16x32_bf16 v[104:107], v[168:171], a[188:191], v[104:107]
    s_and_b32 s83, s76, 7
    v_mfma_f32_16x16x32_bf16 v[12:15], v[172:175], a[176:179], v[12:15]
    s_lshl_b32 s83, s83, 2
    ds_read_b64_tr_b16 v[168:169], v225 offset:32768
    v_mfma_f32_16x16x32_bf16 v[44:47], v[172:175], a[180:183], v[44:47]
    s_add_u32 s83, s83, s3
    ds_read_b64_tr_b16 v[170:171], v225 offset:33792
    v_mfma_f32_16x16x32_bf16 v[76:79], v[172:175], a[184:187], v[76:79]
    s_add_u32 m0, s57, 98304
    s_mov_b32 s56, 0
    s_mul_i32 s83, s83, 44032
    buffer_load_dwordx4 v236, s[20:23], s56 offen offset:0 lds
    v_mfma_f32_16x16x32_bf16 v[108:111], v[172:175], a[188:191], v[108:111]
    s_waitcnt lgkmcnt(14)
    v_mov_b32 v247, 0
    v_mfma_f32_16x16x32_bf16 v[16:19], v[176:179], a[176:179], v[16:19]
    ds_read_b64_tr_b16 v[172:173], v225 offset:32776
    v_mfma_f32_16x16x32_bf16 v[48:51], v[176:179], a[180:183], v[48:51]
    ds_read_b64_tr_b16 v[174:175], v225 offset:33800
    v_mfma_f32_16x16x32_bf16 v[80:83], v[176:179], a[184:187], v[80:83]
    v_mfma_f32_16x16x32_bf16 v[112:115], v[176:179], a[188:191], v[112:115]
    buffer_load_dwordx4 v237, s[20:23], s56 offen offset:1024 lds
    v_mfma_f32_16x16x32_bf16 v[20:23], v[180:183], a[176:179], v[20:23]
    ds_read_b64_tr_b16 v[176:177], v226 offset:32768
    v_mfma_f32_16x16x32_bf16 v[52:55], v[180:183], a[180:183], v[52:55]
    ds_read_b64_tr_b16 v[178:179], v226 offset:33792
    v_mfma_f32_16x16x32_bf16 v[84:87], v[180:183], a[184:187], v[84:87]
    v_mfma_f32_16x16x32_bf16 v[116:119], v[180:183], a[188:191], v[116:119]
    v_mfma_f32_16x16x32_bf16 v[24:27], v[184:187], a[176:179], v[24:27]
    ds_read_b64_tr_b16 v[180:181], v226 offset:32776
    v_mfma_f32_16x16x32_bf16 v[56:59], v[184:187], a[180:183], v[56:59]
    ds_read_b64_tr_b16 v[182:183], v226 offset:33800
    v_mfma_f32_16x16x32_bf16 v[88:91], v[184:187], a[184:187], v[88:91]
    buffer_load_dwordx4 v238, s[20:23], s56 offen offset:2048 lds
    v_mfma_f32_16x16x32_bf16 v[120:123], v[184:187], a[188:191], v[120:123]
    v_mfma_f32_16x16x32_bf16 v[28:31], v[188:191], a[176:179], v[28:31]
    ds_read_b64_tr_b16 v[184:185], v227 offset:32768
    v_mfma_f32_16x16x32_bf16 v[60:63], v[188:191], a[180:183], v[60:63]
    ds_read_b64_tr_b16 v[186:187], v227 offset:33792
    v_mfma_f32_16x16x32_bf16 v[92:95], v[188:191], a[184:187], v[92:95]
    buffer_load_dwordx4 v239, s[20:23], s56 offen offset:3072 lds
    v_mfma_f32_16x16x32_bf16 v[124:127], v[188:191], a[188:191], v[124:127]
    s_waitcnt lgkmcnt(14)
    v_mfma_f32_16x16x32_bf16 v[128:131], v[192:195], a[176:179], v[128:131]
    ds_read_b64_tr_b16 v[188:189], v227 offset:32776
    v_mfma_f32_16x16x32_bf16 v[136:139], v[192:195], a[180:183], v[136:139]
    ds_read_b64_tr_b16 v[190:191], v227 offset:33800
    v_mfma_f32_16x16x32_bf16 v[144:147], v[192:195], a[184:187], v[144:147]
    s_add_u32 m0, s57, 0
    s_mov_b32 s56, 0
    buffer_load_dwordx4 v240, s[24:27], s56 offen offset:0 lds
    v_mfma_f32_16x16x32_bf16 v[152:155], v[192:195], a[188:191], v[152:155]
    v_mfma_f32_16x16x32_bf16 v[132:135], v[196:199], a[176:179], v[132:135]
    ds_read_b64_tr_b16 v[192:193], v228 offset:16384
    v_mfma_f32_16x16x32_bf16 v[140:143], v[196:199], a[180:183], v[140:143]
    ds_read_b64_tr_b16 v[194:195], v228 offset:16640
    v_mfma_f32_16x16x32_bf16 v[148:151], v[196:199], a[184:187], v[148:151]
    v_mfma_f32_16x16x32_bf16 v[156:159], v[196:199], a[188:191], v[156:159]
    buffer_load_dwordx4 v241, s[24:27], s56 offen offset:1024 lds
    v_mfma_f32_16x16x32_bf16 v[208:211], v[200:203], a[176:179], v[208:211]
    ds_read_b64_tr_b16 v[196:197], v229 offset:16384
    v_mfma_f32_16x16x32_bf16 v[216:219], v[200:203], a[180:183], v[216:219]
    ds_read_b64_tr_b16 v[198:199], v229 offset:16640
    v_mfma_f32_16x16x32_bf16 v[212:215], v[204:207], a[176:179], v[212:215]
    ds_read_b64_tr_b16 v[200:201], v228 offset:17408
    v_mfma_f32_16x16x32_bf16 v[220:223], v[204:207], a[180:183], v[220:223]
    s_waitcnt vmcnt(24) lgkmcnt(13)
    ds_read_b64_tr_b16 v[202:203], v228 offset:17664
    v_mfma_f32_16x16x32_bf16 v[0:3], v[160:163], a[192:195], v[0:3]
    ds_read_b64_tr_b16 v[204:205], v229 offset:17408
    v_mfma_f32_16x16x32_bf16 v[32:35], v[160:163], a[196:199], v[32:35]
    ds_read_b64_tr_b16 v[206:207], v229 offset:17664
    v_mfma_f32_16x16x32_bf16 v[64:67], v[160:163], a[200:203], v[64:67]
    buffer_load_dwordx4 v240, s[24:27], s56 offen offset:2048 lds
    v_mfma_f32_16x16x32_bf16 v[96:99], v[160:163], a[204:207], v[96:99]
    v_mfma_f32_16x16x32_bf16 v[4:7], v[164:167], a[192:195], v[4:7]
    ds_read_b64_tr_b16 v[160:161], v224 offset:40960
    v_mfma_f32_16x16x32_bf16 v[36:39], v[164:167], a[196:199], v[36:39]
    ds_read_b64_tr_b16 v[162:163], v224 offset:41984
    v_mfma_f32_16x16x32_bf16 v[68:71], v[164:167], a[200:203], v[68:71]
    buffer_load_dwordx4 v241, s[24:27], s56 offen offset:3072 lds
    v_mfma_f32_16x16x32_bf16 v[100:103], v[164:167], a[204:207], v[100:103]
    v_mfma_f32_16x16x32_bf16 v[8:11], v[168:171], a[192:195], v[8:11]
    ds_read_b64_tr_b16 v[164:165], v224 offset:40968
    v_mfma_f32_16x16x32_bf16 v[40:43], v[168:171], a[196:199], v[40:43]
    ds_read_b64_tr_b16 v[166:167], v224 offset:41992
    v_mfma_f32_16x16x32_bf16 v[72:75], v[168:171], a[200:203], v[72:75]
    buffer_load_dword a136, v249, s[20:23], s82 offen
    v_mfma_f32_16x16x32_bf16 v[104:107], v[168:171], a[204:207], v[104:107]
    v_mfma_f32_16x16x32_bf16 v[12:15], v[172:175], a[192:195], v[12:15]
    ds_read_b64_tr_b16 v[168:169], v225 offset:40960
    v_mfma_f32_16x16x32_bf16 v[44:47], v[172:175], a[196:199], v[44:47]
    ds_read_b64_tr_b16 v[170:171], v225 offset:41984
    v_mfma_f32_16x16x32_bf16 v[76:79], v[172:175], a[200:203], v[76:79]
    v_mfma_f32_16x16x32_bf16 v[108:111], v[172:175], a[204:207], v[108:111]
    s_waitcnt lgkmcnt(14)
    buffer_load_dword a137, v249, s[24:27], s82 offen
    v_mfma_f32_16x16x32_bf16 v[16:19], v[176:179], a[192:195], v[16:19]
    ds_read_b64_tr_b16 v[172:173], v225 offset:40968
    v_mfma_f32_16x16x32_bf16 v[48:51], v[176:179], a[196:199], v[48:51]
    ds_read_b64_tr_b16 v[174:175], v225 offset:41992
    v_mfma_f32_16x16x32_bf16 v[80:83], v[176:179], a[200:203], v[80:83]
    v_mfma_f32_16x16x32_bf16 v[112:115], v[176:179], a[204:207], v[112:115]
    v_mfma_f32_16x16x32_bf16 v[20:23], v[180:183], a[192:195], v[20:23]
    ds_read_b64_tr_b16 v[176:177], v226 offset:40960
    v_mfma_f32_16x16x32_bf16 v[52:55], v[180:183], a[196:199], v[52:55]
    ds_read_b64_tr_b16 v[178:179], v226 offset:41984
    v_mfma_f32_16x16x32_bf16 v[84:87], v[180:183], a[200:203], v[84:87]
    buffer_load_dword a138, v248, s[32:35], s83 offen
    v_mfma_f32_16x16x32_bf16 v[116:119], v[180:183], a[204:207], v[116:119]
    v_mfma_f32_16x16x32_bf16 v[24:27], v[184:187], a[192:195], v[24:27]
    ds_read_b64_tr_b16 v[180:181], v226 offset:40968
    v_mfma_f32_16x16x32_bf16 v[56:59], v[184:187], a[196:199], v[56:59]
    ds_read_b64_tr_b16 v[182:183], v226 offset:41992
    v_mfma_f32_16x16x32_bf16 v[88:91], v[184:187], a[200:203], v[88:91]
    buffer_load_dword a139, v247, s[48:51], 0 offen
    v_mfma_f32_16x16x32_bf16 v[120:123], v[184:187], a[204:207], v[120:123]
    v_mfma_f32_16x16x32_bf16 v[28:31], v[188:191], a[192:195], v[28:31]
    ds_read_b64_tr_b16 v[184:185], v227 offset:40960
    v_mfma_f32_16x16x32_bf16 v[60:63], v[188:191], a[196:199], v[60:63]
    ds_read_b64_tr_b16 v[186:187], v227 offset:41984
    v_mfma_f32_16x16x32_bf16 v[92:95], v[188:191], a[200:203], v[92:95]
    v_mfma_f32_16x16x32_bf16 v[124:127], v[188:191], a[204:207], v[124:127]
    s_waitcnt lgkmcnt(14)
    v_mfma_f32_16x16x32_bf16 v[128:131], v[192:195], a[192:195], v[128:131]
    ds_read_b64_tr_b16 v[188:189], v227 offset:40968
    v_mfma_f32_16x16x32_bf16 v[136:139], v[192:195], a[196:199], v[136:139]
    ds_read_b64_tr_b16 v[190:191], v227 offset:41992
    v_mfma_f32_16x16x32_bf16 v[144:147], v[192:195], a[200:203], v[144:147]
    v_mfma_f32_16x16x32_bf16 v[152:155], v[192:195], a[204:207], v[152:155]
    v_mfma_f32_16x16x32_bf16 v[132:135], v[196:199], a[192:195], v[132:135]
    ds_read_b64_tr_b16 v[192:193], v228 offset:20480
    v_mfma_f32_16x16x32_bf16 v[140:143], v[196:199], a[196:199], v[140:143]
    ds_read_b64_tr_b16 v[194:195], v228 offset:20736
    v_mfma_f32_16x16x32_bf16 v[148:151], v[196:199], a[200:203], v[148:151]
    v_mfma_f32_16x16x32_bf16 v[156:159], v[196:199], a[204:207], v[156:159]
    v_mfma_f32_16x16x32_bf16 v[208:211], v[200:203], a[192:195], v[208:211]
    ds_read_b64_tr_b16 v[196:197], v229 offset:20480
    v_mfma_f32_16x16x32_bf16 v[216:219], v[200:203], a[196:199], v[216:219]
    ds_read_b64_tr_b16 v[198:199], v229 offset:20736
    v_mfma_f32_16x16x32_bf16 v[212:215], v[204:207], a[192:195], v[212:215]
    ds_read_b64_tr_b16 v[200:201], v228 offset:21504
    v_mfma_f32_16x16x32_bf16 v[220:223], v[204:207], a[196:199], v[220:223]
    s_waitcnt vmcnt(20) lgkmcnt(13)
    s_barrier
    ds_read_b64_tr_b16 v[202:203], v228 offset:21760
    v_mfma_f32_16x16x32_bf16 v[0:3], v[160:163], a[208:211], v[0:3]
    ds_read_b64_tr_b16 v[204:205], v229 offset:21504
    v_mfma_f32_16x16x32_bf16 v[32:35], v[160:163], a[212:215], v[32:35]
    ds_read_b64_tr_b16 v[206:207], v229 offset:21760
    v_mfma_f32_16x16x32_bf16 v[64:67], v[160:163], a[216:219], v[64:67]
    v_mfma_f32_16x16x32_bf16 v[96:99], v[160:163], a[220:223], v[96:99]
    v_mfma_f32_16x16x32_bf16 v[4:7], v[164:167], a[208:211], v[4:7]
    ds_read_b64_tr_b16 v[160:161], v224 offset:49152
    v_mfma_f32_16x16x32_bf16 v[36:39], v[164:167], a[212:215], v[36:39]
    ds_read_b64_tr_b16 v[162:163], v224 offset:50176
    v_mfma_f32_16x16x32_bf16 v[68:71], v[164:167], a[216:219], v[68:71]
    v_mfma_f32_16x16x32_bf16 v[100:103], v[164:167], a[220:223], v[100:103]
    v_mfma_f32_16x16x32_bf16 v[8:11], v[168:171], a[208:211], v[8:11]
    ds_read_b64_tr_b16 v[164:165], v224 offset:49160
    v_mfma_f32_16x16x32_bf16 v[40:43], v[168:171], a[212:215], v[40:43]
    ds_read_b64_tr_b16 v[166:167], v224 offset:50184
    v_mfma_f32_16x16x32_bf16 v[72:75], v[168:171], a[216:219], v[72:75]
    v_mfma_f32_16x16x32_bf16 v[104:107], v[168:171], a[220:223], v[104:107]
    v_mfma_f32_16x16x32_bf16 v[12:15], v[172:175], a[208:211], v[12:15]
    ds_read_b64_tr_b16 v[168:169], v225 offset:49152
    v_mfma_f32_16x16x32_bf16 v[44:47], v[172:175], a[212:215], v[44:47]
    ds_read_b64_tr_b16 v[170:171], v225 offset:50176
    v_mfma_f32_16x16x32_bf16 v[76:79], v[172:175], a[216:219], v[76:79]
    v_mfma_f32_16x16x32_bf16 v[108:111], v[172:175], a[220:223], v[108:111]
    s_waitcnt lgkmcnt(14)
    v_mfma_f32_16x16x32_bf16 v[16:19], v[176:179], a[208:211], v[16:19]
    ds_read_b64_tr_b16 v[172:173], v225 offset:49160
    v_mfma_f32_16x16x32_bf16 v[48:51], v[176:179], a[212:215], v[48:51]
    ds_read_b64_tr_b16 v[174:175], v225 offset:50184
    v_mfma_f32_16x16x32_bf16 v[80:83], v[176:179], a[216:219], v[80:83]
    v_mfma_f32_16x16x32_bf16 v[112:115], v[176:179], a[220:223], v[112:115]
    v_mfma_f32_16x16x32_bf16 v[20:23], v[180:183], a[208:211], v[20:23]
    ds_read_b64_tr_b16 v[176:177], v226 offset:49152
    v_mfma_f32_16x16x32_bf16 v[52:55], v[180:183], a[212:215], v[52:55]
    ds_read_b64_tr_b16 v[178:179], v226 offset:50176
    v_mfma_f32_16x16x32_bf16 v[84:87], v[180:183], a[216:219], v[84:87]
    v_mfma_f32_16x16x32_bf16 v[116:119], v[180:183], a[220:223], v[116:119]
    v_mfma_f32_16x16x32_bf16 v[24:27], v[184:187], a[208:211], v[24:27]
    ds_read_b64_tr_b16 v[180:181], v226 offset:49160
    v_mfma_f32_16x16x32_bf16 v[56:59], v[184:187], a[212:215], v[56:59]
    ds_read_b64_tr_b16 v[182:183], v226 offset:50184
    v_mfma_f32_16x16x32_bf16 v[88:91], v[184:187], a[216:219], v[88:91]
    v_mfma_f32_16x16x32_bf16 v[120:123], v[184:187], a[220:223], v[120:123]
    v_mfma_f32_16x16x32_bf16 v[28:31], v[188:191], a[208:211], v[28:31]
    ds_read_b64_tr_b16 v[184:185], v227 offset:49152
    v_mfma_f32_16x16x32_bf16 v[60:63], v[188:191], a[212:215], v[60:63]
    ds_read_b64_tr_b16 v[186:187], v227 offset:50176
    v_mfma_f32_16x16x32_bf16 v[92:95], v[188:191], a[216:219], v[92:95]
    v_mfma_f32_16x16x32_bf16 v[124:127], v[188:191], a[220:223], v[124:127]
    s_waitcnt lgkmcnt(14)
    v_mfma_f32_16x16x32_bf16 v[128:131], v[192:195], a[208:211], v[128:131]
    ds_read_b64_tr_b16 v[188:189], v227 offset:49160
    v_mfma_f32_16x16x32_bf16 v[136:139], v[192:195], a[212:215], v[136:139]
    ds_read_b64_tr_b16 v[190:191], v227 offset:50184
    v_mfma_f32_16x16x32_bf16 v[144:147], v[192:195], a[216:219], v[144:147]
    v_mfma_f32_16x16x32_bf16 v[152:155], v[192:195], a[220:223], v[152:155]
    v_mfma_f32_16x16x32_bf16 v[132:135], v[196:199], a[208:211], v[132:135]
    ds_read_b64_tr_b16 v[192:193], v228 offset:24576
    v_mfma_f32_16x16x32_bf16 v[140:143], v[196:199], a[212:215], v[140:143]
    ds_read_b64_tr_b16 v[194:195], v228 offset:24832
    v_mfma_f32_16x16x32_bf16 v[148:151], v[196:199], a[216:219], v[148:151]
    v_mfma_f32_16x16x32_bf16 v[156:159], v[196:199], a[220:223], v[156:159]
    v_mfma_f32_16x16x32_bf16 v[208:211], v[200:203], a[208:211], v[208:211]
    ds_read_b64_tr_b16 v[196:197], v229 offset:24576
    v_mfma_f32_16x16x32_bf16 v[216:219], v[200:203], a[212:215], v[216:219]
    ds_read_b64_tr_b16 v[198:199], v229 offset:24832
    v_mfma_f32_16x16x32_bf16 v[212:215], v[204:207], a[208:211], v[212:215]
    ds_read_b64_tr_b16 v[200:201], v228 offset:25600
    v_mfma_f32_16x16x32_bf16 v[220:223], v[204:207], a[212:215], v[220:223]
    s_waitcnt vmcnt(16) lgkmcnt(13)
    ds_read_b64_tr_b16 v[202:203], v228 offset:25856
    v_mfma_f32_16x16x32_bf16 v[0:3], v[160:163], a[224:227], v[0:3]
    ds_read_b64_tr_b16 v[204:205], v229 offset:25600
    v_mfma_f32_16x16x32_bf16 v[32:35], v[160:163], a[228:231], v[32:35]
    ds_read_b64_tr_b16 v[206:207], v229 offset:25856
    v_mfma_f32_16x16x32_bf16 v[64:67], v[160:163], a[232:235], v[64:67]
    v_mfma_f32_16x16x32_bf16 v[96:99], v[160:163], a[236:239], v[96:99]
    v_mfma_f32_16x16x32_bf16 v[4:7], v[164:167], a[224:227], v[4:7]
    ds_read_b64_tr_b16 v[160:161], v224 offset:57344
    v_mfma_f32_16x16x32_bf16 v[36:39], v[164:167], a[228:231], v[36:39]
    ds_read_b64_tr_b16 v[162:163], v224 offset:58368
    v_mfma_f32_16x16x32_bf16 v[68:71], v[164:167], a[232:235], v[68:71]
    v_mfma_f32_16x16x32_bf16 v[100:103], v[164:167], a[236:239], v[100:103]
    v_mfma_f32_16x16x32_bf16 v[8:11], v[168:171], a[224:227], v[8:11]
    ds_read_b64_tr_b16 v[164:165], v224 offset:57352
    v_mfma_f32_16x16x32_bf16 v[40:43], v[168:171], a[228:231], v[40:43]
    ds_read_b64_tr_b16 v[166:167], v224 offset:58376
    v_mfma_f32_16x16x32_bf16 v[72:75], v[168:171], a[232:235], v[72:75]
    v_mfma_f32_16x16x32_bf16 v[104:107], v[168:171], a[236:239], v[104:107]
    v_mfma_f32_16x16x32_bf16 v[12:15], v[172:175], a[224:227], v[12:15]
    ds_read_b64_tr_b16 v[168:169], v225 offset:57344
    v_mfma_f32_16x16x32_bf16 v[44:47], v[172:175], a[228:231], v[44:47]
    ds_read_b64_tr_b16 v[170:171], v225 offset:58368
    v_mfma_f32_16x16x32_bf16 v[76:79], v[172:175], a[232:235], v[76:79]
    v_mfma_f32_16x16x32_bf16 v[108:111], v[172:175], a[236:239], v[108:111]
    s_waitcnt lgkmcnt(14)
    v_mfma_f32_16x16x32_bf16 v[16:19], v[176:179], a[224:227], v[16:19]
    ds_read_b64_tr_b16 v[172:173], v225 offset:57352
    v_mfma_f32_16x16x32_bf16 v[48:51], v[176:179], a[228:231], v[48:51]
    ds_read_b64_tr_b16 v[174:175], v225 offset:58376
    v_mfma_f32_16x16x32_bf16 v[80:83], v[176:179], a[232:235], v[80:83]
    v_mfma_f32_16x16x32_bf16 v[112:115], v[176:179], a[236:239], v[112:115]
    v_mfma_f32_16x16x32_bf16 v[20:23], v[180:183], a[224:227], v[20:23]
    ds_read_b64_tr_b16 v[176:177], v226 offset:57344
    v_mfma_f32_16x16x32_bf16 v[52:55], v[180:183], a[228:231], v[52:55]
    ds_read_b64_tr_b16 v[178:179], v226 offset:58368
    v_mfma_f32_16x16x32_bf16 v[84:87], v[180:183], a[232:235], v[84:87]
    v_mfma_f32_16x16x32_bf16 v[116:119], v[180:183], a[236:239], v[116:119]
    v_mfma_f32_16x16x32_bf16 v[24:27], v[184:187], a[224:227], v[24:27]
    ds_read_b64_tr_b16 v[180:181], v226 offset:57352
    v_mfma_f32_16x16x32_bf16 v[56:59], v[184:187], a[228:231], v[56:59]
    ds_read_b64_tr_b16 v[182:183], v226 offset:58376
    v_mfma_f32_16x16x32_bf16 v[88:91], v[184:187], a[232:235], v[88:91]
    v_mfma_f32_16x16x32_bf16 v[120:123], v[184:187], a[236:239], v[120:123]
    v_mfma_f32_16x16x32_bf16 v[28:31], v[188:191], a[224:227], v[28:31]
    ds_read_b64_tr_b16 v[184:185], v227 offset:57344
    v_mfma_f32_16x16x32_bf16 v[60:63], v[188:191], a[228:231], v[60:63]
    ds_read_b64_tr_b16 v[186:187], v227 offset:58368
    v_mfma_f32_16x16x32_bf16 v[92:95], v[188:191], a[232:235], v[92:95]
    v_mfma_f32_16x16x32_bf16 v[124:127], v[188:191], a[236:239], v[124:127]
    s_waitcnt lgkmcnt(14)
    v_mfma_f32_16x16x32_bf16 v[128:131], v[192:195], a[224:227], v[128:131]
    ds_read_b64_tr_b16 v[188:189], v227 offset:57352
    v_mfma_f32_16x16x32_bf16 v[136:139], v[192:195], a[228:231], v[136:139]
    ds_read_b64_tr_b16 v[190:191], v227 offset:58376
    v_mfma_f32_16x16x32_bf16 v[144:147], v[192:195], a[232:235], v[144:147]
    v_mfma_f32_16x16x32_bf16 v[152:155], v[192:195], a[236:239], v[152:155]
    v_mfma_f32_16x16x32_bf16 v[132:135], v[196:199], a[224:227], v[132:135]
    ds_read_b64_tr_b16 v[192:193], v228 offset:28672
    v_mfma_f32_16x16x32_bf16 v[140:143], v[196:199], a[228:231], v[140:143]
    ds_read_b64_tr_b16 v[194:195], v228 offset:28928
    v_mfma_f32_16x16x32_bf16 v[148:151], v[196:199], a[232:235], v[148:151]
    v_mfma_f32_16x16x32_bf16 v[156:159], v[196:199], a[236:239], v[156:159]
    v_mfma_f32_16x16x32_bf16 v[208:211], v[200:203], a[224:227], v[208:211]
    ds_read_b64_tr_b16 v[196:197], v229 offset:28672
    v_mfma_f32_16x16x32_bf16 v[216:219], v[200:203], a[228:231], v[216:219]
    ds_read_b64_tr_b16 v[198:199], v229 offset:28928
    v_mfma_f32_16x16x32_bf16 v[212:215], v[204:207], a[224:227], v[212:215]
    ds_read_b64_tr_b16 v[200:201], v228 offset:29696
    v_mfma_f32_16x16x32_bf16 v[220:223], v[204:207], a[228:231], v[220:223]
    s_waitcnt vmcnt(4) lgkmcnt(13)
    s_barrier
    ds_read_b64_tr_b16 v[202:203], v228 offset:29952
    v_mfma_f32_16x16x32_bf16 v[0:3], v[160:163], a[240:243], v[0:3]
    ds_read_b64_tr_b16 v[204:205], v229 offset:29696
    v_mfma_f32_16x16x32_bf16 v[32:35], v[160:163], a[244:247], v[32:35]
    ds_read_b64_tr_b16 v[206:207], v229 offset:29952
    v_mfma_f32_16x16x32_bf16 v[64:67], v[160:163], a[248:251], v[64:67]
    ds_read_b128 a[64:67], v232 offset:0
    v_mfma_f32_16x16x32_bf16 v[96:99], v[160:163], a[252:255], v[96:99]
    ds_read_b128 a[68:71], v233 offset:0
    v_mfma_f32_16x16x32_bf16 v[4:7], v[164:167], a[240:243], v[4:7]
    ds_read_b128 a[72:75], v234 offset:0
    v_mfma_f32_16x16x32_bf16 v[36:39], v[164:167], a[244:247], v[36:39]
    ds_read_b128 a[76:79], v235 offset:0
    v_mfma_f32_16x16x32_bf16 v[68:71], v[164:167], a[248:251], v[68:71]
    ds_read_b128 a[80:83], v232 offset:4096
    v_mfma_f32_16x16x32_bf16 v[100:103], v[164:167], a[252:255], v[100:103]
    ds_read_b128 a[84:87], v233 offset:4096
    v_mfma_f32_16x16x32_bf16 v[8:11], v[168:171], a[240:243], v[8:11]
    ds_read_b128 a[88:91], v234 offset:4096
    v_mfma_f32_16x16x32_bf16 v[40:43], v[168:171], a[244:247], v[40:43]
    ds_read_b128 a[92:95], v235 offset:4096
    v_mfma_f32_16x16x32_bf16 v[72:75], v[168:171], a[248:251], v[72:75]
    s_add_u32 m0, s57, 114688
    s_mov_b32 s56, 16384
    buffer_load_dwordx4 v236, s[20:23], s56 offen offset:0 lds
    v_mfma_f32_16x16x32_bf16 v[104:107], v[168:171], a[252:255], v[104:107]
    v_cvt_pk_bf16_f32 v247, v0, v1
    v_cvt_pk_bf16_f32 v248, v2, v3
    v_accvgpr_write_b32 a0, v247
    v_mfma_f32_16x16x32_bf16 v[12:15], v[172:175], a[240:243], v[12:15]
    v_accvgpr_write_b32 a1, v248
    v_cvt_pk_bf16_f32 v247, v4, v5
    v_cvt_pk_bf16_f32 v248, v6, v7
    v_mfma_f32_16x16x32_bf16 v[44:47], v[172:175], a[244:247], v[44:47]
    v_accvgpr_write_b32 a2, v247
    v_accvgpr_write_b32 a3, v248
    v_cvt_pk_bf16_f32 v247, v32, v33
    v_mfma_f32_16x16x32_bf16 v[76:79], v[172:175], a[248:251], v[76:79]
    buffer_load_dwordx4 v237, s[20:23], s56 offen offset:1024 lds
    v_cvt_pk_bf16_f32 v248, v34, v35
    v_mfma_f32_16x16x32_bf16 v[108:111], v[172:175], a[252:255], v[108:111]
    s_waitcnt lgkmcnt(15)
    v_accvgpr_write_b32 a16, v247
    v_accvgpr_write_b32 a17, v248
    v_cvt_pk_bf16_f32 v247, v36, v37
    v_mfma_f32_16x16x32_bf16 v[16:19], v[176:179], a[240:243], v[16:19]
    v_cvt_pk_bf16_f32 v248, v38, v39
    v_accvgpr_write_b32 a18, v247
    v_accvgpr_write_b32 a19, v248
    v_mfma_f32_16x16x32_bf16 v[48:51], v[176:179], a[244:247], v[48:51]
    v_cvt_pk_bf16_f32 v247, v64, v65
    v_cvt_pk_bf16_f32 v248, v66, v67
    v_accvgpr_write_b32 a32, v247
    v_mfma_f32_16x16x32_bf16 v[80:83], v[176:179], a[248:251], v[80:83]
    buffer_load_dwordx4 v238, s[20:23], s56 offen offset:2048 lds
    v_accvgpr_write_b32 a33, v248
    v_mfma_f32_16x16x32_bf16 v[112:115], v[176:179], a[252:255], v[112:115]
    v_cvt_pk_bf16_f32 v247, v68, v69
    v_cvt_pk_bf16_f32 v248, v70, v71
    v_accvgpr_write_b32 a34, v247
    v_mfma_f32_16x16x32_bf16 v[20:23], v[180:183], a[240:243], v[20:23]
    v_accvgpr_write_b32 a35, v248
    v_cvt_pk_bf16_f32 v247, v96, v97
    v_cvt_pk_bf16_f32 v248, v98, v99
    v_mfma_f32_16x16x32_bf16 v[52:55], v[180:183], a[244:247], v[52:55]
    v_accvgpr_write_b32 a48, v247
    v_accvgpr_write_b32 a49, v248
    v_cvt_pk_bf16_f32 v247, v100, v101
    v_mfma_f32_16x16x32_bf16 v[84:87], v[180:183], a[248:251], v[84:87]
    buffer_load_dwordx4 v239, s[20:23], s56 offen offset:3072 lds
    v_cvt_pk_bf16_f32 v248, v102, v103
    v_mfma_f32_16x16x32_bf16 v[116:119], v[180:183], a[252:255], v[116:119]
    v_accvgpr_write_b32 a50, v247
    v_accvgpr_write_b32 a51, v248
    v_cvt_pk_bf16_f32 v247, v8, v9
    v_mfma_f32_16x16x32_bf16 v[24:27], v[184:187], a[240:243], v[24:27]
    v_cvt_pk_bf16_f32 v248, v10, v11
    v_accvgpr_write_b32 a4, v247
    v_accvgpr_write_b32 a5, v248
    v_mfma_f32_16x16x32_bf16 v[56:59], v[184:187], a[244:247], v[56:59]
    v_cvt_pk_bf16_f32 v247, v12, v13
    v_cvt_pk_bf16_f32 v248, v14, v15
    v_accvgpr_write_b32 a6, v247
    v_mfma_f32_16x16x32_bf16 v[88:91], v[184:187], a[248:251], v[88:91]
    s_add_u32 m0, s57, 16384
    s_mov_b32 s56, 16384
    buffer_load_dwordx4 v240, s[24:27], s56 offen offset:0 lds
    v_mfma_f32_16x16x32_bf16 v[120:123], v[184:187], a[252:255], v[120:123]
    v_accvgpr_write_b32 a7, v248
    v_cvt_pk_bf16_f32 v247, v40, v41
    v_cvt_pk_bf16_f32 v248, v42, v43
    v_mfma_f32_16x16x32_bf16 v[28:31], v[188:191], a[240:243], v[28:31]
    v_accvgpr_write_b32 a20, v247
    v_accvgpr_write_b32 a21, v248
    v_cvt_pk_bf16_f32 v247, v44, v45
    v_mfma_f32_16x16x32_bf16 v[60:63], v[188:191], a[244:247], v[60:63]
    v_cvt_pk_bf16_f32 v248, v46, v47
    v_accvgpr_write_b32 a22, v247
    v_accvgpr_write_b32 a23, v248
    v_mfma_f32_16x16x32_bf16 v[92:95], v[188:191], a[248:251], v[92:95]
    buffer_load_dwordx4 v241, s[24:27], s56 offen offset:1024 lds
    v_cvt_pk_bf16_f32 v247, v72, v73
    v_mfma_f32_16x16x32_bf16 v[124:127], v[188:191], a[252:255], v[124:127]
    s_waitcnt lgkmcnt(8)
    v_cvt_pk_bf16_f32 v248, v74, v75
    v_accvgpr_write_b32 a36, v247
    v_accvgpr_write_b32 a37, v248
    v_mfma_f32_16x16x32_bf16 v[208:211], v[200:203], a[240:243], v[208:211]
    v_cvt_pk_bf16_f32 v247, v76, v77
    v_cvt_pk_bf16_f32 v248, v78, v79
    v_accvgpr_write_b32 a38, v247
    v_mfma_f32_16x16x32_bf16 v[216:219], v[200:203], a[244:247], v[216:219]
    v_accvgpr_write_b32 a39, v248
    v_cvt_pk_bf16_f32 v247, v104, v105
    v_cvt_pk_bf16_f32 v248, v106, v107
    v_mfma_f32_16x16x32_bf16 v[212:215], v[204:207], a[240:243], v[212:215]
    buffer_load_dwordx4 v240, s[24:27], s56 offen offset:2048 lds
    v_accvgpr_write_b32 a52, v247
    v_mfma_f32_16x16x32_bf16 v[220:223], v[204:207], a[244:247], v[220:223]
    v_accvgpr_write_b32 a53, v248
    v_cvt_pk_bf16_f32 v247, v108, v109
    v_cvt_pk_bf16_f32 v248, v110, v111
    v_mfma_f32_16x16x32_bf16 v[128:131], v[192:195], a[240:243], v[128:131]
    v_accvgpr_write_b32 a54, v247
    v_accvgpr_write_b32 a55, v248
    v_cvt_pk_bf16_f32 v247, v16, v17
    v_mfma_f32_16x16x32_bf16 v[136:139], v[192:195], a[244:247], v[136:139]
    v_cvt_pk_bf16_f32 v248, v18, v19
    v_accvgpr_write_b32 a8, v247
    v_accvgpr_write_b32 a9, v248
    v_mfma_f32_16x16x32_bf16 v[144:147], v[192:195], a[248:251], v[144:147]
    buffer_load_dwordx4 v241, s[24:27], s56 offen offset:3072 lds
    v_cvt_pk_bf16_f32 v247, v20, v21
    v_mfma_f32_16x16x32_bf16 v[152:155], v[192:195], a[252:255], v[152:155]
    v_cvt_pk_bf16_f32 v248, v22, v23
    v_accvgpr_write_b32 a10, v247
    v_accvgpr_write_b32 a11, v248
    v_mfma_f32_16x16x32_bf16 v[132:135], v[196:199], a[240:243], v[132:135]
    v_cvt_pk_bf16_f32 v247, v48, v49
    v_cvt_pk_bf16_f32 v248, v50, v51
    v_accvgpr_write_b32 a24, v247
    v_mfma_f32_16x16x32_bf16 v[140:143], v[196:199], a[244:247], v[140:143]
    v_accvgpr_write_b32 a25, v248
    v_cvt_pk_bf16_f32 v247, v52, v53
    v_cvt_pk_bf16_f32 v248, v54, v55
    v_mfma_f32_16x16x32_bf16 v[148:151], v[196:199], a[248:251], v[148:151]
    s_add_u32 m0, s57, 131072
    s_mov_b32 s56, 32768
    buffer_load_dwordx4 v236, s[20:23], s56 offen offset:0 lds
    v_mfma_f32_16x16x32_bf16 v[156:159], v[196:199], a[252:255], v[156:159]
    s_waitcnt lgkmcnt(0)
    v_accvgpr_write_b32 a26, v247
    v_accvgpr_write_b32 a27, v248
    v_cvt_pk_bf16_f32 v247, v80, v81
    v_mfma_f32_16x16x32_bf16 v[160:163], a[64:67], a[0:3], 0
    v_cvt_pk_bf16_f32 v248, v82, v83
    v_accvgpr_write_b32 a40, v247
    v_accvgpr_write_b32 a41, v248
    v_mfma_f32_16x16x32_bf16 v[160:163], a[68:71], a[4:7], v[160:163]
    v_cvt_pk_bf16_f32 v247, v84, v85
    v_cvt_pk_bf16_f32 v248, v86, v87
    v_accvgpr_write_b32 a42, v247
    v_mfma_f32_16x16x32_bf16 v[160:163], a[72:75], a[8:11], v[160:163]
    buffer_load_dwordx4 v237, s[20:23], s56 offen offset:1024 lds
    v_accvgpr_write_b32 a43, v248
    v_cvt_pk_bf16_f32 v247, v112, v113
    v_cvt_pk_bf16_f32 v248, v114, v115
    v_accvgpr_write_b32 a56, v247
    v_accvgpr_write_b32 a57, v248
    v_cvt_pk_bf16_f32 v247, v116, v117
    v_cvt_pk_bf16_f32 v248, v118, v119
    v_accvgpr_write_b32 a58, v247
    v_accvgpr_write_b32 a59, v248
    v_cvt_pk_bf16_f32 v247, v24, v25
    v_cvt_pk_bf16_f32 v248, v26, v27
    v_accvgpr_write_b32 a12, v247
    v_accvgpr_write_b32 a13, v248
    v_cvt_pk_bf16_f32 v247, v28, v29
    v_cvt_pk_bf16_f32 v248, v30, v31
    v_accvgpr_write_b32 a14, v247
    v_accvgpr_write_b32 a15, v248
    s_nop 1
    v_mfma_f32_16x16x32_bf16 v[160:163], a[76:79], a[12:15], v[160:163]
    v_cvt_pk_bf16_f32 v247, v56, v57
    v_cvt_pk_bf16_f32 v248, v58, v59
    v_accvgpr_write_b32 a28, v247
    v_mfma_f32_16x16x32_bf16 v[164:167], a[80:83], a[0:3], 0
    v_accvgpr_write_b32 a29, v248
    v_cvt_pk_bf16_f32 v247, v60, v61
    v_cvt_pk_bf16_f32 v248, v62, v63
    v_mfma_f32_16x16x32_bf16 v[164:167], a[84:87], a[4:7], v[164:167]
    v_accvgpr_write_b32 a30, v247
    v_accvgpr_write_b32 a31, v248
    v_cvt_pk_bf16_f32 v247, v88, v89
    v_mfma_f32_16x16x32_bf16 v[164:167], a[88:91], a[8:11], v[164:167]
    buffer_load_dwordx4 v238, s[20:23], s56 offen offset:2048 lds
    v_cvt_pk_bf16_f32 v248, v90, v91
    v_mfma_f32_16x16x32_bf16 v[164:167], a[92:95], a[12:15], v[164:167]
    v_accvgpr_write_b32 a44, v247
    v_accvgpr_write_b32 a45, v248
    v_cvt_pk_bf16_f32 v247, v92, v93
    v_mfma_f32_16x16x32_bf16 v[168:171], a[64:67], a[16:19], 0
    v_cvt_pk_bf16_f32 v248, v94, v95
    v_accvgpr_write_b32 a46, v247
    v_accvgpr_write_b32 a47, v248
    v_mfma_f32_16x16x32_bf16 v[168:171], a[68:71], a[20:23], v[168:171]
    v_cvt_pk_bf16_f32 v247, v120, v121
    v_cvt_pk_bf16_f32 v248, v122, v123
    v_accvgpr_write_b32 a60, v247
    v_mfma_f32_16x16x32_bf16 v[168:171], a[72:75], a[24:27], v[168:171]
    buffer_load_dwordx4 v239, s[20:23], s56 offen offset:3072 lds
    v_accvgpr_write_b32 a61, v248
    v_mfma_f32_16x16x32_bf16 v[168:171], a[76:79], a[28:31], v[168:171]
    v_cvt_pk_bf16_f32 v247, v124, v125
    v_cvt_pk_bf16_f32 v248, v126, v127
    v_accvgpr_write_b32 a62, v247
    v_mfma_f32_16x16x32_bf16 v[172:175], a[80:83], a[16:19], 0
    v_accvgpr_write_b32 a63, v248
    v_and_b32 v247, 0x1c0, v242
    v_lshrrev_b32 v247, 1, v247
    v_mfma_f32_16x16x32_bf16 v[172:175], a[84:87], a[20:23], v[172:175]
    v_lshrrev_b32 v248, 1, v242
    v_and_b32 v248, 0x18, v248
    v_xor_b32 v247, v247, v248
    v_mfma_f32_16x16x32_bf16 v[172:175], a[88:91], a[24:27], v[172:175]
    s_add_u32 m0, s57, 32768
    s_mov_b32 s56, 32768
    buffer_load_dwordx4 v240, s[24:27], s56 offen offset:0 lds
    v_mfma_f32_16x16x32_bf16 v[172:175], a[92:95], a[28:31], v[172:175]
    v_and_b32 v248, 0x3c0, v242
    v_lshl_add_u32 v224, v248, 2, v247
    v_xor_b32 v225, 32, v224
    v_mfma_f32_16x16x32_bf16 v[176:179], a[64:67], a[32:35], 0
    v_xor_b32 v226, 64, v224
    v_xor_b32 v227, 96, v224
    v_xor_b32 v228, 128, v224
    v_mfma_f32_16x16x32_bf16 v[176:179], a[68:71], a[36:39], v[176:179]
    v_xor_b32 v229, 160, v224
    v_xor_b32 v230, 192, v224
    v_xor_b32 v231, 224, v224
    s_mul_i32 s63, s6, 88064
    s_lshr_b32 s59, s4, 1
    s_lshl_b32 s59, s59, 10
    s_add_u32 s63, s63, s59
    s_add_u32 s63, s63, 2129920
    s_cmp_ge_u32 s4, 22
    s_cselect_b32 s63, 536870912, s63
    v_mfma_f32_16x16x32_bf16 v[176:179], a[72:75], a[40:43], v[176:179]
    buffer_load_dwordx4 v241, s[24:27], s56 offen offset:1024 lds
    v_max_f32 v208, 0, v208
    v_mfma_f32_16x16x32_bf16 v[176:179], a[76:79], a[44:47], v[176:179]
    v_max_f32 v209, 0, v209
    v_max_f32 v210, 0, v210
    v_max_f32 v211, 0, v211
    v_mfma_f32_16x16x32_bf16 v[180:183], a[80:83], a[32:35], 0
    v_max_f32 v212, 0, v212
    v_max_f32 v213, 0, v213
    v_max_f32 v214, 0, v214
    v_mfma_f32_16x16x32_bf16 v[180:183], a[84:87], a[36:39], v[180:183]
    v_max_f32 v215, 0, v215
    v_mul_f32 v208, v208, v208
    v_mul_f32 v209, v209, v209
    v_mfma_f32_16x16x32_bf16 v[180:183], a[88:91], a[40:43], v[180:183]
    buffer_load_dwordx4 v240, s[24:27], s56 offen offset:2048 lds
    v_mul_f32 v210, v210, v210
    v_mfma_f32_16x16x32_bf16 v[180:183], a[92:95], a[44:47], v[180:183]
    v_mul_f32 v211, v211, v211
    v_mul_f32 v212, v212, v212
    v_mul_f32 v213, v213, v213
    v_mfma_f32_16x16x32_bf16 v[184:187], a[64:67], a[48:51], 0
    ds_read_b128 a[64:67], v232 offset:8192
    v_mul_f32 v214, v214, v214
    v_mul_f32 v215, v215, v215
    v_mfma_f32_16x16x32_bf16 v[184:187], a[68:71], a[52:55], v[184:187]
    ds_read_b128 a[68:71], v233 offset:8192
    v_cvt_pk_bf16_f32 v208, v208, v209
    v_cvt_pk_bf16_f32 v209, v210, v211
    v_mfma_f32_16x16x32_bf16 v[184:187], a[72:75], a[56:59], v[184:187]
    ds_read_b128 a[72:75], v234 offset:8192
    buffer_load_dwordx4 v241, s[24:27], s56 offen offset:3072 lds
    v_mfma_f32_16x16x32_bf16 v[184:187], a[76:79], a[60:63], v[184:187]
    ds_read_b128 a[76:79], v235 offset:8192
    v_cvt_pk_bf16_f32 v210, v212, v213
    v_cvt_pk_bf16_f32 v211, v214, v215
    v_mfma_f32_16x16x32_bf16 v[188:191], a[80:83], a[48:51], 0
    ds_read_b128 a[80:83], v232 offset:12288
    buffer_store_dwordx4 v[208:211], v242, s[8:11], s63 offen sc1
    v_mfma_f32_16x16x32_bf16 v[188:191], a[84:87], a[52:55], v[188:191]
    ds_read_b128 a[84:87], v233 offset:12288
    v_max_f32 v216, 0, v216
    v_max_f32 v217, 0, v217
    v_mfma_f32_16x16x32_bf16 v[188:191], a[88:91], a[56:59], v[188:191]
    ds_read_b128 a[88:91], v234 offset:12288
    v_max_f32 v218, 0, v218
    v_max_f32 v219, 0, v219
    v_mfma_f32_16x16x32_bf16 v[188:191], a[92:95], a[60:63], v[188:191]
    ds_read_b128 a[92:95], v235 offset:12288
    v_max_f32 v220, 0, v220
    v_max_f32 v221, 0, v221
    s_nop 7
    v_max_f32 v222, 0, v222
    v_max_f32 v223, 0, v223
    v_mul_f32 v216, v216, v216
    v_mul_f32 v217, v217, v217
    v_mul_f32 v218, v218, v218
    v_mul_f32 v219, v219, v219
    v_mul_f32 v220, v220, v220
    v_mul_f32 v221, v221, v221
    v_mul_f32 v222, v222, v222
    v_mul_f32 v223, v223, v223
    v_cvt_pk_bf16_f32 v216, v216, v217
    v_cvt_pk_bf16_f32 v217, v218, v219
    v_cvt_pk_bf16_f32 v218, v220, v221
    v_cvt_pk_bf16_f32 v219, v222, v223
    s_add_u32 s63, s63, 44032
    buffer_store_dwordx4 v[216:219], v242, s[8:11], s63 offen sc1
    v_max_f32 v249, v160, v161
    v_max3_f32 v249, v249, v162, v163
    v_max3_f32 v249, v249, v164, v165
    v_max3_f32 v249, v249, v166, v167
    v_mov_b32 v247, v249
    s_nop 1
    v_permlane16_swap_b32 v249, v247
    v_max_f32 v249, v249, v247
    v_mov_b32 v247, v249
    s_nop 1
    v_permlane32_swap_b32 v249, v247
    v_max_f32 v249, v249, v247
    v_cndmask_b32 v249, v249, v243, s[60:61]
    v_sub_f32 v192, 0, v249
    v_sub_f32 v193, 0, v249
    v_sub_f32 v194, 0, v249
    v_sub_f32 v195, 0, v249
    v_sub_f32 v160, v160, v249
    v_sub_f32 v161, v161, v249
    v_sub_f32 v162, v162, v249
    v_sub_f32 v163, v163, v249
    v_sub_f32 v164, v164, v249
    v_sub_f32 v165, v165, v249
    v_sub_f32 v166, v166, v249
    v_sub_f32 v167, v167, v249
    v_max_f32 v249, v168, v169
    v_max3_f32 v249, v249, v170, v171
    v_max3_f32 v249, v249, v172, v173
    v_max3_f32 v249, v249, v174, v175
    v_mov_b32 v247, v249
    s_nop 1
    v_permlane16_swap_b32 v249, v247
    v_max_f32 v249, v249, v247
    v_mov_b32 v247, v249
    s_nop 1
    v_permlane32_swap_b32 v249, v247
    v_max_f32 v249, v249, v247
    v_cndmask_b32 v249, v249, v244, s[60:61]
    v_sub_f32 v196, 0, v249
    v_sub_f32 v197, 0, v249
    v_sub_f32 v198, 0, v249
    v_sub_f32 v199, 0, v249
    v_sub_f32 v168, v168, v249
    v_sub_f32 v169, v169, v249
    v_sub_f32 v170, v170, v249
    v_sub_f32 v171, v171, v249
    v_sub_f32 v172, v172, v249
    v_sub_f32 v173, v173, v249
    v_sub_f32 v174, v174, v249
    v_sub_f32 v175, v175, v249
    v_mov_b32 v220, 0x3f803f80
    v_mov_b32 v221, 0x3f803f80
    v_mov_b32 v222, 0x3f803f80
    v_mov_b32 v223, 0x3f803f80
    s_mul_i32 s63, s6, 88064
    s_lshl_b32 s59, s4, 10
    s_add_u32 s63, s63, s59
    s_add_u32 s63, s63, 2097152
    v_max_f32 v128, 0, v128
    v_max_f32 v129, 0, v129
    v_max_f32 v130, 0, v130
    v_max_f32 v131, 0, v131
    v_max_f32 v132, 0, v132
    v_max_f32 v133, 0, v133
    v_max_f32 v134, 0, v134
    v_max_f32 v135, 0, v135
    v_mul_f32 v128, v128, v128
    v_mul_f32 v129, v129, v129
    v_mul_f32 v130, v130, v130
    v_mul_f32 v131, v131, v131
    v_mul_f32 v132, v132, v132
    v_mul_f32 v133, v133, v133
    v_mul_f32 v134, v134, v134
    v_mul_f32 v135, v135, v135
    v_cvt_pk_bf16_f32 v128, v128, v129
    v_cvt_pk_bf16_f32 v129, v130, v131
    v_cvt_pk_bf16_f32 v130, v132, v133
    v_cvt_pk_bf16_f32 v131, v134, v135
    buffer_store_dwordx4 v[128:131], v242, s[8:11], s63 offen sc1
    v_max_f32 v136, 0, v136
    v_max_f32 v137, 0, v137
    v_max_f32 v138, 0, v138
    v_max_f32 v139, 0, v139
    v_max_f32 v140, 0, v140
    v_max_f32 v141, 0, v141
    v_max_f32 v142, 0, v142
    v_max_f32 v143, 0, v143
    v_mul_f32 v136, v136, v136
    v_mul_f32 v137, v137, v137
    v_mul_f32 v138, v138, v138
    v_mul_f32 v139, v139, v139
    v_mul_f32 v140, v140, v140
    v_mul_f32 v141, v141, v141
    v_mul_f32 v142, v142, v142
    v_mul_f32 v143, v143, v143
    v_cvt_pk_bf16_f32 v136, v136, v137
    v_cvt_pk_bf16_f32 v137, v138, v139
    v_cvt_pk_bf16_f32 v138, v140, v141
    v_cvt_pk_bf16_f32 v139, v142, v143
    s_add_u32 s63, s63, 44032
    buffer_store_dwordx4 v[136:139], v242, s[8:11], s63 offen sc1
    v_max_f32 v249, v176, v177
    v_max3_f32 v249, v249, v178, v179
    v_max3_f32 v249, v249, v180, v181
    v_max3_f32 v249, v249, v182, v183
    v_mov_b32 v247, v249
    s_nop 1
    v_permlane16_swap_b32 v249, v247
    v_max_f32 v249, v249, v247
    v_mov_b32 v247, v249
    s_nop 1
    v_permlane32_swap_b32 v249, v247
    v_max_f32 v249, v249, v247
    v_cndmask_b32 v249, v249, v245, s[60:61]
    v_sub_f32 v200, 0, v249
    v_sub_f32 v201, 0, v249
    v_sub_f32 v202, 0, v249
    v_sub_f32 v203, 0, v249
    v_sub_f32 v176, v176, v249
    v_sub_f32 v177, v177, v249
    v_sub_f32 v178, v178, v249
    v_sub_f32 v179, v179, v249
    v_sub_f32 v180, v180, v249
    v_sub_f32 v181, v181, v249
    v_sub_f32 v182, v182, v249
    v_sub_f32 v183, v183, v249
    v_max_f32 v249, v184, v185
    v_max3_f32 v249, v249, v186, v187
    v_max3_f32 v249, v249, v188, v189
    v_max3_f32 v249, v249, v190, v191
    v_mov_b32 v247, v249
    s_nop 1
    v_permlane16_swap_b32 v249, v247
    v_max_f32 v249, v249, v247
    v_mov_b32 v247, v249
    s_nop 1
    v_permlane32_swap_b32 v249, v247
    v_max_f32 v249, v249, v247
    v_cndmask_b32 v249, v249, v246, s[60:61]
    v_sub_f32 v204, 0, v249
    v_sub_f32 v205, 0, v249
    v_sub_f32 v206, 0, v249
    v_sub_f32 v207, 0, v249
    v_sub_f32 v184, v184, v249
    v_sub_f32 v185, v185, v249
    v_sub_f32 v186, v186, v249
    v_sub_f32 v187, v187, v249
    v_sub_f32 v188, v188, v249
    v_sub_f32 v189, v189, v249
    v_sub_f32 v190, v190, v249
    v_sub_f32 v191, v191, v249
    v_exp_f32 v160, v160
    v_exp_f32 v161, v161
    v_exp_f32 v162, v162
    v_cvt_pk_bf16_f32 v160, v160, v161
    v_exp_f32 v163, v163
    v_exp_f32 v164, v164
    v_cvt_pk_bf16_f32 v161, v162, v163
    v_exp_f32 v165, v165
    v_exp_f32 v166, v166
    v_cvt_pk_bf16_f32 v162, v164, v165
    v_exp_f32 v167, v167
    s_nop 0
    v_cvt_pk_bf16_f32 v163, v166, v167
    s_waitcnt lgkmcnt(4)
    s_nop 1
    s_cmp_lg_u32 s1, 0
    s_cbranch_scc1 maxpass
    v_mfma_f32_16x16x32_bf16 v[128:131], a[64:67], a[0:3], v[192:195]
    v_exp_f32 v168, v168
    v_mfma_f32_16x16x32_bf16 v[128:131], a[68:71], a[4:7], v[128:131]
    s_mul_i32 s63, s7, 88064
    s_lshl_b32 s59, s4, 10
    s_add_u32 s63, s63, s59
    s_add_u32 s63, s63, 2097152
    ds_read_b64_tr_b16 a[96:97], v224 offset:0
    ds_read_b64_tr_b16 a[98:99], v224 offset:4096
    v_mfma_f32_16x16x32_bf16 v[128:131], a[72:75], a[8:11], v[128:131]
    v_exp_f32 v169, v169
    v_max_f32 v144, 0, v144
    v_max_f32 v145, 0, v145
    v_max_f32 v146, 0, v146
    v_max_f32 v147, 0, v147
    v_mfma_f32_16x16x32_bf16 v[128:131], a[76:79], a[12:15], v[128:131]
    s_waitcnt vmcnt(12) lgkmcnt(2)
    s_barrier
    ds_read_b64_tr_b16 a[100:101], v225 offset:0
    v_cvt_pk_bf16_f32 v168, v168, v169
    v_max_f32 v148, 0, v148
    v_max_f32 v149, 0, v149
    v_max_f32 v150, 0, v150
    v_mfma_f32_16x16x32_bf16 v[132:135], a[80:83], a[0:3], v[192:195]
    v_exp_f32 v170, v170
    v_max_f32 v151, 0, v151
    v_mul_f32 v144, v144, v144
    v_mul_f32 v145, v145, v145
    v_mul_f32 v146, v146, v146
    v_mfma_f32_16x16x32_bf16 v[132:135], a[84:87], a[4:7], v[132:135]
    v_mul_f32 v147, v147, v147
    v_mul_f32 v148, v148, v148
    v_mul_f32 v149, v149, v149
    v_mfma_f32_16x16x32_bf16 v[132:135], a[88:91], a[8:11], v[132:135]
    v_exp_f32 v171, v171
    v_mul_f32 v150, v150, v150
    v_mul_f32 v151, v151, v151
    v_cvt_pk_bf16_f32 v144, v144, v145
    v_cvt_pk_bf16_f32 v145, v146, v147
    v_mfma_f32_16x16x32_bf16 v[132:135], a[92:95], a[12:15], v[132:135]
    ds_read_b64_tr_b16 a[102:103], v225 offset:4096
    v_cvt_pk_bf16_f32 v169, v170, v171
    v_cvt_pk_bf16_f32 v146, v148, v149
    v_cvt_pk_bf16_f32 v147, v150, v151
    v_mfma_f32_16x16x32_bf16 v[136:139], a[64:67], a[16:19], v[196:199]
    v_exp_f32 v172, v172
    v_max_f32 v152, 0, v152
    v_max_f32 v153, 0, v153
    v_max_f32 v154, 0, v154
    v_max_f32 v155, 0, v155
    v_mfma_f32_16x16x32_bf16 v[136:139], a[68:71], a[20:23], v[136:139]
    ds_read_b64_tr_b16 a[104:105], v226 offset:0
    ds_read_b64_tr_b16 a[106:107], v226 offset:4096
    buffer_store_dwordx4 v[144:147], v242, s[8:11], s63 offen sc1
    v_max_f32 v156, 0, v156
    v_max_f32 v157, 0, v157
    v_max_f32 v158, 0, v158
    v_mfma_f32_16x16x32_bf16 v[136:139], a[72:75], a[24:27], v[136:139]
    v_exp_f32 v173, v173
    v_max_f32 v159, 0, v159
    v_mul_f32 v152, v152, v152
    v_mul_f32 v153, v153, v153
    v_mul_f32 v154, v154, v154
    v_mfma_f32_16x16x32_bf16 v[136:139], a[76:79], a[28:31], v[136:139]
    ds_read_b64_tr_b16 a[108:109], v227 offset:0
    v_cvt_pk_bf16_f32 v170, v172, v173
    v_mul_f32 v155, v155, v155
    v_mul_f32 v156, v156, v156
    v_mul_f32 v157, v157, v157
    v_mfma_f32_16x16x32_bf16 v[140:143], a[80:83], a[16:19], v[196:199]
    v_exp_f32 v174, v174
    v_mul_f32 v158, v158, v158
    v_mul_f32 v159, v159, v159
    v_cvt_pk_bf16_f32 v152, v152, v153
    v_cvt_pk_bf16_f32 v153, v154, v155
    v_mfma_f32_16x16x32_bf16 v[140:143], a[84:87], a[20:23], v[140:143]
    v_cvt_pk_bf16_f32 v154, v156, v157
    v_cvt_pk_bf16_f32 v155, v158, v159
    v_mfma_f32_16x16x32_bf16 v[140:143], a[88:91], a[24:27], v[140:143]
    v_exp_f32 v175, v175
    v_mfma_f32_16x16x32_bf16 v[140:143], a[92:95], a[28:31], v[140:143]
    s_add_u32 s63, s63, 44032
    ds_read_b64_tr_b16 a[110:111], v227 offset:4096
    buffer_store_dwordx4 v[152:155], v242, s[8:11], s63 offen sc1
    v_cvt_pk_bf16_f32 v171, v174, v175
    v_mfma_f32_16x16x32_bf16 v[144:147], a[64:67], a[32:35], v[200:203]
    v_exp_f32 v176, v176
    v_mfma_f32_16x16x32_bf16 v[144:147], a[68:71], a[36:39], v[144:147]
    ds_read_b64_tr_b16 a[112:113], v228 offset:0
    ds_read_b64_tr_b16 a[114:115], v228 offset:4096
    v_mfma_f32_16x16x32_bf16 v[144:147], a[72:75], a[40:43], v[144:147]
    v_exp_f32 v177, v177
    v_mfma_f32_16x16x32_bf16 v[144:147], a[76:79], a[44:47], v[144:147]
    ds_read_b64_tr_b16 a[116:117], v229 offset:0
    v_cvt_pk_bf16_f32 v176, v176, v177
    v_mfma_f32_16x16x32_bf16 v[148:151], a[80:83], a[32:35], v[200:203]
    v_exp_f32 v178, v178
    v_mfma_f32_16x16x32_bf16 v[148:151], a[84:87], a[36:39], v[148:151]
    s_add_u32 m0, s57, 147456
    s_mov_b32 s56, 49152
    buffer_load_dwordx4 v236, s[20:23], s56 offen offset:0 lds
    v_mfma_f32_16x16x32_bf16 v[148:151], a[88:91], a[40:43], v[148:151]
    v_exp_f32 v179, v179
    v_mfma_f32_16x16x32_bf16 v[148:151], a[92:95], a[44:47], v[148:151]
    ds_read_b64_tr_b16 a[118:119], v229 offset:4096
    v_cvt_pk_bf16_f32 v177, v178, v179
    v_mfma_f32_16x16x32_bf16 v[152:155], a[64:67], a[48:51], v[204:207]
    v_exp_f32 v180, v180
    v_mfma_f32_16x16x32_bf16 v[152:155], a[68:71], a[52:55], v[152:155]
    ds_read_b64_tr_b16 a[120:121], v230 offset:0
    ds_read_b64_tr_b16 a[122:123], v230 offset:4096
    v_mfma_f32_16x16x32_bf16 v[152:155], a[72:75], a[56:59], v[152:155]
    v_exp_f32 v181, v181
    v_mfma_f32_16x16x32_bf16 v[152:155], a[76:79], a[60:63], v[152:155]
    ds_read_b64_tr_b16 a[124:125], v231 offset:0
    v_cvt_pk_bf16_f32 v178, v180, v181
    v_mfma_f32_16x16x32_bf16 v[156:159], a[80:83], a[48:51], v[204:207]
    v_exp_f32 v182, v182
    v_mfma_f32_16x16x32_bf16 v[156:159], a[84:87], a[52:55], v[156:159]
    buffer_load_dwordx4 v237, s[20:23], s56 offen offset:1024 lds
    v_mfma_f32_16x16x32_bf16 v[156:159], a[88:91], a[56:59], v[156:159]
    v_exp_f32 v183, v183
    v_mfma_f32_16x16x32_bf16 v[156:159], a[92:95], a[60:63], v[156:159]
    s_waitcnt lgkmcnt(7)
    ds_read_b64_tr_b16 a[126:127], v231 offset:4096
    v_cvt_pk_bf16_f32 v179, v182, v183
    v_mfma_f32_16x16x32_bf16 v[0:3], a[96:99], v[160:163], 0
    v_exp_f32 v184, v184
    v_mfma_f32_16x16x32_bf16 v[4:7], a[100:103], v[160:163], 0
    buffer_load_dwordx4 v238, s[20:23], s56 offen offset:2048 lds
    v_mfma_f32_16x16x32_bf16 v[8:11], a[104:107], v[160:163], 0
    v_exp_f32 v185, v185
    v_mfma_f32_16x16x32_bf16 v[12:15], a[108:111], v[160:163], 0
    s_waitcnt lgkmcnt(0)
    ds_read_b128 a[64:67], v232 offset:16384
    v_cvt_pk_bf16_f32 v184, v184, v185
    v_mfma_f32_16x16x32_bf16 v[16:19], a[112:115], v[160:163], 0
    v_exp_f32 v186, v186
    v_mfma_f32_16x16x32_bf16 v[20:23], a[116:119], v[160:163], 0
    buffer_load_dwordx4 v239, s[20:23], s56 offen offset:3072 lds
    v_mfma_f32_16x16x32_bf16 v[24:27], a[120:123], v[160:163], 0
    v_exp_f32 v187, v187
    v_mfma_f32_16x16x32_bf16 v[28:31], a[124:127], v[160:163], 0
    ds_read_b128 a[68:71], v233 offset:16384
    v_cvt_pk_bf16_f32 v185, v186, v187
    v_mfma_f32_16x16x32_bf16 a[240:243], v[220:223], v[160:163], 0
    v_exp_f32 v188, v188
    v_mfma_f32_16x16x32_bf16 v[32:35], a[96:99], v[168:171], 0
    s_add_u32 m0, s57, 49152
    s_mov_b32 s56, 49152
    buffer_load_dwordx4 v240, s[24:27], s56 offen offset:0 lds
    v_mfma_f32_16x16x32_bf16 v[36:39], a[100:103], v[168:171], 0
    v_exp_f32 v189, v189
    v_mfma_f32_16x16x32_bf16 v[40:43], a[104:107], v[168:171], 0
    ds_read_b128 a[72:75], v234 offset:16384
    v_cvt_pk_bf16_f32 v186, v188, v189
    v_mfma_f32_16x16x32_bf16 v[44:47], a[108:111], v[168:171], 0
    v_exp_f32 v190, v190
    v_mfma_f32_16x16x32_bf16 v[48:51], a[112:115], v[168:171], 0
    buffer_load_dwordx4 v241, s[24:27], s56 offen offset:1024 lds
    v_mfma_f32_16x16x32_bf16 v[52:55], a[116:119], v[168:171], 0
    v_exp_f32 v191, v191
    v_mfma_f32_16x16x32_bf16 v[56:59], a[120:123], v[168:171], 0
    ds_read_b128 a[76:79], v235 offset:16384
    v_cvt_pk_bf16_f32 v187, v190, v191
    v_mfma_f32_16x16x32_bf16 v[60:63], a[124:127], v[168:171], 0
    buffer_load_dwordx4 v240, s[24:27], s56 offen offset:2048 lds
    v_mfma_f32_16x16x32_bf16 a[244:247], v[220:223], v[168:171], 0
    v_mfma_f32_16x16x32_bf16 v[64:67], a[96:99], v[176:179], 0
    v_exp_f32 v128, v128
    v_mfma_f32_16x16x32_bf16 v[68:71], a[100:103], v[176:179], 0
    buffer_load_dwordx4 v241, s[24:27], s56 offen offset:3072 lds
    v_mfma_f32_16x16x32_bf16 v[72:75], a[104:107], v[176:179], 0
    v_exp_f32 v129, v129
    v_mfma_f32_16x16x32_bf16 v[76:79], a[108:111], v[176:179], 0
    ds_read_b128 a[80:83], v232 offset:20480
    v_cvt_pk_bf16_f32 v128, v128, v129
    v_mfma_f32_16x16x32_bf16 v[80:83], a[112:115], v[176:179], 0
    v_exp_f32 v130, v130
    v_mfma_f32_16x16x32_bf16 v[84:87], a[116:119], v[176:179], 0
    v_mfma_f32_16x16x32_bf16 v[88:91], a[120:123], v[176:179], 0
    v_exp_f32 v131, v131
    v_mfma_f32_16x16x32_bf16 v[92:95], a[124:127], v[176:179], 0
    ds_read_b128 a[84:87], v233 offset:20480
    v_cvt_pk_bf16_f32 v129, v130, v131
    v_mfma_f32_16x16x32_bf16 a[248:251], v[220:223], v[176:179], 0
    v_exp_f32 v132, v132
    v_mfma_f32_16x16x32_bf16 v[96:99], a[96:99], v[184:187], 0
    v_mfma_f32_16x16x32_bf16 v[100:103], a[100:103], v[184:187], 0
    v_exp_f32 v133, v133
    v_mfma_f32_16x16x32_bf16 v[104:107], a[104:107], v[184:187], 0
    ds_read_b128 a[88:91], v234 offset:20480
    v_cvt_pk_bf16_f32 v130, v132, v133
    v_mfma_f32_16x16x32_bf16 v[108:111], a[108:111], v[184:187], 0
    v_exp_f32 v134, v134
    v_mfma_f32_16x16x32_bf16 v[112:115], a[112:115], v[184:187], 0
    v_mfma_f32_16x16x32_bf16 v[116:119], a[116:119], v[184:187], 0
    v_exp_f32 v135, v135
    v_mfma_f32_16x16x32_bf16 v[120:123], a[120:123], v[184:187], 0
    ds_read_b128 a[92:95], v235 offset:20480
    v_cvt_pk_bf16_f32 v131, v134, v135
    v_mfma_f32_16x16x32_bf16 v[124:127], a[124:127], v[184:187], 0
    v_mfma_f32_16x16x32_bf16 a[252:255], v[220:223], v[184:187], 0
    s_waitcnt lgkmcnt(4)
    v_mfma_f32_16x16x32_bf16 v[160:163], a[64:67], a[0:3], v[192:195]
    v_exp_f32 v136, v136
    v_mfma_f32_16x16x32_bf16 v[160:163], a[68:71], a[4:7], v[160:163]
    ds_read_b64_tr_b16 a[96:97], v224 offset:8192
    ds_read_b64_tr_b16 a[98:99], v224 offset:12288
    v_mfma_f32_16x16x32_bf16 v[160:163], a[72:75], a[8:11], v[160:163]
    v_exp_f32 v137, v137
    v_mfma_f32_16x16x32_bf16 v[160:163], a[76:79], a[12:15], v[160:163]
    s_waitcnt lgkmcnt(2)
    ds_read_b64_tr_b16 a[100:101], v225 offset:8192
    v_cvt_pk_bf16_f32 v136, v136, v137
    v_mfma_f32_16x16x32_bf16 v[164:167], a[80:83], a[0:3], v[192:195]
    v_exp_f32 v138, v138
    v_mfma_f32_16x16x32_bf16 v[164:167], a[84:87], a[4:7], v[164:167]
    s_mul_i32 s100, s3, 4096
    s_add_u32 s100, s100, 0
    v_min_u32 v218, 496, v242
    v_lshlrev_b32 v218, 3, v218
    v_mfma_f32_16x16x32_bf16 v[164:167], a[88:91], a[8:11], v[164:167]
    v_exp_f32 v139, v139
    v_mfma_f32_16x16x32_bf16 v[164:167], a[92:95], a[12:15], v[164:167]
    ds_read_b64_tr_b16 a[102:103], v225 offset:12288
    v_cvt_pk_bf16_f32 v137, v138, v139
    v_mfma_f32_16x16x32_bf16 v[168:171], a[64:67], a[16:19], v[196:199]
    v_exp_f32 v140, v140
    v_mfma_f32_16x16x32_bf16 v[168:171], a[68:71], a[20:23], v[168:171]
    ds_read_b64_tr_b16 a[104:105], v226 offset:8192
    ds_read_b64_tr_b16 a[106:107], v226 offset:12288
    v_mfma_f32_16x16x32_bf16 v[168:171], a[72:75], a[24:27], v[168:171]
    v_exp_f32 v141, v141
    v_mfma_f32_16x16x32_bf16 v[168:171], a[76:79], a[28:31], v[168:171]
    ds_read_b64_tr_b16 a[108:109], v227 offset:8192
    v_cvt_pk_bf16_f32 v138, v140, v141
    v_mfma_f32_16x16x32_bf16 v[172:175], a[80:83], a[16:19], v[196:199]
    v_exp_f32 v142, v142
    v_mfma_f32_16x16x32_bf16 v[172:175], a[84:87], a[20:23], v[172:175]
    v_add_u32 v218, s100, v218
    v_min_u32 v218, code_end-ct_site2-8, v218
    v_mfma_f32_16x16x32_bf16 v[172:175], a[88:91], a[24:27], v[172:175]
    v_exp_f32 v143, v143
    v_mfma_f32_16x16x32_bf16 v[172:175], a[92:95], a[28:31], v[172:175]
    ds_read_b64_tr_b16 a[110:111], v227 offset:12288
    v_cvt_pk_bf16_f32 v139, v142, v143
    v_mfma_f32_16x16x32_bf16 v[176:179], a[64:67], a[32:35], v[200:203]
    v_exp_f32 v144, v144
    v_mfma_f32_16x16x32_bf16 v[176:179], a[68:71], a[36:39], v[176:179]
    ds_read_b64_tr_b16 a[112:113], v228 offset:8192
    ds_read_b64_tr_b16 a[114:115], v228 offset:12288
    v_mfma_f32_16x16x32_bf16 v[176:179], a[72:75], a[40:43], v[176:179]
    v_exp_f32 v145, v145
    v_mfma_f32_16x16x32_bf16 v[176:179], a[76:79], a[44:47], v[176:179]
    ds_read_b64_tr_b16 a[116:117], v229 offset:8192
    v_cvt_pk_bf16_f32 v144, v144, v145
    v_mfma_f32_16x16x32_bf16 v[180:183], a[80:83], a[32:35], v[200:203]
    v_exp_f32 v146, v146
    v_mfma_f32_16x16x32_bf16 v[180:183], a[84:87], a[36:39], v[180:183]
    s_and_b32 s82, s5, 3
    s_lshl_b32 s82, s82, 2
    s_add_u32 s82, s82, s3
    s_mul_i32 s82, s82, 4096
    s_add_u32 s82, s82, 65536
    v_min_u32 v247, 496, v242
    v_lshlrev_b32 v247, 3, v247
    v_mfma_f32_16x16x32_bf16 v[180:183], a[88:91], a[40:43], v[180:183]
    v_exp_f32 v147, v147
    v_mfma_f32_16x16x32_bf16 v[180:183], a[92:95], a[44:47], v[180:183]
    ds_read_b64_tr_b16 a[118:119], v229 offset:12288
    v_cvt_pk_bf16_f32 v145, v146, v147
    v_mfma_f32_16x16x32_bf16 v[184:187], a[64:67], a[48:51], v[204:207]
    v_exp_f32 v148, v148
    v_mfma_f32_16x16x32_bf16 v[184:187], a[68:71], a[52:55], v[184:187]
    ds_read_b64_tr_b16 a[120:121], v230 offset:8192
    ds_read_b64_tr_b16 a[122:123], v230 offset:12288
    v_mfma_f32_16x16x32_bf16 v[184:187], a[72:75], a[56:59], v[184:187]
    v_exp_f32 v149, v149
    v_mfma_f32_16x16x32_bf16 v[184:187], a[76:79], a[60:63], v[184:187]
    ds_read_b64_tr_b16 a[124:125], v231 offset:8192
    v_cvt_pk_bf16_f32 v146, v148, v149
    v_mfma_f32_16x16x32_bf16 v[188:191], a[80:83], a[48:51], v[204:207]
    v_exp_f32 v150, v150
    v_mfma_f32_16x16x32_bf16 v[188:191], a[84:87], a[52:55], v[188:191]
    s_mul_i32 s53, s78, 88064
    s_add_u32 s53, s53, 2097152
    s_add_u32 s65, s53, 44032
    v_and_b32 v212, 496, v242
    v_lshlrev_b32 v212, 3, v212
    v_mfma_f32_16x16x32_bf16 v[188:191], a[88:91], a[56:59], v[188:191]
    v_exp_f32 v151, v151
    v_mfma_f32_16x16x32_bf16 v[188:191], a[92:95], a[60:63], v[188:191]
    s_waitcnt lgkmcnt(7)
    ds_read_b64_tr_b16 a[126:127], v231 offset:12288
    v_cvt_pk_bf16_f32 v147, v150, v151
    v_mfma_f32_16x16x32_bf16 v[0:3], a[96:99], v[128:131], v[0:3]
    v_exp_f32 v152, v152
    v_mfma_f32_16x16x32_bf16 v[4:7], a[100:103], v[128:131], v[4:7]
    s_getpc_b64 s[100:101]
ct_site2:
    global_load_dword v218, v218, s[100:101]
    v_mfma_f32_16x16x32_bf16 v[8:11], a[104:107], v[128:131], v[8:11]
    v_exp_f32 v153, v153
    v_mfma_f32_16x16x32_bf16 v[12:15], a[108:111], v[128:131], v[12:15]
    s_waitcnt lgkmcnt(0)
    ds_read_b128 a[64:67], v232 offset:24576
    v_cvt_pk_bf16_f32 v152, v152, v153
    v_mfma_f32_16x16x32_bf16 v[16:19], a[112:115], v[128:131], v[16:19]
    v_exp_f32 v154, v154
    v_mfma_f32_16x16x32_bf16 v[20:23], a[116:119], v[128:131], v[20:23]
    buffer_load_dword a158, v247, s[20:23], s82 offen
    v_mfma_f32_16x16x32_bf16 v[24:27], a[120:123], v[128:131], v[24:27]
    v_exp_f32 v155, v155
    v_mfma_f32_16x16x32_bf16 v[28:31], a[124:127], v[128:131], v[28:31]
    ds_read_b128 a[68:71], v233 offset:24576
    v_cvt_pk_bf16_f32 v153, v154, v155
    v_mfma_f32_16x16x32_bf16 a[240:243], v[220:223], v[128:131], a[240:243]
    v_exp_f32 v156, v156
    v_mfma_f32_16x16x32_bf16 v[32:35], a[96:99], v[136:139], v[32:35]
    buffer_load_dword a159, v247, s[24:27], s82 offen
    v_mfma_f32_16x16x32_bf16 v[36:39], a[100:103], v[136:139], v[36:39]
    v_exp_f32 v157, v157
    v_mfma_f32_16x16x32_bf16 v[40:43], a[104:107], v[136:139], v[40:43]
    ds_read_b128 a[72:75], v234 offset:24576
    v_cvt_pk_bf16_f32 v154, v156, v157
    v_mfma_f32_16x16x32_bf16 v[44:47], a[108:111], v[136:139], v[44:47]
    v_exp_f32 v158, v158
    v_mfma_f32_16x16x32_bf16 v[48:51], a[112:115], v[136:139], v[48:51]
    v_mfma_f32_16x16x32_bf16 v[52:55], a[116:119], v[136:139], v[52:55]
    v_exp_f32 v159, v159
    v_mfma_f32_16x16x32_bf16 v[56:59], a[120:123], v[136:139], v[56:59]
    ds_read_b128 a[76:79], v235 offset:24576
    v_cvt_pk_bf16_f32 v155, v158, v159
    v_mfma_f32_16x16x32_bf16 v[60:63], a[124:127], v[136:139], v[60:63]
    v_mfma_f32_16x16x32_bf16 a[244:247], v[220:223], v[136:139], a[244:247]
    v_mfma_f32_16x16x32_bf16 v[64:67], a[96:99], v[144:147], v[64:67]
    v_exp_f32 v160, v160
    v_mfma_f32_16x16x32_bf16 v[68:71], a[100:103], v[144:147], v[68:71]
    v_mfma_f32_16x16x32_bf16 v[72:75], a[104:107], v[144:147], v[72:75]
    v_exp_f32 v161, v161
    v_mfma_f32_16x16x32_bf16 v[76:79], a[108:111], v[144:147], v[76:79]
    ds_read_b128 a[80:83], v232 offset:28672
    v_cvt_pk_bf16_f32 v160, v160, v161
    v_mfma_f32_16x16x32_bf16 v[80:83], a[112:115], v[144:147], v[80:83]
    v_exp_f32 v162, v162
    v_mfma_f32_16x16x32_bf16 v[84:87], a[116:119], v[144:147], v[84:87]
    v_mfma_f32_16x16x32_bf16 v[88:91], a[120:123], v[144:147], v[88:91]
    v_exp_f32 v163, v163
    v_mfma_f32_16x16x32_bf16 v[92:95], a[124:127], v[144:147], v[92:95]
    ds_read_b128 a[84:87], v233 offset:28672
    v_cvt_pk_bf16_f32 v161, v162, v163
    v_mfma_f32_16x16x32_bf16 a[248:251], v[220:223], v[144:147], a[248:251]
    v_exp_f32 v164, v164
    v_mfma_f32_16x16x32_bf16 v[96:99], a[96:99], v[152:155], v[96:99]
    v_mfma_f32_16x16x32_bf16 v[100:103], a[100:103], v[152:155], v[100:103]
    v_exp_f32 v165, v165
    v_mfma_f32_16x16x32_bf16 v[104:107], a[104:107], v[152:155], v[104:107]
    ds_read_b128 a[88:91], v234 offset:28672
    v_cvt_pk_bf16_f32 v162, v164, v165
    v_mfma_f32_16x16x32_bf16 v[108:111], a[108:111], v[152:155], v[108:111]
    v_exp_f32 v166, v166
    v_mfma_f32_16x16x32_bf16 v[112:115], a[112:115], v[152:155], v[112:115]
    v_mfma_f32_16x16x32_bf16 v[116:119], a[116:119], v[152:155], v[116:119]
    v_exp_f32 v167, v167
    v_mfma_f32_16x16x32_bf16 v[120:123], a[120:123], v[152:155], v[120:123]
    ds_read_b128 a[92:95], v235 offset:28672
    v_cvt_pk_bf16_f32 v163, v166, v167
    v_mfma_f32_16x16x32_bf16 v[124:127], a[124:127], v[152:155], v[124:127]
    v_mfma_f32_16x16x32_bf16 a[252:255], v[220:223], v[152:155], a[252:255]
    s_waitcnt lgkmcnt(4)
    v_mfma_f32_16x16x32_bf16 v[128:131], a[64:67], a[0:3], v[192:195]
    v_exp_f32 v168, v168
    v_mfma_f32_16x16x32_bf16 v[128:131], a[68:71], a[4:7], v[128:131]
    ds_read_b64_tr_b16 a[96:97], v224 offset:16384
    ds_read_b64_tr_b16 a[98:99], v224 offset:20480
    v_mfma_f32_16x16x32_bf16 v[128:131], a[72:75], a[8:11], v[128:131]
    v_exp_f32 v169, v169
    v_mfma_f32_16x16x32_bf16 v[128:131], a[76:79], a[12:15], v[128:131]
    s_waitcnt vmcnt(11) lgkmcnt(2)
    s_barrier
    ds_read_b64_tr_b16 a[100:101], v225 offset:16384
    v_cvt_pk_bf16_f32 v168, v168, v169
    v_mfma_f32_16x16x32_bf16 v[132:135], a[80:83], a[0:3], v[192:195]
    v_exp_f32 v170, v170
    v_mfma_f32_16x16x32_bf16 v[132:135], a[84:87], a[4:7], v[132:135]
    v_min_u32 v249, 1, v242
    v_lshlrev_b32 v249, 31, v249
    v_mfma_f32_16x16x32_bf16 v[132:135], a[88:91], a[8:11], v[132:135]
    v_exp_f32 v171, v171
    v_mfma_f32_16x16x32_bf16 v[132:135], a[92:95], a[12:15], v[132:135]
    ds_read_b64_tr_b16 a[102:103], v225 offset:20480
    v_cvt_pk_bf16_f32 v169, v170, v171
    v_mfma_f32_16x16x32_bf16 v[136:139], a[64:67], a[16:19], v[196:199]
    v_exp_f32 v172, v172
    v_mfma_f32_16x16x32_bf16 v[136:139], a[68:71], a[20:23], v[136:139]
    ds_read_b64_tr_b16 a[104:105], v226 offset:16384
    ds_read_b64_tr_b16 a[106:107], v226 offset:20480
    v_mfma_f32_16x16x32_bf16 v[136:139], a[72:75], a[24:27], v[136:139]
    v_exp_f32 v173, v173
    v_mfma_f32_16x16x32_bf16 v[136:139], a[76:79], a[28:31], v[136:139]
    ds_read_b64_tr_b16 a[108:109], v227 offset:16384
    v_cvt_pk_bf16_f32 v170, v172, v173
    v_mfma_f32_16x16x32_bf16 v[140:143], a[80:83], a[16:19], v[196:199]
    v_exp_f32 v174, v174
    v_mfma_f32_16x16x32_bf16 v[140:143], a[84:87], a[20:23], v[140:143]
    v_mov_b32 v248, s64
    v_and_b32 v247, 0xf0, v240
    v_mfma_f32_16x16x32_bf16 v[140:143], a[88:91], a[24:27], v[140:143]
    v_exp_f32 v175, v175
    v_mfma_f32_16x16x32_bf16 v[140:143], a[92:95], a[28:31], v[140:143]
    ds_read_b64_tr_b16 a[110:111], v227 offset:20480
    v_cvt_pk_bf16_f32 v171, v174, v175
    v_mfma_f32_16x16x32_bf16 v[144:147], a[64:67], a[32:35], v[200:203]
    v_exp_f32 v176, v176
    v_mfma_f32_16x16x32_bf16 v[144:147], a[68:71], a[36:39], v[144:147]
    ds_read_b64_tr_b16 a[112:113], v228 offset:16384
    ds_read_b64_tr_b16 a[114:115], v228 offset:20480
    v_mfma_f32_16x16x32_bf16 v[144:147], a[72:75], a[40:43], v[144:147]
    v_exp_f32 v177, v177
    v_mfma_f32_16x16x32_bf16 v[144:147], a[76:79], a[44:47], v[144:147]
    ds_read_b64_tr_b16 a[116:117], v229 offset:16384
    v_cvt_pk_bf16_f32 v176, v176, v177
    v_mfma_f32_16x16x32_bf16 v[148:151], a[80:83], a[32:35], v[200:203]
    v_exp_f32 v178, v178
    v_mfma_f32_16x16x32_bf16 v[148:151], a[84:87], a[36:39], v[148:151]
    v_and_b32 v250, 0x300, v242
    v_lshl_add_u32 v250, v250, 2, v247
    v_mfma_f32_16x16x32_bf16 v[148:151], a[88:91], a[40:43], v[148:151]
    v_exp_f32 v179, v179
    v_mfma_f32_16x16x32_bf16 v[148:151], a[92:95], a[44:47], v[148:151]
    ds_read_b64_tr_b16 a[118:119], v229 offset:20480
    v_cvt_pk_bf16_f32 v177, v178, v179
    v_mfma_f32_16x16x32_bf16 v[152:155], a[64:67], a[48:51], v[204:207]
    v_exp_f32 v180, v180
    v_mfma_f32_16x16x32_bf16 v[152:155], a[68:71], a[52:55], v[152:155]
    ds_read_b64_tr_b16 a[120:121], v230 offset:16384
    ds_read_b64_tr_b16 a[122:123], v230 offset:20480
    v_mfma_f32_16x16x32_bf16 v[152:155], a[72:75], a[56:59], v[152:155]
    v_exp_f32 v181, v181
    v_mfma_f32_16x16x32_bf16 v[152:155], a[76:79], a[60:63], v[152:155]
    ds_read_b64_tr_b16 a[124:125], v231 offset:16384
    v_cvt_pk_bf16_f32 v178, v180, v181
    v_mfma_f32_16x16x32_bf16 v[156:159], a[80:83], a[48:51], v[204:207]
    v_exp_f32 v182, v182
    v_mfma_f32_16x16x32_bf16 v[156:159], a[84:87], a[52:55], v[156:159]
    s_lshl_b32 s59, s3, 14
    v_add_u32 v250, s59, v250
    v_add_u32 v252, 6144, v250
    v_mfma_f32_16x16x32_bf16 v[156:159], a[88:91], a[56:59], v[156:159]
    v_exp_f32 v183, v183
    v_mfma_f32_16x16x32_bf16 v[156:159], a[92:95], a[60:63], v[156:159]
    s_waitcnt lgkmcnt(7)
    ds_read_b64_tr_b16 a[126:127], v231 offset:20480
    v_cvt_pk_bf16_f32 v179, v182, v183
    v_mfma_f32_16x16x32_bf16 v[0:3], a[96:99], v[160:163], v[0:3]
    v_exp_f32 v184, v184
    v_mfma_f32_16x16x32_bf16 v[4:7], a[100:103], v[160:163], v[4:7]
    buffer_store_dword v248, v249, s[8:11], s67 offen sc1
    v_mfma_f32_16x16x32_bf16 v[8:11], a[104:107], v[160:163], v[8:11]
    v_exp_f32 v185, v185
    v_mfma_f32_16x16x32_bf16 v[12:15], a[108:111], v[160:163], v[12:15]
    s_waitcnt lgkmcnt(0)
    ds_read_b128 a[64:67], v232 offset:32768
    v_cvt_pk_bf16_f32 v184, v184, v185
    v_mfma_f32_16x16x32_bf16 v[16:19], a[112:115], v[160:163], v[16:19]
    v_exp_f32 v186, v186
    v_mfma_f32_16x16x32_bf16 v[20:23], a[116:119], v[160:163], v[20:23]
    v_mfma_f32_16x16x32_bf16 v[24:27], a[120:123], v[160:163], v[24:27]
    v_exp_f32 v187, v187
    v_mfma_f32_16x16x32_bf16 v[28:31], a[124:127], v[160:163], v[28:31]
    ds_read_b128 a[68:71], v233 offset:32768
    v_cvt_pk_bf16_f32 v185, v186, v187
    v_mfma_f32_16x16x32_bf16 a[240:243], v[220:223], v[160:163], a[240:243]
    v_exp_f32 v188, v188
    v_mfma_f32_16x16x32_bf16 v[32:35], a[96:99], v[168:171], v[32:35]
    v_mfma_f32_16x16x32_bf16 v[36:39], a[100:103], v[168:171], v[36:39]
    v_exp_f32 v189, v189
    v_mfma_f32_16x16x32_bf16 v[40:43], a[104:107], v[168:171], v[40:43]
    ds_read_b128 a[72:75], v234 offset:32768
    v_cvt_pk_bf16_f32 v186, v188, v189
    v_mfma_f32_16x16x32_bf16 v[44:47], a[108:111], v[168:171], v[44:47]
    v_exp_f32 v190, v190
    v_mfma_f32_16x16x32_bf16 v[48:51], a[112:115], v[168:171], v[48:51]
    v_mfma_f32_16x16x32_bf16 v[52:55], a[116:119], v[168:171], v[52:55]
    v_exp_f32 v191, v191
    v_mfma_f32_16x16x32_bf16 v[56:59], a[120:123], v[168:171], v[56:59]
    ds_read_b128 a[76:79], v235 offset:32768
    v_cvt_pk_bf16_f32 v187, v190, v191
    v_mfma_f32_16x16x32_bf16 v[60:63], a[124:127], v[168:171], v[60:63]
    v_mfma_f32_16x16x32_bf16 a[244:247], v[220:223], v[168:171], a[244:247]
    v_mfma_f32_16x16x32_bf16 v[64:67], a[96:99], v[176:179], v[64:67]
    v_exp_f32 v128, v128
    v_mfma_f32_16x16x32_bf16 v[68:71], a[100:103], v[176:179], v[68:71]
    v_mfma_f32_16x16x32_bf16 v[72:75], a[104:107], v[176:179], v[72:75]
    v_exp_f32 v129, v129
    v_mfma_f32_16x16x32_bf16 v[76:79], a[108:111], v[176:179], v[76:79]
    ds_read_b128 a[80:83], v232 offset:36864
    v_cvt_pk_bf16_f32 v128, v128, v129
    v_mfma_f32_16x16x32_bf16 v[80:83], a[112:115], v[176:179], v[80:83]
    v_exp_f32 v130, v130
    v_mfma_f32_16x16x32_bf16 v[84:87], a[116:119], v[176:179], v[84:87]
    v_mfma_f32_16x16x32_bf16 v[88:91], a[120:123], v[176:179], v[88:91]
    v_exp_f32 v131, v131
    v_mfma_f32_16x16x32_bf16 v[92:95], a[124:127], v[176:179], v[92:95]
    ds_read_b128 a[84:87], v233 offset:36864
    v_cvt_pk_bf16_f32 v129, v130, v131
    v_mfma_f32_16x16x32_bf16 a[248:251], v[220:223], v[176:179], a[248:251]
    v_exp_f32 v132, v132
    v_mfma_f32_16x16x32_bf16 v[96:99], a[96:99], v[184:187], v[96:99]
    v_mfma_f32_16x16x32_bf16 v[100:103], a[100:103], v[184:187], v[100:103]
    v_exp_f32 v133, v133
    v_mfma_f32_16x16x32_bf16 v[104:107], a[104:107], v[184:187], v[104:107]
    ds_read_b128 a[88:91], v234 offset:36864
    v_cvt_pk_bf16_f32 v130, v132, v133
    v_mfma_f32_16x16x32_bf16 v[108:111], a[108:111], v[184:187], v[108:111]
    v_exp_f32 v134, v134
    v_mfma_f32_16x16x32_bf16 v[112:115], a[112:115], v[184:187], v[112:115]
    v_mfma_f32_16x16x32_bf16 v[116:119], a[116:119], v[184:187], v[116:119]
    v_exp_f32 v135, v135
    v_mfma_f32_16x16x32_bf16 v[120:123], a[120:123], v[184:187], v[120:123]
    ds_read_b128 a[92:95], v235 offset:36864
    v_cvt_pk_bf16_f32 v131, v134, v135
    v_mfma_f32_16x16x32_bf16 v[124:127], a[124:127], v[184:187], v[124:127]
    v_mfma_f32_16x16x32_bf16 a[252:255], v[220:223], v[184:187], a[252:255]
    s_waitcnt lgkmcnt(4)
    v_mfma_f32_16x16x32_bf16 v[160:163], a[64:67], a[0:3], v[192:195]
    v_exp_f32 v136, v136
    v_mfma_f32_16x16x32_bf16 v[160:163], a[68:71], a[4:7], v[160:163]
    ds_read_b64_tr_b16 a[96:97], v224 offset:24576
    ds_read_b64_tr_b16 a[98:99], v224 offset:28672
    v_mfma_f32_16x16x32_bf16 v[160:163], a[72:75], a[8:11], v[160:163]
    v_exp_f32 v137, v137
    v_mfma_f32_16x16x32_bf16 v[160:163], a[76:79], a[12:15], v[160:163]
    s_waitcnt lgkmcnt(2)
    ds_read_b64_tr_b16 a[100:101], v225 offset:24576
    v_cvt_pk_bf16_f32 v136, v136, v137
    v_mfma_f32_16x16x32_bf16 v[164:167], a[80:83], a[0:3], v[192:195]
    v_exp_f32 v138, v138
    v_mfma_f32_16x16x32_bf16 v[164:167], a[84:87], a[4:7], v[164:167]
    s_lshl_b32 s59, s3, 14
    v_xor_b32 v247, 128, v250
    v_add_u32 v251, 3072, v247
    v_mfma_f32_16x16x32_bf16 v[164:167], a[88:91], a[8:11], v[164:167]
    v_exp_f32 v139, v139
    v_mfma_f32_16x16x32_bf16 v[164:167], a[92:95], a[12:15], v[164:167]
    ds_read_b64_tr_b16 a[102:103], v225 offset:28672
    v_cvt_pk_bf16_f32 v137, v138, v139
    v_mfma_f32_16x16x32_bf16 v[168:171], a[64:67], a[16:19], v[196:199]
    v_exp_f32 v140, v140
    v_mfma_f32_16x16x32_bf16 v[168:171], a[68:71], a[20:23], v[168:171]
    ds_read_b64_tr_b16 a[104:105], v226 offset:24576
    ds_read_b64_tr_b16 a[106:107], v226 offset:28672
    v_mfma_f32_16x16x32_bf16 v[168:171], a[72:75], a[24:27], v[168:171]
    v_exp_f32 v141, v141
    v_mfma_f32_16x16x32_bf16 v[168:171], a[76:79], a[28:31], v[168:171]
    ds_read_b64_tr_b16 a[108:109], v227 offset:24576
    v_cvt_pk_bf16_f32 v138, v140, v141
    v_mfma_f32_16x16x32_bf16 v[172:175], a[80:83], a[16:19], v[196:199]
    v_exp_f32 v142, v142
    v_mfma_f32_16x16x32_bf16 v[172:175], a[84:87], a[20:23], v[172:175]
    v_add_u32 v253, 9216, v247
    v_lshrrev_b32 v247, 3, v242
    v_mfma_f32_16x16x32_bf16 v[172:175], a[88:91], a[24:27], v[172:175]
    v_exp_f32 v143, v143
    v_mfma_f32_16x16x32_bf16 v[172:175], a[92:95], a[28:31], v[172:175]
    ds_read_b64_tr_b16 a[110:111], v227 offset:28672
    v_cvt_pk_bf16_f32 v139, v142, v143
    v_mfma_f32_16x16x32_bf16 v[176:179], a[64:67], a[32:35], v[200:203]
    v_exp_f32 v144, v144
    v_mfma_f32_16x16x32_bf16 v[176:179], a[68:71], a[36:39], v[176:179]
    ds_read_b64_tr_b16 a[112:113], v228 offset:24576
    ds_read_b64_tr_b16 a[114:115], v228 offset:28672
    v_mfma_f32_16x16x32_bf16 v[176:179], a[72:75], a[40:43], v[176:179]
    v_exp_f32 v145, v145
    v_mfma_f32_16x16x32_bf16 v[176:179], a[76:79], a[44:47], v[176:179]
    ds_read_b64_tr_b16 a[116:117], v229 offset:24576
    v_cvt_pk_bf16_f32 v144, v144, v145
    v_mfma_f32_16x16x32_bf16 v[180:183], a[80:83], a[32:35], v[200:203]
    v_exp_f32 v146, v146
    v_mfma_f32_16x16x32_bf16 v[180:183], a[84:87], a[36:39], v[180:183]
    v_and_b32 v247, 0x20, v247
    v_xor_b32 v247, v247, v242
    v_mfma_f32_16x16x32_bf16 v[180:183], a[88:91], a[40:43], v[180:183]
    v_exp_f32 v147, v147
    v_mfma_f32_16x16x32_bf16 v[180:183], a[92:95], a[44:47], v[180:183]
    ds_read_b64_tr_b16 a[118:119], v229 offset:28672
    v_cvt_pk_bf16_f32 v145, v146, v147
    v_mfma_f32_16x16x32_bf16 v[184:187], a[64:67], a[48:51], v[204:207]
    v_exp_f32 v148, v148
    v_mfma_f32_16x16x32_bf16 v[184:187], a[68:71], a[52:55], v[184:187]
    ds_read_b64_tr_b16 a[120:121], v230 offset:24576
    ds_read_b64_tr_b16 a[122:123], v230 offset:28672
    v_mfma_f32_16x16x32_bf16 v[184:187], a[72:75], a[56:59], v[184:187]
    v_exp_f32 v149, v149
    v_mfma_f32_16x16x32_bf16 v[184:187], a[76:79], a[60:63], v[184:187]
    ds_read_b64_tr_b16 a[124:125], v231 offset:24576
    v_cvt_pk_bf16_f32 v146, v148, v149
    v_mfma_f32_16x16x32_bf16 v[188:191], a[80:83], a[48:51], v[204:207]
    v_exp_f32 v150, v150
    v_mfma_f32_16x16x32_bf16 v[188:191], a[84:87], a[52:55], v[188:191]
    v_and_b32 v247, 0x30, v247
    v_and_b32 v254, 0x3c0, v242
    v_mfma_f32_16x16x32_bf16 v[188:191], a[88:91], a[56:59], v[188:191]
    v_exp_f32 v151, v151
    v_mfma_f32_16x16x32_bf16 v[188:191], a[92:95], a[60:63], v[188:191]
    s_waitcnt lgkmcnt(7)
    ds_read_b64_tr_b16 a[126:127], v231 offset:28672
    v_cvt_pk_bf16_f32 v147, v150, v151
    v_mfma_f32_16x16x32_bf16 v[0:3], a[96:99], v[128:131], v[0:3]
    v_exp_f32 v152, v152
    v_mfma_f32_16x16x32_bf16 v[4:7], a[100:103], v[128:131], v[4:7]
    v_lshl_add_u32 v254, v254, 4, v247
    v_add_u32 v254, s59, v254
    v_mfma_f32_16x16x32_bf16 v[8:11], a[104:107], v[128:131], v[8:11]
    v_exp_f32 v153, v153
    v_mfma_f32_16x16x32_bf16 v[12:15], a[108:111], v[128:131], v[12:15]
    s_waitcnt lgkmcnt(0)
    ds_read_b128 a[64:67], v232 offset:40960
    v_cvt_pk_bf16_f32 v152, v152, v153
    v_mfma_f32_16x16x32_bf16 v[16:19], a[112:115], v[128:131], v[16:19]
    v_exp_f32 v154, v154
    v_mfma_f32_16x16x32_bf16 v[20:23], a[116:119], v[128:131], v[20:23]
    s_add_u32 m0, s57, 98304
    s_mov_b32 s56, 65536
    buffer_load_dwordx4 v236, s[20:23], s56 offen offset:0 lds
    v_mfma_f32_16x16x32_bf16 v[24:27], a[120:123], v[128:131], v[24:27]
    v_exp_f32 v155, v155
    v_mfma_f32_16x16x32_bf16 v[28:31], a[124:127], v[128:131], v[28:31]
    ds_read_b128 a[68:71], v233 offset:40960
    v_cvt_pk_bf16_f32 v153, v154, v155
    v_mfma_f32_16x16x32_bf16 a[240:243], v[220:223], v[128:131], a[240:243]
    v_exp_f32 v156, v156
    v_mfma_f32_16x16x32_bf16 v[32:35], a[96:99], v[136:139], v[32:35]
    buffer_load_dwordx4 v237, s[20:23], s56 offen offset:1024 lds
    v_mfma_f32_16x16x32_bf16 v[36:39], a[100:103], v[136:139], v[36:39]
    v_exp_f32 v157, v157
    v_mfma_f32_16x16x32_bf16 v[40:43], a[104:107], v[136:139], v[40:43]
    ds_read_b128 a[72:75], v234 offset:40960
    v_cvt_pk_bf16_f32 v154, v156, v157
    v_mfma_f32_16x16x32_bf16 v[44:47], a[108:111], v[136:139], v[44:47]
    v_exp_f32 v158, v158
    v_mfma_f32_16x16x32_bf16 v[48:51], a[112:115], v[136:139], v[48:51]
    buffer_load_dwordx4 v238, s[20:23], s56 offen offset:2048 lds
    v_mfma_f32_16x16x32_bf16 v[52:55], a[116:119], v[136:139], v[52:55]
    v_exp_f32 v159, v159
    v_mfma_f32_16x16x32_bf16 v[56:59], a[120:123], v[136:139], v[56:59]
    ds_read_b128 a[76:79], v235 offset:40960
    v_cvt_pk_bf16_f32 v155, v158, v159
    v_mfma_f32_16x16x32_bf16 v[60:63], a[124:127], v[136:139], v[60:63]
    buffer_load_dwordx4 v239, s[20:23], s56 offen offset:3072 lds
    v_mfma_f32_16x16x32_bf16 a[244:247], v[220:223], v[136:139], a[244:247]
    v_mfma_f32_16x16x32_bf16 v[64:67], a[96:99], v[144:147], v[64:67]
    v_exp_f32 v160, v160
    v_mfma_f32_16x16x32_bf16 v[68:71], a[100:103], v[144:147], v[68:71]
    s_add_u32 m0, s57, 0
    s_mov_b32 s56, 65536
    buffer_load_dwordx4 v240, s[24:27], s56 offen offset:0 lds
    v_mfma_f32_16x16x32_bf16 v[72:75], a[104:107], v[144:147], v[72:75]
    v_exp_f32 v161, v161
    v_mfma_f32_16x16x32_bf16 v[76:79], a[108:111], v[144:147], v[76:79]
    ds_read_b128 a[80:83], v232 offset:45056
    v_cvt_pk_bf16_f32 v160, v160, v161
    v_mfma_f32_16x16x32_bf16 v[80:83], a[112:115], v[144:147], v[80:83]
    v_exp_f32 v162, v162
    v_mfma_f32_16x16x32_bf16 v[84:87], a[116:119], v[144:147], v[84:87]
    buffer_load_dwordx4 v241, s[24:27], s56 offen offset:1024 lds
    v_mfma_f32_16x16x32_bf16 v[88:91], a[120:123], v[144:147], v[88:91]
    v_exp_f32 v163, v163
    v_mfma_f32_16x16x32_bf16 v[92:95], a[124:127], v[144:147], v[92:95]
    ds_read_b128 a[84:87], v233 offset:45056
    v_cvt_pk_bf16_f32 v161, v162, v163
    v_mfma_f32_16x16x32_bf16 a[248:251], v[220:223], v[144:147], a[248:251]
    v_exp_f32 v164, v164
    v_mfma_f32_16x16x32_bf16 v[96:99], a[96:99], v[152:155], v[96:99]
    buffer_load_dwordx4 v240, s[24:27], s56 offen offset:2048 lds
    v_mfma_f32_16x16x32_bf16 v[100:103], a[100:103], v[152:155], v[100:103]
    v_exp_f32 v165, v165
    v_mfma_f32_16x16x32_bf16 v[104:107], a[104:107], v[152:155], v[104:107]
    ds_read_b128 a[88:91], v234 offset:45056
    v_cvt_pk_bf16_f32 v162, v164, v165
    v_mfma_f32_16x16x32_bf16 v[108:111], a[108:111], v[152:155], v[108:111]
    v_exp_f32 v166, v166
    v_mfma_f32_16x16x32_bf16 v[112:115], a[112:115], v[152:155], v[112:115]
    buffer_load_dwordx4 v241, s[24:27], s56 offen offset:3072 lds
    v_mfma_f32_16x16x32_bf16 v[116:119], a[116:119], v[152:155], v[116:119]
    v_exp_f32 v167, v167
    v_mfma_f32_16x16x32_bf16 v[120:123], a[120:123], v[152:155], v[120:123]
    ds_read_b128 a[92:95], v235 offset:45056
    v_cvt_pk_bf16_f32 v163, v166, v167
    v_mfma_f32_16x16x32_bf16 v[124:127], a[124:127], v[152:155], v[124:127]
    s_add_u32 m0, s81, 65536
    s_mov_b32 s55, 0
    buffer_load_dwordx4 v254, s[32:35], s55 offen lds
    v_mfma_f32_16x16x32_bf16 a[252:255], v[220:223], v[152:155], a[252:255]
    s_waitcnt lgkmcnt(4)
    v_mfma_f32_16x16x32_bf16 v[128:131], a[64:67], a[0:3], v[192:195]
    v_exp_f32 v168, v168
    v_mfma_f32_16x16x32_bf16 v[128:131], a[68:71], a[4:7], v[128:131]
    ds_read_b64_tr_b16 a[96:97], v224 offset:32768
    ds_read_b64_tr_b16 a[98:99], v224 offset:36864
    v_mfma_f32_16x16x32_bf16 v[128:131], a[72:75], a[8:11], v[128:131]
    v_exp_f32 v169, v169
    v_mfma_f32_16x16x32_bf16 v[128:131], a[76:79], a[12:15], v[128:131]
    s_waitcnt vmcnt(13) lgkmcnt(2)
    s_barrier
    ds_read_b64_tr_b16 a[100:101], v225 offset:32768
    v_cvt_pk_bf16_f32 v168, v168, v169
    v_mfma_f32_16x16x32_bf16 v[132:135], a[80:83], a[0:3], v[192:195]
    v_exp_f32 v170, v170
    v_mfma_f32_16x16x32_bf16 v[132:135], a[84:87], a[4:7], v[132:135]
    v_and_b32 v247, 0xf0, v242
    v_lshrrev_b32 v255, 8, v242
    v_mfma_f32_16x16x32_bf16 v[132:135], a[88:91], a[8:11], v[132:135]
    v_exp_f32 v171, v171
    v_mfma_f32_16x16x32_bf16 v[132:135], a[92:95], a[12:15], v[132:135]
    ds_read_b64_tr_b16 a[102:103], v225 offset:36864
    v_cvt_pk_bf16_f32 v169, v170, v171
    v_mfma_f32_16x16x32_bf16 v[136:139], a[64:67], a[16:19], v[196:199]
    v_exp_f32 v172, v172
    v_mfma_f32_16x16x32_bf16 v[136:139], a[68:71], a[20:23], v[136:139]
    ds_read_b64_tr_b16 a[104:105], v226 offset:32768
    ds_read_b64_tr_b16 a[106:107], v226 offset:36864
    v_mfma_f32_16x16x32_bf16 v[136:139], a[72:75], a[24:27], v[136:139]
    v_exp_f32 v173, v173
    v_mfma_f32_16x16x32_bf16 v[136:139], a[76:79], a[28:31], v[136:139]
    ds_read_b64_tr_b16 a[108:109], v227 offset:32768
    v_cvt_pk_bf16_f32 v170, v172, v173
    v_mfma_f32_16x16x32_bf16 v[140:143], a[80:83], a[16:19], v[196:199]
    v_exp_f32 v174, v174
    v_mfma_f32_16x16x32_bf16 v[140:143], a[84:87], a[20:23], v[140:143]
    v_lshlrev_b32 v255, 3, v255
    v_lshl_add_u32 v255, v247, 6, v255
    v_mfma_f32_16x16x32_bf16 v[140:143], a[88:91], a[24:27], v[140:143]
    v_exp_f32 v175, v175
    v_mfma_f32_16x16x32_bf16 v[140:143], a[92:95], a[28:31], v[140:143]
    ds_read_b64_tr_b16 a[110:111], v227 offset:36864
    v_cvt_pk_bf16_f32 v171, v174, v175
    v_mfma_f32_16x16x32_bf16 v[144:147], a[64:67], a[32:35], v[200:203]
    v_exp_f32 v176, v176
    v_mfma_f32_16x16x32_bf16 v[144:147], a[68:71], a[36:39], v[144:147]
    ds_read_b64_tr_b16 a[112:113], v228 offset:32768
    ds_read_b64_tr_b16 a[114:115], v228 offset:36864
    v_mfma_f32_16x16x32_bf16 v[144:147], a[72:75], a[40:43], v[144:147]
    v_exp_f32 v177, v177
    v_mfma_f32_16x16x32_bf16 v[144:147], a[76:79], a[44:47], v[144:147]
    ds_read_b64_tr_b16 a[116:117], v229 offset:32768
    v_cvt_pk_bf16_f32 v176, v176, v177
    v_mfma_f32_16x16x32_bf16 v[148:151], a[80:83], a[32:35], v[200:203]
    v_exp_f32 v178, v178
    v_mfma_f32_16x16x32_bf16 v[148:151], a[84:87], a[36:39], v[148:151]
    s_add_u32 m0, s81, 69632
    s_mov_b32 s55, 65536
    buffer_load_dwordx4 v254, s[32:35], s55 offen lds
    v_mfma_f32_16x16x32_bf16 v[148:151], a[88:91], a[40:43], v[148:151]
    v_exp_f32 v179, v179
    v_mfma_f32_16x16x32_bf16 v[148:151], a[92:95], a[44:47], v[148:151]
    ds_read_b64_tr_b16 a[118:119], v229 offset:36864
    v_cvt_pk_bf16_f32 v177, v178, v179
    v_mfma_f32_16x16x32_bf16 v[152:155], a[64:67], a[48:51], v[204:207]
    v_exp_f32 v180, v180
    v_mfma_f32_16x16x32_bf16 v[152:155], a[68:71], a[52:55], v[152:155]
    ds_read_b64_tr_b16 a[120:121], v230 offset:32768
    ds_read_b64_tr_b16 a[122:123], v230 offset:36864
    v_mfma_f32_16x16x32_bf16 v[152:155], a[72:75], a[56:59], v[152:155]
    v_exp_f32 v181, v181
    v_mfma_f32_16x16x32_bf16 v[152:155], a[76:79], a[60:63], v[152:155]
    ds_read_b64_tr_b16 a[124:125], v231 offset:32768
    v_cvt_pk_bf16_f32 v178, v180, v181
    v_mfma_f32_16x16x32_bf16 v[156:159], a[80:83], a[48:51], v[204:207]
    v_exp_f32 v182, v182
    v_mfma_f32_16x16x32_bf16 v[156:159], a[84:87], a[52:55], v[156:159]
    s_add_u32 m0, s81, 73728
    s_mov_b32 s55, 131072
    buffer_load_dwordx4 v254, s[32:35], s55 offen lds
    v_mfma_f32_16x16x32_bf16 v[156:159], a[88:91], a[56:59], v[156:159]
    v_exp_f32 v183, v183
    v_mfma_f32_16x16x32_bf16 v[156:159], a[92:95], a[60:63], v[156:159]
    s_waitcnt lgkmcnt(7)
    ds_read_b64_tr_b16 a[126:127], v231 offset:36864
    v_cvt_pk_bf16_f32 v179, v182, v183
    v_mfma_f32_16x16x32_bf16 v[0:3], a[96:99], v[160:163], v[0:3]
    v_exp_f32 v184, v184
    v_mfma_f32_16x16x32_bf16 v[4:7], a[100:103], v[160:163], v[4:7]
    buffer_load_dword v213, v212, s[8:11], s68 offen sc1
    v_mfma_f32_16x16x32_bf16 v[8:11], a[104:107], v[160:163], v[8:11]
    v_exp_f32 v185, v185
    v_mfma_f32_16x16x32_bf16 v[12:15], a[108:111], v[160:163], v[12:15]
    s_waitcnt lgkmcnt(0)
    ds_read_b128 a[64:67], v232 offset:49152
    v_cvt_pk_bf16_f32 v184, v184, v185
    v_mfma_f32_16x16x32_bf16 v[16:19], a[112:115], v[160:163], v[16:19]
    v_exp_f32 v186, v186
    v_mfma_f32_16x16x32_bf16 v[20:23], a[116:119], v[160:163], v[20:23]
    s_add_u32 m0, s81, 77824
    s_mov_b32 s55, 196608
    buffer_load_dwordx4 v254, s[32:35], s55 offen lds
    v_mfma_f32_16x16x32_bf16 v[24:27], a[120:123], v[160:163], v[24:27]
    v_exp_f32 v187, v187
    v_mfma_f32_16x16x32_bf16 v[28:31], a[124:127], v[160:163], v[28:31]
    ds_read_b128 a[68:71], v233 offset:49152
    v_cvt_pk_bf16_f32 v185, v186, v187
    v_mfma_f32_16x16x32_bf16 a[240:243], v[220:223], v[160:163], a[240:243]
    v_exp_f32 v188, v188
    v_mfma_f32_16x16x32_bf16 v[32:35], a[96:99], v[168:171], v[32:35]
    s_add_u32 m0, s81, 81920
    s_mov_b32 s55, 262144
    buffer_load_dwordx4 v254, s[32:35], s55 offen lds
    v_mfma_f32_16x16x32_bf16 v[36:39], a[100:103], v[168:171], v[36:39]
    v_exp_f32 v189, v189
    v_mfma_f32_16x16x32_bf16 v[40:43], a[104:107], v[168:171], v[40:43]
    ds_read_b128 a[72:75], v234 offset:49152
    v_cvt_pk_bf16_f32 v186, v188, v189
    v_mfma_f32_16x16x32_bf16 v[44:47], a[108:111], v[168:171], v[44:47]
    v_exp_f32 v190, v190
    v_mfma_f32_16x16x32_bf16 v[48:51], a[112:115], v[168:171], v[48:51]
    s_add_u32 m0, s81, 86016
    s_mov_b32 s55, 327680
    buffer_load_dwordx4 v254, s[32:35], s55 offen lds
    v_mfma_f32_16x16x32_bf16 v[52:55], a[116:119], v[168:171], v[52:55]
    v_exp_f32 v191, v191
    v_mfma_f32_16x16x32_bf16 v[56:59], a[120:123], v[168:171], v[56:59]
    ds_read_b128 a[76:79], v235 offset:49152
    v_cvt_pk_bf16_f32 v187, v190, v191
    v_mfma_f32_16x16x32_bf16 v[60:63], a[124:127], v[168:171], v[60:63]
    s_add_u32 m0, s81, 90112
    s_mov_b32 s55, 393216
    buffer_load_dwordx4 v254, s[32:35], s55 offen lds
    v_mfma_f32_16x16x32_bf16 a[244:247], v[220:223], v[168:171], a[244:247]
    v_mfma_f32_16x16x32_bf16 v[64:67], a[96:99], v[176:179], v[64:67]
    v_exp_f32 v128, v128
    v_mfma_f32_16x16x32_bf16 v[68:71], a[100:103], v[176:179], v[68:71]
    s_add_u32 m0, s81, 94208
    s_mov_b32 s55, 458752
    buffer_load_dwordx4 v254, s[32:35], s55 offen lds
    v_mfma_f32_16x16x32_bf16 v[72:75], a[104:107], v[176:179], v[72:75]
    v_exp_f32 v129, v129
    v_mfma_f32_16x16x32_bf16 v[76:79], a[108:111], v[176:179], v[76:79]
    ds_read_b128 a[80:83], v232 offset:53248
    v_cvt_pk_bf16_f32 v128, v128, v129
    v_mfma_f32_16x16x32_bf16 v[80:83], a[112:115], v[176:179], v[80:83]
    v_exp_f32 v130, v130
    v_mfma_f32_16x16x32_bf16 v[84:87], a[116:119], v[176:179], v[84:87]
    s_add_u32 m0, s57, 114688
    s_mov_b32 s56, 81920
    buffer_load_dwordx4 v236, s[20:23], s56 offen offset:0 lds
    v_mfma_f32_16x16x32_bf16 v[88:91], a[120:123], v[176:179], v[88:91]
    v_exp_f32 v131, v131
    v_mfma_f32_16x16x32_bf16 v[92:95], a[124:127], v[176:179], v[92:95]
    ds_read_b128 a[84:87], v233 offset:53248
    v_cvt_pk_bf16_f32 v129, v130, v131
    v_mfma_f32_16x16x32_bf16 a[248:251], v[220:223], v[176:179], a[248:251]
    v_exp_f32 v132, v132
    v_mfma_f32_16x16x32_bf16 v[96:99], a[96:99], v[184:187], v[96:99]
    buffer_load_dwordx4 v237, s[20:23], s56 offen offset:1024 lds
    v_mfma_f32_16x16x32_bf16 v[100:103], a[100:103], v[184:187], v[100:103]
    v_exp_f32 v133, v133
    v_mfma_f32_16x16x32_bf16 v[104:107], a[104:107], v[184:187], v[104:107]
    ds_read_b128 a[88:91], v234 offset:53248
    v_cvt_pk_bf16_f32 v130, v132, v133
    v_mfma_f32_16x16x32_bf16 v[108:111], a[108:111], v[184:187], v[108:111]
    v_exp_f32 v134, v134
    v_mfma_f32_16x16x32_bf16 v[112:115], a[112:115], v[184:187], v[112:115]
    buffer_load_dwordx4 v238, s[20:23], s56 offen offset:2048 lds
    v_mfma_f32_16x16x32_bf16 v[116:119], a[116:119], v[184:187], v[116:119]
    v_exp_f32 v135, v135
    v_mfma_f32_16x16x32_bf16 v[120:123], a[120:123], v[184:187], v[120:123]
    ds_read_b128 a[92:95], v235 offset:53248
    v_cvt_pk_bf16_f32 v131, v134, v135
    v_mfma_f32_16x16x32_bf16 v[124:127], a[124:127], v[184:187], v[124:127]
    buffer_load_dwordx4 v239, s[20:23], s56 offen offset:3072 lds
    v_mfma_f32_16x16x32_bf16 a[252:255], v[220:223], v[184:187], a[252:255]
    s_waitcnt lgkmcnt(4)
    v_mfma_f32_16x16x32_bf16 v[160:163], a[64:67], a[0:3], v[192:195]
    v_exp_f32 v136, v136
    v_mfma_f32_16x16x32_bf16 v[160:163], a[68:71], a[4:7], v[160:163]
    ds_read_b64_tr_b16 a[96:97], v224 offset:40960
    ds_read_b64_tr_b16 a[98:99], v224 offset:45056
    v_mfma_f32_16x16x32_bf16 v[160:163], a[72:75], a[8:11], v[160:163]
    v_exp_f32 v137, v137
    v_mfma_f32_16x16x32_bf16 v[160:163], a[76:79], a[12:15], v[160:163]
    s_waitcnt lgkmcnt(2)
    ds_read_b64_tr_b16 a[100:101], v225 offset:40960
    v_cvt_pk_bf16_f32 v136, v136, v137
    v_mfma_f32_16x16x32_bf16 v[164:167], a[80:83], a[0:3], v[192:195]
    v_exp_f32 v138, v138
    v_mfma_f32_16x16x32_bf16 v[164:167], a[84:87], a[4:7], v[164:167]
    v_lshrrev_b32 v247, 1, v242
    v_and_b32 v247, 0x18, v247
    v_mfma_f32_16x16x32_bf16 v[164:167], a[88:91], a[8:11], v[164:167]
    v_exp_f32 v139, v139
    v_mfma_f32_16x16x32_bf16 v[164:167], a[92:95], a[12:15], v[164:167]
    ds_read_b64_tr_b16 a[102:103], v225 offset:45056
    v_cvt_pk_bf16_f32 v137, v138, v139
    v_mfma_f32_16x16x32_bf16 v[168:171], a[64:67], a[16:19], v[196:199]
    v_exp_f32 v140, v140
    v_mfma_f32_16x16x32_bf16 v[168:171], a[68:71], a[20:23], v[168:171]
    ds_read_b64_tr_b16 a[104:105], v226 offset:40960
    ds_read_b64_tr_b16 a[106:107], v226 offset:45056
    v_mfma_f32_16x16x32_bf16 v[168:171], a[72:75], a[24:27], v[168:171]
    v_exp_f32 v141, v141
    v_mfma_f32_16x16x32_bf16 v[168:171], a[76:79], a[28:31], v[168:171]
    ds_read_b64_tr_b16 a[108:109], v227 offset:40960
    v_cvt_pk_bf16_f32 v138, v140, v141
    v_mfma_f32_16x16x32_bf16 v[172:175], a[80:83], a[16:19], v[196:199]
    v_exp_f32 v142, v142
    v_mfma_f32_16x16x32_bf16 v[172:175], a[84:87], a[20:23], v[172:175]
    v_lshrrev_b32 v208, 3, v242
    v_and_b32 v208, 0x20, v208
    v_mfma_f32_16x16x32_bf16 v[172:175], a[88:91], a[24:27], v[172:175]
    v_exp_f32 v143, v143
    v_mfma_f32_16x16x32_bf16 v[172:175], a[92:95], a[28:31], v[172:175]
    ds_read_b64_tr_b16 a[110:111], v227 offset:45056
    v_cvt_pk_bf16_f32 v139, v142, v143
    s_waitcnt vmcnt(9)
    v_cmp_ne_u32 vcc, s64, v213
    s_cbranch_vccnz h2_spin
h2_ok:
    v_mfma_f32_16x16x32_bf16 v[176:179], a[64:67], a[32:35], v[200:203]
    v_exp_f32 v144, v144
    v_mfma_f32_16x16x32_bf16 v[176:179], a[68:71], a[36:39], v[176:179]
    ds_read_b64_tr_b16 a[112:113], v228 offset:40960
    ds_read_b64_tr_b16 a[114:115], v228 offset:45056
    v_mfma_f32_16x16x32_bf16 v[176:179], a[72:75], a[40:43], v[176:179]
    v_exp_f32 v145, v145
    v_mfma_f32_16x16x32_bf16 v[176:179], a[76:79], a[44:47], v[176:179]
    ds_read_b64_tr_b16 a[116:117], v229 offset:40960
    v_cvt_pk_bf16_f32 v144, v144, v145
    v_mfma_f32_16x16x32_bf16 v[180:183], a[80:83], a[32:35], v[200:203]
    v_exp_f32 v146, v146
    v_mfma_f32_16x16x32_bf16 v[180:183], a[84:87], a[36:39], v[180:183]
    v_xor_b32 v247, v247, v208
    v_and_b32 v210, 0x3c0, v242
    v_mfma_f32_16x16x32_bf16 v[180:183], a[88:91], a[40:43], v[180:183]
    v_exp_f32 v147, v147
    v_mfma_f32_16x16x32_bf16 v[180:183], a[92:95], a[44:47], v[180:183]
    ds_read_b64_tr_b16 a[118:119], v229 offset:45056
    v_cvt_pk_bf16_f32 v145, v146, v147
    v_mfma_f32_16x16x32_bf16 v[184:187], a[64:67], a[48:51], v[204:207]
    v_exp_f32 v148, v148
    v_mfma_f32_16x16x32_bf16 v[184:187], a[68:71], a[52:55], v[184:187]
    ds_read_b64_tr_b16 a[120:121], v230 offset:40960
    ds_read_b64_tr_b16 a[122:123], v230 offset:45056
    v_mfma_f32_16x16x32_bf16 v[184:187], a[72:75], a[56:59], v[184:187]
    v_exp_f32 v149, v149
    v_mfma_f32_16x16x32_bf16 v[184:187], a[76:79], a[60:63], v[184:187]
    ds_read_b64_tr_b16 a[124:125], v231 offset:40960
    v_cvt_pk_bf16_f32 v146, v148, v149
    v_mfma_f32_16x16x32_bf16 v[188:191], a[80:83], a[48:51], v[204:207]
    v_exp_f32 v150, v150
    v_mfma_f32_16x16x32_bf16 v[188:191], a[84:87], a[52:55], v[188:191]
    v_add_u32 v210, v210, v247
    v_xor_b32 v211, 32, v210
    v_mfma_f32_16x16x32_bf16 v[188:191], a[88:91], a[56:59], v[188:191]
    v_exp_f32 v151, v151
    v_mfma_f32_16x16x32_bf16 v[188:191], a[92:95], a[60:63], v[188:191]
    s_waitcnt lgkmcnt(7)
    ds_read_b64_tr_b16 a[126:127], v231 offset:45056
    v_cvt_pk_bf16_f32 v147, v150, v151
    v_mfma_f32_16x16x32_bf16 v[0:3], a[96:99], v[128:131], v[0:3]
    v_exp_f32 v152, v152
    v_mfma_f32_16x16x32_bf16 v[4:7], a[100:103], v[128:131], v[4:7]
    v_add_u32 v208, 65536, v210
    v_add_u32 v209, 65536, v211
    v_mfma_f32_16x16x32_bf16 v[8:11], a[104:107], v[128:131], v[8:11]
    v_exp_f32 v153, v153
    v_mfma_f32_16x16x32_bf16 v[12:15], a[108:111], v[128:131], v[12:15]
    s_waitcnt lgkmcnt(0)
    ds_read_b128 a[64:67], v232 offset:57344
    v_cvt_pk_bf16_f32 v152, v152, v153
    v_mfma_f32_16x16x32_bf16 v[16:19], a[112:115], v[128:131], v[16:19]
    v_exp_f32 v154, v154
    v_mfma_f32_16x16x32_bf16 v[20:23], a[116:119], v[128:131], v[20:23]
    s_add_u32 m0, s57, 16384
    s_mov_b32 s56, 81920
    buffer_load_dwordx4 v240, s[24:27], s56 offen offset:0 lds
    v_mfma_f32_16x16x32_bf16 v[24:27], a[120:123], v[128:131], v[24:27]
    v_exp_f32 v155, v155
    v_mfma_f32_16x16x32_bf16 v[28:31], a[124:127], v[128:131], v[28:31]
    ds_read_b128 a[68:71], v233 offset:57344
    v_cvt_pk_bf16_f32 v153, v154, v155
    v_mfma_f32_16x16x32_bf16 a[240:243], v[220:223], v[128:131], a[240:243]
    v_exp_f32 v156, v156
    v_mfma_f32_16x16x32_bf16 v[32:35], a[96:99], v[136:139], v[32:35]
    buffer_load_dwordx4 v241, s[24:27], s56 offen offset:1024 lds
    v_mfma_f32_16x16x32_bf16 v[36:39], a[100:103], v[136:139], v[36:39]
    v_exp_f32 v157, v157
    v_mfma_f32_16x16x32_bf16 v[40:43], a[104:107], v[136:139], v[40:43]
    ds_read_b128 a[72:75], v234 offset:57344
    v_cvt_pk_bf16_f32 v154, v156, v157
    v_mfma_f32_16x16x32_bf16 v[44:47], a[108:111], v[136:139], v[44:47]
    v_exp_f32 v158, v158
    v_mfma_f32_16x16x32_bf16 v[48:51], a[112:115], v[136:139], v[48:51]
    buffer_load_dwordx4 v240, s[24:27], s56 offen offset:2048 lds
    v_mfma_f32_16x16x32_bf16 v[52:55], a[116:119], v[136:139], v[52:55]
    v_exp_f32 v159, v159
    v_mfma_f32_16x16x32_bf16 v[56:59], a[120:123], v[136:139], v[56:59]
    ds_read_b128 a[76:79], v235 offset:57344
    v_cvt_pk_bf16_f32 v155, v158, v159
    v_mfma_f32_16x16x32_bf16 v[60:63], a[124:127], v[136:139], v[60:63]
    buffer_load_dwordx4 v241, s[24:27], s56 offen offset:3072 lds
    v_mfma_f32_16x16x32_bf16 a[244:247], v[220:223], v[136:139], a[244:247]
    v_mfma_f32_16x16x32_bf16 v[64:67], a[96:99], v[144:147], v[64:67]
    v_exp_f32 v160, v160
    v_mfma_f32_16x16x32_bf16 v[68:71], a[100:103], v[144:147], v[68:71]
    buffer_load_dwordx4 a[128:131], v242, s[8:11], s53 offen offset:0 sc1
    v_mfma_f32_16x16x32_bf16 v[72:75], a[104:107], v[144:147], v[72:75]
    v_exp_f32 v161, v161
    v_mfma_f32_16x16x32_bf16 v[76:79], a[108:111], v[144:147], v[76:79]
    ds_read_b128 a[80:83], v232 offset:61440
    v_cvt_pk_bf16_f32 v160, v160, v161
    v_mfma_f32_16x16x32_bf16 v[80:83], a[112:115], v[144:147], v[80:83]
    v_exp_f32 v162, v162
    v_mfma_f32_16x16x32_bf16 v[84:87], a[116:119], v[144:147], v[84:87]
    buffer_load_dwordx4 a[132:135], v242, s[8:11], s65 offen offset:0 sc1
    v_mfma_f32_16x16x32_bf16 v[88:91], a[120:123], v[144:147], v[88:91]
    v_exp_f32 v163, v163
    v_mfma_f32_16x16x32_bf16 v[92:95], a[124:127], v[144:147], v[92:95]
    ds_read_b128 a[84:87], v233 offset:61440
    v_cvt_pk_bf16_f32 v161, v162, v163
    v_mfma_f32_16x16x32_bf16 a[248:251], v[220:223], v[144:147], a[248:251]
    v_exp_f32 v164, v164
    v_mfma_f32_16x16x32_bf16 v[96:99], a[96:99], v[152:155], v[96:99]
    buffer_load_dwordx4 a[136:139], v242, s[8:11], s53 offen offset:1024 sc1
    v_mfma_f32_16x16x32_bf16 v[100:103], a[100:103], v[152:155], v[100:103]
    v_exp_f32 v165, v165
    v_mfma_f32_16x16x32_bf16 v[104:107], a[104:107], v[152:155], v[104:107]
    ds_read_b128 a[88:91], v234 offset:61440
    v_cvt_pk_bf16_f32 v162, v164, v165
    v_mfma_f32_16x16x32_bf16 v[108:111], a[108:111], v[152:155], v[108:111]
    v_exp_f32 v166, v166
    v_mfma_f32_16x16x32_bf16 v[112:115], a[112:115], v[152:155], v[112:115]
    buffer_load_dwordx4 a[140:143], v242, s[8:11], s65 offen offset:1024 sc1
    v_mfma_f32_16x16x32_bf16 v[116:119], a[116:119], v[152:155], v[116:119]
    v_exp_f32 v167, v167
    v_mfma_f32_16x16x32_bf16 v[120:123], a[120:123], v[152:155], v[120:123]
    ds_read_b128 a[92:95], v235 offset:61440
    v_cvt_pk_bf16_f32 v163, v166, v167
    v_mfma_f32_16x16x32_bf16 v[124:127], a[124:127], v[152:155], v[124:127]
    buffer_load_dwordx4 a[144:147], v242, s[8:11], s53 offen offset:2048 sc1
    v_mfma_f32_16x16x32_bf16 a[252:255], v[220:223], v[152:155], a[252:255]
    s_waitcnt lgkmcnt(4)
    v_mfma_f32_16x16x32_bf16 v[128:131], a[64:67], a[0:3], v[192:195]
    v_exp_f32 v168, v168
    v_mfma_f32_16x16x32_bf16 v[128:131], a[68:71], a[4:7], v[128:131]
    ds_read_b64_tr_b16 a[96:97], v224 offset:49152
    ds_read_b64_tr_b16 a[98:99], v224 offset:53248
    v_mfma_f32_16x16x32_bf16 v[128:131], a[72:75], a[8:11], v[128:131]
    v_exp_f32 v169, v169
    v_mfma_f32_16x16x32_bf16 v[128:131], a[76:79], a[12:15], v[128:131]
    s_waitcnt vmcnt(13) lgkmcnt(2)
    s_barrier
    ds_read_b64_tr_b16 a[100:101], v225 offset:49152
    v_cvt_pk_bf16_f32 v168, v168, v169
    v_mfma_f32_16x16x32_bf16 v[132:135], a[80:83], a[0:3], v[192:195]
    v_exp_f32 v170, v170
    v_mfma_f32_16x16x32_bf16 v[132:135], a[84:87], a[4:7], v[132:135]
    v_min_u32 v249, 1, v242
    v_lshlrev_b32 v249, 31, v249
    v_mfma_f32_16x16x32_bf16 v[132:135], a[88:91], a[8:11], v[132:135]
    v_exp_f32 v171, v171
    v_mfma_f32_16x16x32_bf16 v[132:135], a[92:95], a[12:15], v[132:135]
    ds_read_b64_tr_b16 a[102:103], v225 offset:53248
    v_cvt_pk_bf16_f32 v169, v170, v171
    v_mfma_f32_16x16x32_bf16 v[136:139], a[64:67], a[16:19], v[196:199]
    v_exp_f32 v172, v172
    v_mfma_f32_16x16x32_bf16 v[136:139], a[68:71], a[20:23], v[136:139]
    ds_read_b64_tr_b16 a[104:105], v226 offset:49152
    ds_read_b64_tr_b16 a[106:107], v226 offset:53248
    v_mfma_f32_16x16x32_bf16 v[136:139], a[72:75], a[24:27], v[136:139]
    v_exp_f32 v173, v173
    v_mfma_f32_16x16x32_bf16 v[136:139], a[76:79], a[28:31], v[136:139]
    ds_read_b64_tr_b16 a[108:109], v227 offset:49152
    v_cvt_pk_bf16_f32 v170, v172, v173
    v_mfma_f32_16x16x32_bf16 v[140:143], a[80:83], a[16:19], v[196:199]
    v_exp_f32 v174, v174
    v_mfma_f32_16x16x32_bf16 v[140:143], a[84:87], a[20:23], v[140:143]
    v_mov_b32 v248, s74
    v_mfma_f32_16x16x32_bf16 v[140:143], a[88:91], a[24:27], v[140:143]
    v_exp_f32 v175, v175
    v_mfma_f32_16x16x32_bf16 v[140:143], a[92:95], a[28:31], v[140:143]
    ds_read_b64_tr_b16 a[110:111], v227 offset:53248
    v_cvt_pk_bf16_f32 v171, v174, v175
    v_mfma_f32_16x16x32_bf16 v[144:147], a[64:67], a[32:35], v[200:203]
    v_exp_f32 v176, v176
    v_mfma_f32_16x16x32_bf16 v[144:147], a[68:71], a[36:39], v[144:147]
    ds_read_b64_tr_b16 a[112:113], v228 offset:49152
    ds_read_b64_tr_b16 a[114:115], v228 offset:53248
    v_mfma_f32_16x16x32_bf16 v[144:147], a[72:75], a[40:43], v[144:147]
    v_exp_f32 v177, v177
    v_mfma_f32_16x16x32_bf16 v[144:147], a[76:79], a[44:47], v[144:147]
    ds_read_b64_tr_b16 a[116:117], v229 offset:49152
    v_cvt_pk_bf16_f32 v176, v176, v177
    v_mfma_f32_16x16x32_bf16 v[148:151], a[80:83], a[32:35], v[200:203]
    v_exp_f32 v178, v178
    v_mfma_f32_16x16x32_bf16 v[148:151], a[84:87], a[36:39], v[148:151]
    buffer_load_dwordx4 a[148:151], v242, s[8:11], s65 offen offset:2048 sc1
    v_mfma_f32_16x16x32_bf16 v[148:151], a[88:91], a[40:43], v[148:151]
    v_exp_f32 v179, v179
    v_mfma_f32_16x16x32_bf16 v[148:151], a[92:95], a[44:47], v[148:151]
    ds_read_b64_tr_b16 a[118:119], v229 offset:53248
    v_cvt_pk_bf16_f32 v177, v178, v179
    v_mfma_f32_16x16x32_bf16 v[152:155], a[64:67], a[48:51], v[204:207]
    v_exp_f32 v180, v180
    v_mfma_f32_16x16x32_bf16 v[152:155], a[68:71], a[52:55], v[152:155]
    ds_read_b64_tr_b16 a[120:121], v230 offset:49152
    ds_read_b64_tr_b16 a[122:123], v230 offset:53248
    v_mfma_f32_16x16x32_bf16 v[152:155], a[72:75], a[56:59], v[152:155]
    v_exp_f32 v181, v181
    v_mfma_f32_16x16x32_bf16 v[152:155], a[76:79], a[60:63], v[152:155]
    ds_read_b64_tr_b16 a[124:125], v231 offset:49152
    v_cvt_pk_bf16_f32 v178, v180, v181
    v_mfma_f32_16x16x32_bf16 v[156:159], a[80:83], a[48:51], v[204:207]
    v_exp_f32 v182, v182
    v_mfma_f32_16x16x32_bf16 v[156:159], a[84:87], a[52:55], v[156:159]
    buffer_load_dwordx4 a[152:155], v242, s[8:11], s53 offen offset:3072 sc1
    v_mfma_f32_16x16x32_bf16 v[156:159], a[88:91], a[56:59], v[156:159]
    v_exp_f32 v183, v183
    v_mfma_f32_16x16x32_bf16 v[156:159], a[92:95], a[60:63], v[156:159]
    s_waitcnt lgkmcnt(7)
    ds_read_b64_tr_b16 a[126:127], v231 offset:53248
    v_cvt_pk_bf16_f32 v179, v182, v183
    v_mfma_f32_16x16x32_bf16 v[0:3], a[96:99], v[160:163], v[0:3]
    v_exp_f32 v184, v184
    v_mfma_f32_16x16x32_bf16 v[4:7], a[100:103], v[160:163], v[4:7]
    buffer_load_dwordx4 a[156:159], v242, s[8:11], s65 offen offset:3072 sc1
    v_mfma_f32_16x16x32_bf16 v[8:11], a[104:107], v[160:163], v[8:11]
    v_exp_f32 v185, v185
    v_mfma_f32_16x16x32_bf16 v[12:15], a[108:111], v[160:163], v[12:15]
    s_waitcnt lgkmcnt(0)
    ds_read_b128 a[64:67], v232 offset:0
    v_cvt_pk_bf16_f32 v184, v184, v185
    v_mfma_f32_16x16x32_bf16 v[16:19], a[112:115], v[160:163], v[16:19]
    v_exp_f32 v186, v186
    v_mfma_f32_16x16x32_bf16 v[20:23], a[116:119], v[160:163], v[20:23]
    s_add_u32 s53, s53, 4096
    buffer_load_dwordx4 a[160:163], v242, s[8:11], s53 offen offset:0 sc1
    v_mfma_f32_16x16x32_bf16 v[24:27], a[120:123], v[160:163], v[24:27]
    v_exp_f32 v187, v187
    v_mfma_f32_16x16x32_bf16 v[28:31], a[124:127], v[160:163], v[28:31]
    ds_read_b128 a[68:71], v233 offset:0
    v_cvt_pk_bf16_f32 v185, v186, v187
    v_mfma_f32_16x16x32_bf16 a[240:243], v[220:223], v[160:163], a[240:243]
    v_exp_f32 v188, v188
    v_mfma_f32_16x16x32_bf16 v[32:35], a[96:99], v[168:171], v[32:35]
    s_add_u32 s65, s65, 4096
    buffer_load_dwordx4 a[164:167], v242, s[8:11], s65 offen offset:0 sc1
    v_mfma_f32_16x16x32_bf16 v[36:39], a[100:103], v[168:171], v[36:39]
    v_exp_f32 v189, v189
    v_mfma_f32_16x16x32_bf16 v[40:43], a[104:107], v[168:171], v[40:43]
    ds_read_b128 a[72:75], v234 offset:0
    v_cvt_pk_bf16_f32 v186, v188, v189
    v_mfma_f32_16x16x32_bf16 v[44:47], a[108:111], v[168:171], v[44:47]
    v_exp_f32 v190, v190
    v_mfma_f32_16x16x32_bf16 v[48:51], a[112:115], v[168:171], v[48:51]
    buffer_load_dwordx4 a[168:171], v242, s[8:11], s53 offen offset:1024 sc1
    v_mfma_f32_16x16x32_bf16 v[52:55], a[116:119], v[168:171], v[52:55]
    v_exp_f32 v191, v191
    v_mfma_f32_16x16x32_bf16 v[56:59], a[120:123], v[168:171], v[56:59]
    ds_read_b128 a[76:79], v235 offset:0
    v_cvt_pk_bf16_f32 v187, v190, v191
    v_mfma_f32_16x16x32_bf16 v[60:63], a[124:127], v[168:171], v[60:63]
    buffer_load_dwordx4 a[172:175], v242, s[8:11], s65 offen offset:1024 sc1
    v_mfma_f32_16x16x32_bf16 a[244:247], v[220:223], v[168:171], a[244:247]
    v_mfma_f32_16x16x32_bf16 v[64:67], a[96:99], v[176:179], v[64:67]
    v_exp_f32 v128, v128
    v_mfma_f32_16x16x32_bf16 v[68:71], a[100:103], v[176:179], v[68:71]
    buffer_load_dwordx4 a[176:179], v242, s[8:11], s53 offen offset:2048 sc1
    v_mfma_f32_16x16x32_bf16 v[72:75], a[104:107], v[176:179], v[72:75]
    v_exp_f32 v129, v129
    v_mfma_f32_16x16x32_bf16 v[76:79], a[108:111], v[176:179], v[76:79]
    ds_read_b128 a[80:83], v232 offset:4096
    v_cvt_pk_bf16_f32 v128, v128, v129
    v_mfma_f32_16x16x32_bf16 v[80:83], a[112:115], v[176:179], v[80:83]
    v_exp_f32 v130, v130
    v_mfma_f32_16x16x32_bf16 v[84:87], a[116:119], v[176:179], v[84:87]
    buffer_load_dwordx4 a[180:183], v242, s[8:11], s65 offen offset:2048 sc1
    v_mfma_f32_16x16x32_bf16 v[88:91], a[120:123], v[176:179], v[88:91]
    v_exp_f32 v131, v131
    v_mfma_f32_16x16x32_bf16 v[92:95], a[124:127], v[176:179], v[92:95]
    ds_read_b128 a[84:87], v233 offset:4096
    v_cvt_pk_bf16_f32 v129, v130, v131
    v_mfma_f32_16x16x32_bf16 a[248:251], v[220:223], v[176:179], a[248:251]
    v_exp_f32 v132, v132
    v_mfma_f32_16x16x32_bf16 v[96:99], a[96:99], v[184:187], v[96:99]
    buffer_load_dwordx4 a[184:187], v242, s[8:11], s53 offen offset:3072 sc1
    v_mfma_f32_16x16x32_bf16 v[100:103], a[100:103], v[184:187], v[100:103]
    v_exp_f32 v133, v133
    v_mfma_f32_16x16x32_bf16 v[104:107], a[104:107], v[184:187], v[104:107]
    ds_read_b128 a[88:91], v234 offset:4096
    v_cvt_pk_bf16_f32 v130, v132, v133
    v_mfma_f32_16x16x32_bf16 v[108:111], a[108:111], v[184:187], v[108:111]
    v_exp_f32 v134, v134
    v_mfma_f32_16x16x32_bf16 v[112:115], a[112:115], v[184:187], v[112:115]
    buffer_load_dwordx4 a[188:191], v242, s[8:11], s65 offen offset:3072 sc1
    v_mfma_f32_16x16x32_bf16 v[116:119], a[116:119], v[184:187], v[116:119]
    v_exp_f32 v135, v135
    v_mfma_f32_16x16x32_bf16 v[120:123], a[120:123], v[184:187], v[120:123]
    ds_read_b128 a[92:95], v235 offset:4096
    v_cvt_pk_bf16_f32 v131, v134, v135
    v_mfma_f32_16x16x32_bf16 v[124:127], a[124:127], v[184:187], v[124:127]
    s_add_u32 s53, s53, 4096
    buffer_load_dwordx4 a[192:195], v242, s[8:11], s53 offen offset:0 sc1
    v_mfma_f32_16x16x32_bf16 a[252:255], v[220:223], v[184:187], a[252:255]
    s_waitcnt lgkmcnt(4)
    v_mfma_f32_16x16x32_bf16 v[160:163], a[64:67], a[0:3], v[192:195]
    v_exp_f32 v136, v136
    v_mfma_f32_16x16x32_bf16 v[160:163], a[68:71], a[4:7], v[160:163]
    ds_read_b64_tr_b16 a[96:97], v224 offset:57344
    ds_read_b64_tr_b16 a[98:99], v224 offset:61440
    v_mfma_f32_16x16x32_bf16 v[160:163], a[72:75], a[8:11], v[160:163]
    v_exp_f32 v137, v137
    v_mfma_f32_16x16x32_bf16 v[160:163], a[76:79], a[12:15], v[160:163]
    s_waitcnt lgkmcnt(2)
    ds_read_b64_tr_b16 a[100:101], v225 offset:57344
    v_cvt_pk_bf16_f32 v136, v136, v137
    v_mfma_f32_16x16x32_bf16 v[164:167], a[80:83], a[0:3], v[192:195]
    v_exp_f32 v138, v138
    v_mfma_f32_16x16x32_bf16 v[164:167], a[84:87], a[4:7], v[164:167]
    s_add_u32 s65, s65, 4096
    buffer_load_dwordx4 a[196:199], v242, s[8:11], s65 offen offset:0 sc1
    v_mfma_f32_16x16x32_bf16 v[164:167], a[88:91], a[8:11], v[164:167]
    v_exp_f32 v139, v139
    v_mfma_f32_16x16x32_bf16 v[164:167], a[92:95], a[12:15], v[164:167]
    ds_read_b64_tr_b16 a[102:103], v225 offset:61440
    v_cvt_pk_bf16_f32 v137, v138, v139
    v_mfma_f32_16x16x32_bf16 v[168:171], a[64:67], a[16:19], v[196:199]
    v_exp_f32 v140, v140
    v_mfma_f32_16x16x32_bf16 v[168:171], a[68:71], a[20:23], v[168:171]
    ds_read_b64_tr_b16 a[104:105], v226 offset:57344
    ds_read_b64_tr_b16 a[106:107], v226 offset:61440
    v_mfma_f32_16x16x32_bf16 v[168:171], a[72:75], a[24:27], v[168:171]
    v_exp_f32 v141, v141
    v_mfma_f32_16x16x32_bf16 v[168:171], a[76:79], a[28:31], v[168:171]
    ds_read_b64_tr_b16 a[108:109], v227 offset:57344
    v_cvt_pk_bf16_f32 v138, v140, v141
    v_mfma_f32_16x16x32_bf16 v[172:175], a[80:83], a[16:19], v[196:199]
    v_exp_f32 v142, v142
    v_mfma_f32_16x16x32_bf16 v[172:175], a[84:87], a[20:23], v[172:175]
    buffer_store_dword v248, v249, s[8:11], s73 offen sc1
    v_mfma_f32_16x16x32_bf16 v[172:175], a[88:91], a[24:27], v[172:175]
    v_exp_f32 v143, v143
    v_mfma_f32_16x16x32_bf16 v[172:175], a[92:95], a[28:31], v[172:175]
    ds_read_b64_tr_b16 a[110:111], v227 offset:61440
    v_cvt_pk_bf16_f32 v139, v142, v143
    v_mfma_f32_16x16x32_bf16 v[176:179], a[64:67], a[32:35], v[200:203]
    v_exp_f32 v144, v144
    v_mfma_f32_16x16x32_bf16 v[176:179], a[68:71], a[36:39], v[176:179]
    ds_read_b64_tr_b16 a[112:113], v228 offset:57344
    ds_read_b64_tr_b16 a[114:115], v228 offset:61440
    v_mfma_f32_16x16x32_bf16 v[176:179], a[72:75], a[40:43], v[176:179]
    v_exp_f32 v145, v145
    v_mfma_f32_16x16x32_bf16 v[176:179], a[76:79], a[44:47], v[176:179]
    ds_read_b64_tr_b16 a[116:117], v229 offset:57344
    v_cvt_pk_bf16_f32 v144, v144, v145
    v_mfma_f32_16x16x32_bf16 v[180:183], a[80:83], a[32:35], v[200:203]
    v_exp_f32 v146, v146
    v_mfma_f32_16x16x32_bf16 v[180:183], a[84:87], a[36:39], v[180:183]
    buffer_load_dwordx4 a[200:203], v242, s[8:11], s53 offen offset:1024 sc1
    v_mfma_f32_16x16x32_bf16 v[180:183], a[88:91], a[40:43], v[180:183]
    v_exp_f32 v147, v147
    v_mfma_f32_16x16x32_bf16 v[180:183], a[92:95], a[44:47], v[180:183]
    ds_read_b64_tr_b16 a[118:119], v229 offset:61440
    v_cvt_pk_bf16_f32 v145, v146, v147
    v_mfma_f32_16x16x32_bf16 v[184:187], a[64:67], a[48:51], v[204:207]
    v_exp_f32 v148, v148
    v_mfma_f32_16x16x32_bf16 v[184:187], a[68:71], a[52:55], v[184:187]
    ds_read_b64_tr_b16 a[120:121], v230 offset:57344
    ds_read_b64_tr_b16 a[122:123], v230 offset:61440
    v_mfma_f32_16x16x32_bf16 v[184:187], a[72:75], a[56:59], v[184:187]
    v_exp_f32 v149, v149
    v_mfma_f32_16x16x32_bf16 v[184:187], a[76:79], a[60:63], v[184:187]
    ds_read_b64_tr_b16 a[124:125], v231 offset:57344
    v_cvt_pk_bf16_f32 v146, v148, v149
    v_mfma_f32_16x16x32_bf16 v[188:191], a[80:83], a[48:51], v[204:207]
    v_exp_f32 v150, v150
    v_mfma_f32_16x16x32_bf16 v[188:191], a[84:87], a[52:55], v[188:191]
    buffer_load_dwordx4 a[204:207], v242, s[8:11], s65 offen offset:1024 sc1
    v_mfma_f32_16x16x32_bf16 v[188:191], a[88:91], a[56:59], v[188:191]
    v_exp_f32 v151, v151
    v_mfma_f32_16x16x32_bf16 v[188:191], a[92:95], a[60:63], v[188:191]
    s_waitcnt lgkmcnt(7)
    ds_read_b64_tr_b16 a[126:127], v231 offset:61440
    v_cvt_pk_bf16_f32 v147, v150, v151
    v_mfma_f32_16x16x32_bf16 v[0:3], a[96:99], v[128:131], v[0:3]
    ds_read_b64_tr_b16 a[208:209], v208 offset:0
    ds_read_b64_tr_b16 a[210:211], v208 offset:1024
    ds_read_b64_tr_b16 a[212:213], v209 offset:0
    ds_read_b64_tr_b16 a[214:215], v209 offset:1024
    v_exp_f32 v152, v152
    v_mfma_f32_16x16x32_bf16 v[4:7], a[100:103], v[128:131], v[4:7]
    s_add_u32 m0, s57, 131072
    s_mov_b32 s56, 98304
    buffer_load_dwordx4 v236, s[20:23], s56 offen offset:0 lds
    v_mfma_f32_16x16x32_bf16 v[8:11], a[104:107], v[128:131], v[8:11]
    v_exp_f32 v153, v153
    v_mfma_f32_16x16x32_bf16 v[12:15], a[108:111], v[128:131], v[12:15]
    s_waitcnt lgkmcnt(4)
    ds_read_b128 a[64:67], v232 offset:8192
    v_cvt_pk_bf16_f32 v152, v152, v153
    v_mfma_f32_16x16x32_bf16 v[16:19], a[112:115], v[128:131], v[16:19]
    v_exp_f32 v154, v154
    v_mfma_f32_16x16x32_bf16 v[20:23], a[116:119], v[128:131], v[20:23]
    buffer_load_dwordx4 v237, s[20:23], s56 offen offset:1024 lds
    v_mfma_f32_16x16x32_bf16 v[24:27], a[120:123], v[128:131], v[24:27]
    v_exp_f32 v155, v155
    v_mfma_f32_16x16x32_bf16 v[28:31], a[124:127], v[128:131], v[28:31]
    ds_read_b128 a[68:71], v233 offset:8192
    v_cvt_pk_bf16_f32 v153, v154, v155
    v_mfma_f32_16x16x32_bf16 a[240:243], v[220:223], v[128:131], a[240:243]
    v_exp_f32 v156, v156
    v_mfma_f32_16x16x32_bf16 v[32:35], a[96:99], v[136:139], v[32:35]
    buffer_load_dwordx4 v238, s[20:23], s56 offen offset:2048 lds
    v_mfma_f32_16x16x32_bf16 v[36:39], a[100:103], v[136:139], v[36:39]
    v_exp_f32 v157, v157
    v_mfma_f32_16x16x32_bf16 v[40:43], a[104:107], v[136:139], v[40:43]
    ds_read_b128 a[72:75], v234 offset:8192
    v_cvt_pk_bf16_f32 v154, v156, v157
    v_mfma_f32_16x16x32_bf16 v[44:47], a[108:111], v[136:139], v[44:47]
    v_exp_f32 v158, v158
    v_mfma_f32_16x16x32_bf16 v[48:51], a[112:115], v[136:139], v[48:51]
    buffer_load_dwordx4 v239, s[20:23], s56 offen offset:3072 lds
    v_mfma_f32_16x16x32_bf16 v[52:55], a[116:119], v[136:139], v[52:55]
    v_exp_f32 v159, v159
    v_mfma_f32_16x16x32_bf16 v[56:59], a[120:123], v[136:139], v[56:59]
    ds_read_b128 a[76:79], v235 offset:8192
    v_cvt_pk_bf16_f32 v155, v158, v159
    v_mfma_f32_16x16x32_bf16 v[60:63], a[124:127], v[136:139], v[60:63]
    s_add_u32 m0, s57, 32768
    s_mov_b32 s56, 98304
    buffer_load_dwordx4 v240, s[24:27], s56 offen offset:0 lds
    v_mfma_f32_16x16x32_bf16 a[244:247], v[220:223], v[136:139], a[244:247]
    s_waitcnt vmcnt(24) lgkmcnt(4)
    v_mfma_f32_16x16x32_bf16 a[224:227], a[208:211], a[128:131], 0
    ds_read_b64_tr_b16 a[216:217], v208 offset:2048
    ds_read_b64_tr_b16 a[218:219], v208 offset:3072
    v_mfma_f32_16x16x32_bf16 a[232:235], a[208:211], a[132:135], 0
    ds_read_b64_tr_b16 a[220:221], v209 offset:2048
    ds_read_b64_tr_b16 a[222:223], v209 offset:3072
    v_mfma_f32_16x16x32_bf16 a[228:231], a[212:215], a[128:131], 0
    buffer_load_dwordx4 v241, s[24:27], s56 offen offset:1024 lds
    v_mfma_f32_16x16x32_bf16 a[236:239], a[212:215], a[132:135], 0
    buffer_load_dwordx4 v240, s[24:27], s56 offen offset:2048 lds
    s_waitcnt vmcnt(24) lgkmcnt(0)
    v_mfma_f32_16x16x32_bf16 a[224:227], a[216:219], a[136:139], a[224:227]
    ds_read_b64_tr_b16 a[208:209], v208 offset:4096
    ds_read_b64_tr_b16 a[210:211], v208 offset:5120
    v_mfma_f32_16x16x32_bf16 a[232:235], a[216:219], a[140:143], a[232:235]
    ds_read_b64_tr_b16 a[212:213], v209 offset:4096
    ds_read_b64_tr_b16 a[214:215], v209 offset:5120
    v_mfma_f32_16x16x32_bf16 a[228:231], a[220:223], a[136:139], a[228:231]
    buffer_load_dwordx4 v241, s[24:27], s56 offen offset:3072 lds
    v_mfma_f32_16x16x32_bf16 a[236:239], a[220:223], a[140:143], a[236:239]
    s_add_u32 m0, s57, 147456
    s_mov_b32 s56, 114688
    buffer_load_dwordx4 v236, s[20:23], s56 offen offset:0 lds
    v_mfma_f32_16x16x32_bf16 v[64:67], a[96:99], v[144:147], v[64:67]
    v_exp_f32 v160, v160
    v_mfma_f32_16x16x32_bf16 v[68:71], a[100:103], v[144:147], v[68:71]
    buffer_load_dwordx4 v237, s[20:23], s56 offen offset:1024 lds
    v_mfma_f32_16x16x32_bf16 v[72:75], a[104:107], v[144:147], v[72:75]
    v_exp_f32 v161, v161
    v_mfma_f32_16x16x32_bf16 v[76:79], a[108:111], v[144:147], v[76:79]
    ds_read_b128 a[80:83], v232 offset:12288
    v_cvt_pk_bf16_f32 v160, v160, v161
    v_mfma_f32_16x16x32_bf16 v[80:83], a[112:115], v[144:147], v[80:83]
    v_exp_f32 v162, v162
    v_mfma_f32_16x16x32_bf16 v[84:87], a[116:119], v[144:147], v[84:87]
    buffer_load_dwordx4 v238, s[20:23], s56 offen offset:2048 lds
    v_mfma_f32_16x16x32_bf16 v[88:91], a[120:123], v[144:147], v[88:91]
    v_exp_f32 v163, v163
    v_mfma_f32_16x16x32_bf16 v[92:95], a[124:127], v[144:147], v[92:95]
    ds_read_b128 a[84:87], v233 offset:12288
    v_cvt_pk_bf16_f32 v161, v162, v163
    v_mfma_f32_16x16x32_bf16 a[248:251], v[220:223], v[144:147], a[248:251]
    v_exp_f32 v164, v164
    v_mfma_f32_16x16x32_bf16 v[96:99], a[96:99], v[152:155], v[96:99]
    buffer_load_dwordx4 v239, s[20:23], s56 offen offset:3072 lds
    v_mfma_f32_16x16x32_bf16 v[100:103], a[100:103], v[152:155], v[100:103]
    v_exp_f32 v165, v165
    v_mfma_f32_16x16x32_bf16 v[104:107], a[104:107], v[152:155], v[104:107]
    ds_read_b128 a[88:91], v234 offset:12288
    v_cvt_pk_bf16_f32 v162, v164, v165
    v_mfma_f32_16x16x32_bf16 v[108:111], a[108:111], v[152:155], v[108:111]
    v_exp_f32 v166, v166
    v_mfma_f32_16x16x32_bf16 v[112:115], a[112:115], v[152:155], v[112:115]
    buffer_load_dwordx4 a[128:131], v242, s[8:11], s53 offen offset:2048 sc1
    v_mfma_f32_16x16x32_bf16 v[116:119], a[116:119], v[152:155], v[116:119]
    v_exp_f32 v167, v167
    v_mfma_f32_16x16x32_bf16 v[120:123], a[120:123], v[152:155], v[120:123]
    ds_read_b128 a[92:95], v235 offset:12288
    v_cvt_pk_bf16_f32 v163, v166, v167
    v_mfma_f32_16x16x32_bf16 v[124:127], a[124:127], v[152:155], v[124:127]
    buffer_load_dwordx4 a[132:135], v242, s[8:11], s65 offen offset:2048 sc1
    v_mfma_f32_16x16x32_bf16 a[252:255], v[220:223], v[152:155], a[252:255]
    s_waitcnt vmcnt(29) lgkmcnt(4)
    v_mfma_f32_16x16x32_bf16 a[224:227], a[208:211], a[144:147], a[224:227]
    ds_read_b64_tr_b16 a[216:217], v208 offset:6144
    ds_read_b64_tr_b16 a[218:219], v208 offset:7168
    v_mfma_f32_16x16x32_bf16 a[232:235], a[208:211], a[148:151], a[232:235]
    ds_read_b64_tr_b16 a[220:221], v209 offset:6144
    ds_read_b64_tr_b16 a[222:223], v209 offset:7168
    v_mfma_f32_16x16x32_bf16 a[228:231], a[212:215], a[144:147], a[228:231]
    buffer_load_dwordx4 a[136:139], v242, s[8:11], s53 offen offset:3072 sc1
    v_mfma_f32_16x16x32_bf16 a[236:239], a[212:215], a[148:151], a[236:239]
    buffer_load_dwordx4 a[140:143], v242, s[8:11], s65 offen offset:3072 sc1
    v_mfma_f32_16x16x32_bf16 v[128:131], a[64:67], a[0:3], v[192:195]
    v_exp_f32 v168, v168
    v_mfma_f32_16x16x32_bf16 v[128:131], a[68:71], a[4:7], v[128:131]
    ds_read_b64_tr_b16 a[96:97], v224 offset:0
    ds_read_b64_tr_b16 a[98:99], v224 offset:4096
    v_mfma_f32_16x16x32_bf16 v[128:131], a[72:75], a[8:11], v[128:131]
    v_exp_f32 v169, v169
    v_mfma_f32_16x16x32_bf16 v[128:131], a[76:79], a[12:15], v[128:131]
    s_waitcnt lgkmcnt(6)
    s_barrier
    ds_read_b64_tr_b16 a[100:101], v225 offset:0
    v_cvt_pk_bf16_f32 v168, v168, v169
    v_mfma_f32_16x16x32_bf16 v[132:135], a[80:83], a[0:3], v[192:195]
    v_exp_f32 v170, v170
    v_mfma_f32_16x16x32_bf16 v[132:135], a[84:87], a[4:7], v[132:135]
    s_add_u32 s53, s53, 4096
    buffer_load_dwordx4 a[144:147], v242, s[8:11], s53 offen offset:0 sc1
    v_mfma_f32_16x16x32_bf16 v[132:135], a[88:91], a[8:11], v[132:135]
    v_exp_f32 v171, v171
    v_mfma_f32_16x16x32_bf16 v[132:135], a[92:95], a[12:15], v[132:135]
    ds_read_b64_tr_b16 a[102:103], v225 offset:4096
    v_cvt_pk_bf16_f32 v169, v170, v171
    v_mfma_f32_16x16x32_bf16 v[136:139], a[64:67], a[16:19], v[196:199]
    v_exp_f32 v172, v172
    v_mfma_f32_16x16x32_bf16 v[136:139], a[68:71], a[20:23], v[136:139]
    ds_read_b64_tr_b16 a[104:105], v226 offset:0
    ds_read_b64_tr_b16 a[106:107], v226 offset:4096
    v_mfma_f32_16x16x32_bf16 v[136:139], a[72:75], a[24:27], v[136:139]
    v_exp_f32 v173, v173
    v_mfma_f32_16x16x32_bf16 v[136:139], a[76:79], a[28:31], v[136:139]
    ds_read_b64_tr_b16 a[108:109], v227 offset:0
    v_cvt_pk_bf16_f32 v170, v172, v173
    v_mfma_f32_16x16x32_bf16 v[140:143], a[80:83], a[16:19], v[196:199]
    v_exp_f32 v174, v174
    v_mfma_f32_16x16x32_bf16 v[140:143], a[84:87], a[20:23], v[140:143]
    s_add_u32 s65, s65, 4096
    buffer_load_dwordx4 a[148:151], v242, s[8:11], s65 offen offset:0 sc1
    v_mfma_f32_16x16x32_bf16 v[140:143], a[88:91], a[24:27], v[140:143]
    v_exp_f32 v175, v175
    v_mfma_f32_16x16x32_bf16 v[140:143], a[92:95], a[28:31], v[140:143]
    ds_read_b64_tr_b16 a[110:111], v227 offset:4096
    v_cvt_pk_bf16_f32 v171, v174, v175
    s_waitcnt vmcnt(31) lgkmcnt(8)
    v_mfma_f32_16x16x32_bf16 a[224:227], a[216:219], a[152:155], a[224:227]
    ds_read_b64_tr_b16 a[208:209], v208 offset:8192
    ds_read_b64_tr_b16 a[210:211], v208 offset:9216
    v_mfma_f32_16x16x32_bf16 a[232:235], a[216:219], a[156:159], a[232:235]
    ds_read_b64_tr_b16 a[212:213], v209 offset:8192
    ds_read_b64_tr_b16 a[214:215], v209 offset:9216
    v_mfma_f32_16x16x32_bf16 a[228:231], a[220:223], a[152:155], a[228:231]
    v_mfma_f32_16x16x32_bf16 a[236:239], a[220:223], a[156:159], a[236:239]
    v_mfma_f32_16x16x32_bf16 v[144:147], a[64:67], a[32:35], v[200:203]
    v_exp_f32 v176, v176
    v_mfma_f32_16x16x32_bf16 v[144:147], a[68:71], a[36:39], v[144:147]
    ds_read_b64_tr_b16 a[112:113], v228 offset:0
    ds_read_b64_tr_b16 a[114:115], v228 offset:4096
    v_mfma_f32_16x16x32_bf16 v[144:147], a[72:75], a[40:43], v[144:147]
    v_exp_f32 v177, v177
    v_mfma_f32_16x16x32_bf16 v[144:147], a[76:79], a[44:47], v[144:147]
    ds_read_b64_tr_b16 a[116:117], v229 offset:0
    v_cvt_pk_bf16_f32 v176, v176, v177
    v_mfma_f32_16x16x32_bf16 v[148:151], a[80:83], a[32:35], v[200:203]
    v_exp_f32 v178, v178
    v_mfma_f32_16x16x32_bf16 v[148:151], a[84:87], a[36:39], v[148:151]
    buffer_load_dwordx4 a[152:155], v242, s[8:11], s53 offen offset:1024 sc1
    v_mfma_f32_16x16x32_bf16 v[148:151], a[88:91], a[40:43], v[148:151]
    v_exp_f32 v179, v179
    v_mfma_f32_16x16x32_bf16 v[148:151], a[92:95], a[44:47], v[148:151]
    ds_read_b64_tr_b16 a[118:119], v229 offset:4096
    v_cvt_pk_bf16_f32 v177, v178, v179
    v_mfma_f32_16x16x32_bf16 v[152:155], a[64:67], a[48:51], v[204:207]
    v_exp_f32 v180, v180
    v_mfma_f32_16x16x32_bf16 v[152:155], a[68:71], a[52:55], v[152:155]
    ds_read_b64_tr_b16 a[120:121], v230 offset:0
    ds_read_b64_tr_b16 a[122:123], v230 offset:4096
    v_mfma_f32_16x16x32_bf16 v[152:155], a[72:75], a[56:59], v[152:155]
    v_exp_f32 v181, v181
    v_mfma_f32_16x16x32_bf16 v[152:155], a[76:79], a[60:63], v[152:155]
    ds_read_b64_tr_b16 a[124:125], v231 offset:0
    v_cvt_pk_bf16_f32 v178, v180, v181
    v_mfma_f32_16x16x32_bf16 v[156:159], a[80:83], a[48:51], v[204:207]
    v_exp_f32 v182, v182
    v_mfma_f32_16x16x32_bf16 v[156:159], a[84:87], a[52:55], v[156:159]
    buffer_load_dwordx4 a[156:159], v242, s[8:11], s65 offen offset:1024 sc1
    v_mfma_f32_16x16x32_bf16 v[156:159], a[88:91], a[56:59], v[156:159]
    v_exp_f32 v183, v183
    v_mfma_f32_16x16x32_bf16 v[156:159], a[92:95], a[60:63], v[156:159]
    s_waitcnt lgkmcnt(11)
    ds_read_b64_tr_b16 a[126:127], v231 offset:4096
    v_cvt_pk_bf16_f32 v179, v182, v183
    s_waitcnt vmcnt(31) lgkmcnt(8)
    v_mfma_f32_16x16x32_bf16 a[224:227], a[208:211], a[160:163], a[224:227]
    ds_read_b64_tr_b16 a[216:217], v208 offset:10240
    ds_read_b64_tr_b16 a[218:219], v208 offset:11264
    v_mfma_f32_16x16x32_bf16 a[232:235], a[208:211], a[164:167], a[232:235]
    ds_read_b64_tr_b16 a[220:221], v209 offset:10240
    ds_read_b64_tr_b16 a[222:223], v209 offset:11264
    v_mfma_f32_16x16x32_bf16 a[228:231], a[212:215], a[160:163], a[228:231]
    s_add_u32 m0, s81, 98304
    s_mov_b32 s55, 524288
    buffer_load_dwordx4 v254, s[32:35], s55 offen lds
    v_mfma_f32_16x16x32_bf16 a[236:239], a[212:215], a[164:167], a[236:239]
    s_add_u32 m0, s81, 102400
    s_mov_b32 s55, 589824
    buffer_load_dwordx4 v254, s[32:35], s55 offen lds
    v_mfma_f32_16x16x32_bf16 v[0:3], a[96:99], v[160:163], v[0:3]
    v_exp_f32 v184, v184
    v_mfma_f32_16x16x32_bf16 v[4:7], a[100:103], v[160:163], v[4:7]
    buffer_load_dwordx4 a[160:163], v242, s[8:11], s53 offen offset:2048 sc1
    v_mfma_f32_16x16x32_bf16 v[8:11], a[104:107], v[160:163], v[8:11]
    v_exp_f32 v185, v185
    v_mfma_f32_16x16x32_bf16 v[12:15], a[108:111], v[160:163], v[12:15]
    s_waitcnt lgkmcnt(4)
    ds_read_b128 a[64:67], v232 offset:16384
    v_cvt_pk_bf16_f32 v184, v184, v185
    v_mfma_f32_16x16x32_bf16 v[16:19], a[112:115], v[160:163], v[16:19]
    v_exp_f32 v186, v186
    v_mfma_f32_16x16x32_bf16 v[20:23], a[116:119], v[160:163], v[20:23]
    buffer_load_dwordx4 a[164:167], v242, s[8:11], s65 offen offset:2048 sc1
    v_mfma_f32_16x16x32_bf16 v[24:27], a[120:123], v[160:163], v[24:27]
    v_exp_f32 v187, v187
    v_mfma_f32_16x16x32_bf16 v[28:31], a[124:127], v[160:163], v[28:31]
    ds_read_b128 a[68:71], v233 offset:16384
    v_cvt_pk_bf16_f32 v185, v186, v187
    v_mfma_f32_16x16x32_bf16 a[240:243], v[220:223], v[160:163], a[240:243]
    v_exp_f32 v188, v188
    v_mfma_f32_16x16x32_bf16 v[32:35], a[96:99], v[168:171], v[32:35]
    s_add_u32 m0, s81, 106496
    s_mov_b32 s55, 655360
    buffer_load_dwordx4 v254, s[32:35], s55 offen lds
    v_mfma_f32_16x16x32_bf16 v[36:39], a[100:103], v[168:171], v[36:39]
    v_exp_f32 v189, v189
    v_mfma_f32_16x16x32_bf16 v[40:43], a[104:107], v[168:171], v[40:43]
    ds_read_b128 a[72:75], v234 offset:16384
    v_cvt_pk_bf16_f32 v186, v188, v189
    v_mfma_f32_16x16x32_bf16 v[44:47], a[108:111], v[168:171], v[44:47]
    v_exp_f32 v190, v190
    v_mfma_f32_16x16x32_bf16 v[48:51], a[112:115], v[168:171], v[48:51]
    s_add_u32 m0, s81, 110592
    s_mov_b32 s55, 720896
    buffer_load_dwordx4 v254, s[32:35], s55 offen lds
    v_mfma_f32_16x16x32_bf16 v[52:55], a[116:119], v[168:171], v[52:55]
    v_exp_f32 v191, v191
    v_mfma_f32_16x16x32_bf16 v[56:59], a[120:123], v[168:171], v[56:59]
    ds_read_b128 a[76:79], v235 offset:16384
    v_cvt_pk_bf16_f32 v187, v190, v191
    v_mfma_f32_16x16x32_bf16 v[60:63], a[124:127], v[168:171], v[60:63]
    s_add_u32 m0, s57, 49152
    s_mov_b32 s56, 114688
    buffer_load_dwordx4 v240, s[24:27], s56 offen offset:0 lds
    v_mfma_f32_16x16x32_bf16 a[244:247], v[220:223], v[168:171], a[244:247]
    s_waitcnt vmcnt(36) lgkmcnt(4)
    v_mfma_f32_16x16x32_bf16 a[224:227], a[216:219], a[168:171], a[224:227]
    ds_read_b64_tr_b16 a[208:209], v208 offset:12288
    ds_read_b64_tr_b16 a[210:211], v208 offset:13312
    v_mfma_f32_16x16x32_bf16 a[232:235], a[216:219], a[172:175], a[232:235]
    ds_read_b64_tr_b16 a[212:213], v209 offset:12288
    ds_read_b64_tr_b16 a[214:215], v209 offset:13312
    v_mfma_f32_16x16x32_bf16 a[228:231], a[220:223], a[168:171], a[228:231]
    buffer_load_dwordx4 v241, s[24:27], s56 offen offset:1024 lds
    v_mfma_f32_16x16x32_bf16 a[236:239], a[220:223], a[172:175], a[236:239]
    buffer_load_dwordx4 v240, s[24:27], s56 offen offset:2048 lds
    s_waitcnt vmcnt(36) lgkmcnt(0)
    v_mfma_f32_16x16x32_bf16 a[224:227], a[208:211], a[176:179], a[224:227]
    ds_read_b64_tr_b16 a[216:217], v208 offset:14336
    ds_read_b64_tr_b16 a[218:219], v208 offset:15360
    v_mfma_f32_16x16x32_bf16 a[232:235], a[208:211], a[180:183], a[232:235]
    ds_read_b64_tr_b16 a[220:221], v209 offset:14336
    ds_read_b64_tr_b16 a[222:223], v209 offset:15360
    v_mfma_f32_16x16x32_bf16 a[228:231], a[212:215], a[176:179], a[228:231]
    buffer_load_dwordx4 v241, s[24:27], s56 offen offset:3072 lds
    v_mfma_f32_16x16x32_bf16 a[236:239], a[212:215], a[180:183], a[236:239]
    v_mfma_f32_16x16x32_bf16 v[64:67], a[96:99], v[176:179], v[64:67]
    v_exp_f32 v128, v128
    v_mfma_f32_16x16x32_bf16 v[68:71], a[100:103], v[176:179], v[68:71]
    buffer_load_dwordx4 a[168:171], v242, s[8:11], s53 offen offset:3072 sc1
    v_mfma_f32_16x16x32_bf16 v[72:75], a[104:107], v[176:179], v[72:75]
    v_exp_f32 v129, v129
    v_mfma_f32_16x16x32_bf16 v[76:79], a[108:111], v[176:179], v[76:79]
    ds_read_b128 a[80:83], v232 offset:20480
    v_cvt_pk_bf16_f32 v128, v128, v129
    v_mfma_f32_16x16x32_bf16 v[80:83], a[112:115], v[176:179], v[80:83]
    v_exp_f32 v130, v130
    v_mfma_f32_16x16x32_bf16 v[84:87], a[116:119], v[176:179], v[84:87]
    buffer_load_dwordx4 a[172:175], v242, s[8:11], s65 offen offset:3072 sc1
    v_mfma_f32_16x16x32_bf16 v[88:91], a[120:123], v[176:179], v[88:91]
    v_exp_f32 v131, v131
    v_mfma_f32_16x16x32_bf16 v[92:95], a[124:127], v[176:179], v[92:95]
    ds_read_b128 a[84:87], v233 offset:20480
    v_cvt_pk_bf16_f32 v129, v130, v131
    v_mfma_f32_16x16x32_bf16 a[248:251], v[220:223], v[176:179], a[248:251]
    v_exp_f32 v132, v132
    v_mfma_f32_16x16x32_bf16 v[96:99], a[96:99], v[184:187], v[96:99]
    s_add_u32 s53, s53, 4096
    buffer_load_dwordx4 a[176:179], v242, s[8:11], s53 offen offset:0 sc1
    v_mfma_f32_16x16x32_bf16 v[100:103], a[100:103], v[184:187], v[100:103]
    v_exp_f32 v133, v133
    v_mfma_f32_16x16x32_bf16 v[104:107], a[104:107], v[184:187], v[104:107]
    ds_read_b128 a[88:91], v234 offset:20480
    v_cvt_pk_bf16_f32 v130, v132, v133
    v_mfma_f32_16x16x32_bf16 v[108:111], a[108:111], v[184:187], v[108:111]
    v_exp_f32 v134, v134
    v_mfma_f32_16x16x32_bf16 v[112:115], a[112:115], v[184:187], v[112:115]
    s_add_u32 s65, s65, 4096
    buffer_load_dwordx4 a[180:183], v242, s[8:11], s65 offen offset:0 sc1
    v_mfma_f32_16x16x32_bf16 v[116:119], a[116:119], v[184:187], v[116:119]
    v_exp_f32 v135, v135
    v_mfma_f32_16x16x32_bf16 v[120:123], a[120:123], v[184:187], v[120:123]
    ds_read_b128 a[92:95], v235 offset:20480
    v_cvt_pk_bf16_f32 v131, v134, v135
    v_mfma_f32_16x16x32_bf16 v[124:127], a[124:127], v[184:187], v[124:127]
    v_mfma_f32_16x16x32_bf16 a[252:255], v[220:223], v[184:187], a[252:255]
    s_waitcnt vmcnt(39) lgkmcnt(4)
    v_mfma_f32_16x16x32_bf16 a[224:227], a[216:219], a[184:187], a[224:227]
    ds_read_b64_tr_b16 a[208:209], v208 offset:16384
    ds_read_b64_tr_b16 a[210:211], v208 offset:17408
    v_mfma_f32_16x16x32_bf16 a[232:235], a[216:219], a[188:191], a[232:235]
    ds_read_b64_tr_b16 a[212:213], v209 offset:16384
    ds_read_b64_tr_b16 a[214:215], v209 offset:17408
    v_mfma_f32_16x16x32_bf16 a[228:231], a[220:223], a[184:187], a[228:231]
    v_mfma_f32_16x16x32_bf16 a[236:239], a[220:223], a[188:191], a[236:239]
    v_mfma_f32_16x16x32_bf16 v[160:163], a[64:67], a[0:3], v[192:195]
    v_exp_f32 v136, v136
    v_mfma_f32_16x16x32_bf16 v[160:163], a[68:71], a[4:7], v[160:163]
    ds_read_b64_tr_b16 a[96:97], v224 offset:8192
    ds_read_b64_tr_b16 a[98:99], v224 offset:12288
    v_mfma_f32_16x16x32_bf16 v[160:163], a[72:75], a[8:11], v[160:163]
    v_exp_f32 v137, v137
    v_mfma_f32_16x16x32_bf16 v[160:163], a[76:79], a[12:15], v[160:163]
    s_waitcnt lgkmcnt(6)
    ds_read_b64_tr_b16 a[100:101], v225 offset:8192
    v_cvt_pk_bf16_f32 v136, v136, v137
    v_mfma_f32_16x16x32_bf16 v[164:167], a[80:83], a[0:3], v[192:195]
    v_exp_f32 v138, v138
    v_mfma_f32_16x16x32_bf16 v[164:167], a[84:87], a[4:7], v[164:167]
    s_mul_i32 s100, s3, 6144
    s_add_u32 s100, s100, 3072
    v_min_u32 v218, 752, v242
    v_lshlrev_b32 v218, 3, v218
    v_mfma_f32_16x16x32_bf16 v[164:167], a[88:91], a[8:11], v[164:167]
    v_exp_f32 v139, v139
    v_mfma_f32_16x16x32_bf16 v[164:167], a[92:95], a[12:15], v[164:167]
    ds_read_b64_tr_b16 a[102:103], v225 offset:12288
    v_cvt_pk_bf16_f32 v137, v138, v139
    v_mfma_f32_16x16x32_bf16 v[168:171], a[64:67], a[16:19], v[196:199]
    v_exp_f32 v140, v140
    v_mfma_f32_16x16x32_bf16 v[168:171], a[68:71], a[20:23], v[168:171]
    ds_read_b64_tr_b16 a[104:105], v226 offset:8192
    ds_read_b64_tr_b16 a[106:107], v226 offset:12288
    v_mfma_f32_16x16x32_bf16 v[168:171], a[72:75], a[24:27], v[168:171]
    v_exp_f32 v141, v141
    v_mfma_f32_16x16x32_bf16 v[168:171], a[76:79], a[28:31], v[168:171]
    ds_read_b64_tr_b16 a[108:109], v227 offset:8192
    v_cvt_pk_bf16_f32 v138, v140, v141
    v_mfma_f32_16x16x32_bf16 v[172:175], a[80:83], a[16:19], v[196:199]
    v_exp_f32 v142, v142
    v_mfma_f32_16x16x32_bf16 v[172:175], a[84:87], a[20:23], v[172:175]
    v_add_u32 v218, s100, v218
    v_min_u32 v218, code_end-ct_site1-8, v218
    v_mfma_f32_16x16x32_bf16 v[172:175], a[88:91], a[24:27], v[172:175]
    v_exp_f32 v143, v143
    v_mfma_f32_16x16x32_bf16 v[172:175], a[92:95], a[28:31], v[172:175]
    ds_read_b64_tr_b16 a[110:111], v227 offset:12288
    v_cvt_pk_bf16_f32 v139, v142, v143
    s_waitcnt vmcnt(37) lgkmcnt(8)
    v_mfma_f32_16x16x32_bf16 a[224:227], a[208:211], a[192:195], a[224:227]
    ds_read_b64_tr_b16 a[216:217], v208 offset:18432
    ds_read_b64_tr_b16 a[218:219], v208 offset:19456
    v_mfma_f32_16x16x32_bf16 a[232:235], a[208:211], a[196:199], a[232:235]
    ds_read_b64_tr_b16 a[220:221], v209 offset:18432
    ds_read_b64_tr_b16 a[222:223], v209 offset:19456
    v_mfma_f32_16x16x32_bf16 a[228:231], a[212:215], a[192:195], a[228:231]
    buffer_load_dwordx4 a[184:187], v242, s[8:11], s53 offen offset:1024 sc1
    v_mfma_f32_16x16x32_bf16 a[236:239], a[212:215], a[196:199], a[236:239]
    buffer_load_dwordx4 a[188:191], v242, s[8:11], s65 offen offset:1024 sc1
    v_mfma_f32_16x16x32_bf16 v[176:179], a[64:67], a[32:35], v[200:203]
    v_exp_f32 v144, v144
    v_mfma_f32_16x16x32_bf16 v[176:179], a[68:71], a[36:39], v[176:179]
    ds_read_b64_tr_b16 a[112:113], v228 offset:8192
    ds_read_b64_tr_b16 a[114:115], v228 offset:12288
    v_mfma_f32_16x16x32_bf16 v[176:179], a[72:75], a[40:43], v[176:179]
    v_exp_f32 v145, v145
    v_mfma_f32_16x16x32_bf16 v[176:179], a[76:79], a[44:47], v[176:179]
    ds_read_b64_tr_b16 a[116:117], v229 offset:8192
    v_cvt_pk_bf16_f32 v144, v144, v145
    v_mfma_f32_16x16x32_bf16 v[180:183], a[80:83], a[32:35], v[200:203]
    v_exp_f32 v146, v146
    v_mfma_f32_16x16x32_bf16 v[180:183], a[84:87], a[36:39], v[180:183]
    buffer_load_dwordx4 a[192:195], v242, s[8:11], s53 offen offset:2048 sc1
    v_mfma_f32_16x16x32_bf16 v[180:183], a[88:91], a[40:43], v[180:183]
    v_exp_f32 v147, v147
    v_mfma_f32_16x16x32_bf16 v[180:183], a[92:95], a[44:47], v[180:183]
    ds_read_b64_tr_b16 a[118:119], v229 offset:12288
    v_cvt_pk_bf16_f32 v145, v146, v147
    v_mfma_f32_16x16x32_bf16 v[184:187], a[64:67], a[48:51], v[204:207]
    v_exp_f32 v148, v148
    v_mfma_f32_16x16x32_bf16 v[184:187], a[68:71], a[52:55], v[184:187]
    ds_read_b64_tr_b16 a[120:121], v230 offset:8192
    ds_read_b64_tr_b16 a[122:123], v230 offset:12288
    v_mfma_f32_16x16x32_bf16 v[184:187], a[72:75], a[56:59], v[184:187]
    v_exp_f32 v149, v149
    v_mfma_f32_16x16x32_bf16 v[184:187], a[76:79], a[60:63], v[184:187]
    ds_read_b64_tr_b16 a[124:125], v231 offset:8192
    v_cvt_pk_bf16_f32 v146, v148, v149
    v_mfma_f32_16x16x32_bf16 v[188:191], a[80:83], a[48:51], v[204:207]
    v_exp_f32 v150, v150
    v_mfma_f32_16x16x32_bf16 v[188:191], a[84:87], a[52:55], v[188:191]
    buffer_load_dwordx4 a[196:199], v242, s[8:11], s65 offen offset:2048 sc1
    v_mfma_f32_16x16x32_bf16 v[188:191], a[88:91], a[56:59], v[188:191]
    v_exp_f32 v151, v151
    v_mfma_f32_16x16x32_bf16 v[188:191], a[92:95], a[60:63], v[188:191]
    s_waitcnt lgkmcnt(11)
    ds_read_b64_tr_b16 a[126:127], v231 offset:12288
    v_cvt_pk_bf16_f32 v147, v150, v151
    s_waitcnt vmcnt(38) lgkmcnt(8)
    v_mfma_f32_16x16x32_bf16 a[224:227], a[216:219], a[200:203], a[224:227]
    ds_read_b64_tr_b16 a[208:209], v208 offset:20480
    ds_read_b64_tr_b16 a[210:211], v208 offset:21504
    v_mfma_f32_16x16x32_bf16 a[232:235], a[216:219], a[204:207], a[232:235]
    ds_read_b64_tr_b16 a[212:213], v209 offset:20480
    ds_read_b64_tr_b16 a[214:215], v209 offset:21504
    v_mfma_f32_16x16x32_bf16 a[228:231], a[220:223], a[200:203], a[228:231]
    v_mfma_f32_16x16x32_bf16 a[236:239], a[220:223], a[204:207], a[236:239]
    v_mfma_f32_16x16x32_bf16 v[0:3], a[96:99], v[128:131], v[0:3]
    v_exp_f32 v152, v152
    v_mfma_f32_16x16x32_bf16 v[4:7], a[100:103], v[128:131], v[4:7]
    s_getpc_b64 s[100:101]
ct_site1:
    global_load_dword v218, v218, s[100:101]
    v_mfma_f32_16x16x32_bf16 v[8:11], a[104:107], v[128:131], v[8:11]
    v_exp_f32 v153, v153
    v_mfma_f32_16x16x32_bf16 v[12:15], a[108:111], v[128:131], v[12:15]
    s_waitcnt lgkmcnt(4)
    ds_read_b128 a[64:67], v232 offset:24576
    v_cvt_pk_bf16_f32 v152, v152, v153
    v_mfma_f32_16x16x32_bf16 v[16:19], a[112:115], v[128:131], v[16:19]
    v_exp_f32 v154, v154
    v_mfma_f32_16x16x32_bf16 v[20:23], a[116:119], v[128:131], v[20:23]
    buffer_load_dwordx4 a[200:203], v242, s[8:11], s53 offen offset:3072 sc1
    v_mfma_f32_16x16x32_bf16 v[24:27], a[120:123], v[128:131], v[24:27]
    v_exp_f32 v155, v155
    v_mfma_f32_16x16x32_bf16 v[28:31], a[124:127], v[128:131], v[28:31]
    ds_read_b128 a[68:71], v233 offset:24576
    v_cvt_pk_bf16_f32 v153, v154, v155
    v_mfma_f32_16x16x32_bf16 a[240:243], v[220:223], v[128:131], a[240:243]
    v_exp_f32 v156, v156
    v_mfma_f32_16x16x32_bf16 v[32:35], a[96:99], v[136:139], v[32:35]
    buffer_load_dwordx4 a[204:207], v242, s[8:11], s65 offen offset:3072 sc1
    v_mfma_f32_16x16x32_bf16 v[36:39], a[100:103], v[136:139], v[36:39]
    v_exp_f32 v157, v157
    v_mfma_f32_16x16x32_bf16 v[40:43], a[104:107], v[136:139], v[40:43]
    ds_read_b128 a[72:75], v234 offset:24576
    v_cvt_pk_bf16_f32 v154, v156, v157
    v_mfma_f32_16x16x32_bf16 v[44:47], a[108:111], v[136:139], v[44:47]
    v_exp_f32 v158, v158
    v_mfma_f32_16x16x32_bf16 v[48:51], a[112:115], v[136:139], v[48:51]
    v_mfma_f32_16x16x32_bf16 v[52:55], a[116:119], v[136:139], v[52:55]
    v_exp_f32 v159, v159
    v_mfma_f32_16x16x32_bf16 v[56:59], a[120:123], v[136:139], v[56:59]
    ds_read_b128 a[76:79], v235 offset:24576
    v_cvt_pk_bf16_f32 v155, v158, v159
    v_mfma_f32_16x16x32_bf16 v[60:63], a[124:127], v[136:139], v[60:63]
    v_mfma_f32_16x16x32_bf16 a[244:247], v[220:223], v[136:139], a[244:247]
    s_waitcnt vmcnt(27) lgkmcnt(4)
    v_mfma_f32_16x16x32_bf16 a[224:227], a[208:211], a[128:131], a[224:227]
    ds_read_b64_tr_b16 a[216:217], v208 offset:22528
    ds_read_b64_tr_b16 a[218:219], v208 offset:23552
    v_mfma_f32_16x16x32_bf16 a[232:235], a[208:211], a[132:135], a[232:235]
    ds_read_b64_tr_b16 a[220:221], v209 offset:22528
    ds_read_b64_tr_b16 a[222:223], v209 offset:23552
    v_mfma_f32_16x16x32_bf16 a[228:231], a[212:215], a[128:131], a[228:231]
    v_mfma_f32_16x16x32_bf16 a[236:239], a[212:215], a[132:135], a[236:239]
    v_mfma_f32_16x16x32_bf16 v[64:67], a[96:99], v[144:147], v[64:67]
    v_exp_f32 v160, v160
    v_mfma_f32_16x16x32_bf16 v[68:71], a[100:103], v[144:147], v[68:71]
    s_add_u32 s53, s53, 4096
    buffer_load_dwordx4 a[128:131], v242, s[8:11], s53 offen offset:0 sc1
    v_mfma_f32_16x16x32_bf16 v[72:75], a[104:107], v[144:147], v[72:75]
    v_exp_f32 v161, v161
    v_mfma_f32_16x16x32_bf16 v[76:79], a[108:111], v[144:147], v[76:79]
    ds_read_b128 a[80:83], v232 offset:28672
    v_cvt_pk_bf16_f32 v160, v160, v161
    v_mfma_f32_16x16x32_bf16 v[80:83], a[112:115], v[144:147], v[80:83]
    v_exp_f32 v162, v162
    v_mfma_f32_16x16x32_bf16 v[84:87], a[116:119], v[144:147], v[84:87]
    s_add_u32 s65, s65, 4096
    buffer_load_dwordx4 a[132:135], v242, s[8:11], s65 offen offset:0 sc1
    v_mfma_f32_16x16x32_bf16 v[88:91], a[120:123], v[144:147], v[88:91]
    v_exp_f32 v163, v163
    v_mfma_f32_16x16x32_bf16 v[92:95], a[124:127], v[144:147], v[92:95]
    ds_read_b128 a[84:87], v233 offset:28672
    v_cvt_pk_bf16_f32 v161, v162, v163
    v_mfma_f32_16x16x32_bf16 a[248:251], v[220:223], v[144:147], a[248:251]
    v_exp_f32 v164, v164
    v_mfma_f32_16x16x32_bf16 v[96:99], a[96:99], v[152:155], v[96:99]
    v_mfma_f32_16x16x32_bf16 v[100:103], a[100:103], v[152:155], v[100:103]
    v_exp_f32 v165, v165
    v_mfma_f32_16x16x32_bf16 v[104:107], a[104:107], v[152:155], v[104:107]
    ds_read_b128 a[88:91], v234 offset:28672
    v_cvt_pk_bf16_f32 v162, v164, v165
    v_mfma_f32_16x16x32_bf16 v[108:111], a[108:111], v[152:155], v[108:111]
    v_exp_f32 v166, v166
    v_mfma_f32_16x16x32_bf16 v[112:115], a[112:115], v[152:155], v[112:115]
    v_mfma_f32_16x16x32_bf16 v[116:119], a[116:119], v[152:155], v[116:119]
    v_exp_f32 v167, v167
    v_mfma_f32_16x16x32_bf16 v[120:123], a[120:123], v[152:155], v[120:123]
    ds_read_b128 a[92:95], v235 offset:28672
    v_cvt_pk_bf16_f32 v163, v166, v167
    v_mfma_f32_16x16x32_bf16 v[124:127], a[124:127], v[152:155], v[124:127]
    v_mfma_f32_16x16x32_bf16 a[252:255], v[220:223], v[152:155], a[252:255]
    s_waitcnt vmcnt(27) lgkmcnt(4)
    v_mfma_f32_16x16x32_bf16 a[224:227], a[216:219], a[136:139], a[224:227]
    ds_read_b64_tr_b16 a[208:209], v208 offset:24576
    ds_read_b64_tr_b16 a[210:211], v208 offset:25600
    v_mfma_f32_16x16x32_bf16 a[232:235], a[216:219], a[140:143], a[232:235]
    ds_read_b64_tr_b16 a[212:213], v209 offset:24576
    ds_read_b64_tr_b16 a[214:215], v209 offset:25600
    v_mfma_f32_16x16x32_bf16 a[228:231], a[220:223], a[136:139], a[228:231]
    v_mfma_f32_16x16x32_bf16 a[236:239], a[220:223], a[140:143], a[236:239]
    s_waitcnt vmcnt(25) lgkmcnt(0)
    v_mfma_f32_16x16x32_bf16 a[224:227], a[208:211], a[144:147], a[224:227]
    ds_read_b64_tr_b16 a[216:217], v208 offset:26624
    ds_read_b64_tr_b16 a[218:219], v208 offset:27648
    v_mfma_f32_16x16x32_bf16 a[232:235], a[208:211], a[148:151], a[232:235]
    ds_read_b64_tr_b16 a[220:221], v209 offset:26624
    ds_read_b64_tr_b16 a[222:223], v209 offset:27648
    v_mfma_f32_16x16x32_bf16 a[228:231], a[212:215], a[144:147], a[228:231]
    v_mfma_f32_16x16x32_bf16 a[236:239], a[212:215], a[148:151], a[236:239]
    v_mfma_f32_16x16x32_bf16 v[128:131], a[64:67], a[0:3], v[192:195]
    v_exp_f32 v168, v168
    v_mfma_f32_16x16x32_bf16 v[128:131], a[68:71], a[4:7], v[128:131]
    ds_read_b64_tr_b16 a[96:97], v224 offset:16384
    ds_read_b64_tr_b16 a[98:99], v224 offset:20480
    v_mfma_f32_16x16x32_bf16 v[128:131], a[72:75], a[8:11], v[128:131]
    v_exp_f32 v169, v169
    v_mfma_f32_16x16x32_bf16 v[128:131], a[76:79], a[12:15], v[128:131]
    s_waitcnt vmcnt(17)
    s_barrier
    ds_read_b64_tr_b16 a[100:101], v225 offset:16384
    v_cvt_pk_bf16_f32 v168, v168, v169
    v_mfma_f32_16x16x32_bf16 v[132:135], a[80:83], a[0:3], v[192:195]
    v_exp_f32 v170, v170
    v_mfma_f32_16x16x32_bf16 v[132:135], a[84:87], a[4:7], v[132:135]
    buffer_load_dwordx4 a[136:139], v242, s[8:11], s53 offen offset:1024 sc1
    v_mfma_f32_16x16x32_bf16 v[132:135], a[88:91], a[8:11], v[132:135]
    v_exp_f32 v171, v171
    v_mfma_f32_16x16x32_bf16 v[132:135], a[92:95], a[12:15], v[132:135]
    ds_read_b64_tr_b16 a[102:103], v225 offset:20480
    v_cvt_pk_bf16_f32 v169, v170, v171
    v_mfma_f32_16x16x32_bf16 v[136:139], a[64:67], a[16:19], v[196:199]
    v_exp_f32 v172, v172
    v_mfma_f32_16x16x32_bf16 v[136:139], a[68:71], a[20:23], v[136:139]
    ds_read_b64_tr_b16 a[104:105], v226 offset:16384
    ds_read_b64_tr_b16 a[106:107], v226 offset:20480
    v_mfma_f32_16x16x32_bf16 v[136:139], a[72:75], a[24:27], v[136:139]
    v_exp_f32 v173, v173
    v_mfma_f32_16x16x32_bf16 v[136:139], a[76:79], a[28:31], v[136:139]
    ds_read_b64_tr_b16 a[108:109], v227 offset:16384
    v_cvt_pk_bf16_f32 v170, v172, v173
    v_mfma_f32_16x16x32_bf16 v[140:143], a[80:83], a[16:19], v[196:199]
    v_exp_f32 v174, v174
    v_mfma_f32_16x16x32_bf16 v[140:143], a[84:87], a[20:23], v[140:143]
    buffer_load_dwordx4 a[140:143], v242, s[8:11], s65 offen offset:1024 sc1
    v_mfma_f32_16x16x32_bf16 v[140:143], a[88:91], a[24:27], v[140:143]
    v_exp_f32 v175, v175
    v_mfma_f32_16x16x32_bf16 v[140:143], a[92:95], a[28:31], v[140:143]
    ds_read_b64_tr_b16 a[110:111], v227 offset:20480
    v_cvt_pk_bf16_f32 v171, v174, v175
    s_waitcnt lgkmcnt(8)
    v_mfma_f32_16x16x32_bf16 a[224:227], a[216:219], a[152:155], a[224:227]
    ds_read_b64_tr_b16 a[208:209], v208 offset:28672
    ds_read_b64_tr_b16 a[210:211], v208 offset:29696
    v_mfma_f32_16x16x32_bf16 a[232:235], a[216:219], a[156:159], a[232:235]
    ds_read_b64_tr_b16 a[212:213], v209 offset:28672
    ds_read_b64_tr_b16 a[214:215], v209 offset:29696
    v_mfma_f32_16x16x32_bf16 a[228:231], a[220:223], a[152:155], a[228:231]
    buffer_load_dwordx4 a[144:147], v242, s[8:11], s53 offen offset:2048 sc1
    v_mfma_f32_16x16x32_bf16 a[236:239], a[220:223], a[156:159], a[236:239]
    buffer_load_dwordx4 a[148:151], v242, s[8:11], s65 offen offset:2048 sc1
    v_mfma_f32_16x16x32_bf16 v[144:147], a[64:67], a[32:35], v[200:203]
    v_exp_f32 v176, v176
    v_mfma_f32_16x16x32_bf16 v[144:147], a[68:71], a[36:39], v[144:147]
    ds_read_b64_tr_b16 a[112:113], v228 offset:16384
    ds_read_b64_tr_b16 a[114:115], v228 offset:20480
    v_mfma_f32_16x16x32_bf16 v[144:147], a[72:75], a[40:43], v[144:147]
    v_exp_f32 v177, v177
    v_mfma_f32_16x16x32_bf16 v[144:147], a[76:79], a[44:47], v[144:147]
    ds_read_b64_tr_b16 a[116:117], v229 offset:16384
    v_cvt_pk_bf16_f32 v176, v176, v177
    v_mfma_f32_16x16x32_bf16 v[148:151], a[80:83], a[32:35], v[200:203]
    v_exp_f32 v178, v178
    v_mfma_f32_16x16x32_bf16 v[148:151], a[84:87], a[36:39], v[148:151]
    s_add_u32 m0, s81, 114688
    s_mov_b32 s55, 786432
    buffer_load_dwordx4 v254, s[32:35], s55 offen lds
    v_mfma_f32_16x16x32_bf16 v[148:151], a[88:91], a[40:43], v[148:151]
    v_exp_f32 v179, v179
    v_mfma_f32_16x16x32_bf16 v[148:151], a[92:95], a[44:47], v[148:151]
    ds_read_b64_tr_b16 a[118:119], v229 offset:20480
    v_cvt_pk_bf16_f32 v177, v178, v179
    v_mfma_f32_16x16x32_bf16 v[152:155], a[64:67], a[48:51], v[204:207]
    v_exp_f32 v180, v180
    v_mfma_f32_16x16x32_bf16 v[152:155], a[68:71], a[52:55], v[152:155]
    ds_read_b64_tr_b16 a[120:121], v230 offset:16384
    ds_read_b64_tr_b16 a[122:123], v230 offset:20480
    v_mfma_f32_16x16x32_bf16 v[152:155], a[72:75], a[56:59], v[152:155]
    v_exp_f32 v181, v181
    v_mfma_f32_16x16x32_bf16 v[152:155], a[76:79], a[60:63], v[152:155]
    ds_read_b64_tr_b16 a[124:125], v231 offset:16384
    v_cvt_pk_bf16_f32 v178, v180, v181
    v_mfma_f32_16x16x32_bf16 v[156:159], a[80:83], a[48:51], v[204:207]
    v_exp_f32 v182, v182
    v_mfma_f32_16x16x32_bf16 v[156:159], a[84:87], a[52:55], v[156:159]
    s_add_u32 m0, s81, 118784
    s_mov_b32 s55, 851968
    buffer_load_dwordx4 v254, s[32:35], s55 offen lds
    v_mfma_f32_16x16x32_bf16 v[156:159], a[88:91], a[56:59], v[156:159]
    v_exp_f32 v183, v183
    v_mfma_f32_16x16x32_bf16 v[156:159], a[92:95], a[60:63], v[156:159]
    s_waitcnt lgkmcnt(11)
    ds_read_b64_tr_b16 a[126:127], v231 offset:20480
    v_cvt_pk_bf16_f32 v179, v182, v183
    s_waitcnt lgkmcnt(8)
    v_mfma_f32_16x16x32_bf16 a[224:227], a[208:211], a[160:163], a[224:227]
    ds_read_b64_tr_b16 a[216:217], v208 offset:30720
    ds_read_b64_tr_b16 a[218:219], v208 offset:31744
    v_mfma_f32_16x16x32_bf16 a[232:235], a[208:211], a[164:167], a[232:235]
    ds_read_b64_tr_b16 a[220:221], v209 offset:30720
    ds_read_b64_tr_b16 a[222:223], v209 offset:31744
    v_mfma_f32_16x16x32_bf16 a[228:231], a[212:215], a[160:163], a[228:231]
    s_add_u32 m0, s81, 122880
    s_mov_b32 s55, 917504
    buffer_load_dwordx4 v254, s[32:35], s55 offen lds
    v_mfma_f32_16x16x32_bf16 a[236:239], a[212:215], a[164:167], a[236:239]
    s_add_u32 m0, s81, 126976
    s_mov_b32 s55, 983040
    buffer_load_dwordx4 v254, s[32:35], s55 offen lds
    v_mfma_f32_16x16x32_bf16 v[0:3], a[96:99], v[160:163], v[0:3]
    v_exp_f32 v184, v184
    v_mfma_f32_16x16x32_bf16 v[4:7], a[100:103], v[160:163], v[4:7]
    s_add_u32 m0, s81, 0
    s_mov_b32 s55, 1048576
    buffer_load_dwordx4 v254, s[32:35], s55 offen lds
    v_mfma_f32_16x16x32_bf16 v[8:11], a[104:107], v[160:163], v[8:11]
    v_exp_f32 v185, v185
    v_mfma_f32_16x16x32_bf16 v[12:15], a[108:111], v[160:163], v[12:15]
    s_waitcnt lgkmcnt(4)
    ds_read_b128 a[64:67], v232 offset:32768
    v_cvt_pk_bf16_f32 v184, v184, v185
    v_mfma_f32_16x16x32_bf16 v[16:19], a[112:115], v[160:163], v[16:19]
    v_exp_f32 v186, v186
    v_mfma_f32_16x16x32_bf16 v[20:23], a[116:119], v[160:163], v[20:23]
    s_add_u32 m0, s81, 4096
    s_mov_b32 s55, 1114112
    buffer_load_dwordx4 v254, s[32:35], s55 offen lds
    v_mfma_f32_16x16x32_bf16 v[24:27], a[120:123], v[160:163], v[24:27]
    v_exp_f32 v187, v187
    v_mfma_f32_16x16x32_bf16 v[28:31], a[124:127], v[160:163], v[28:31]
    ds_read_b128 a[68:71], v233 offset:32768
    v_cvt_pk_bf16_f32 v185, v186, v187
    v_mfma_f32_16x16x32_bf16 a[240:243], v[220:223], v[160:163], a[240:243]
    v_exp_f32 v188, v188
    v_mfma_f32_16x16x32_bf16 v[32:35], a[96:99], v[168:171], v[32:35]
    s_add_u32 m0, s81, 8192
    s_mov_b32 s55, 1179648
    buffer_load_dwordx4 v254, s[32:35], s55 offen lds
    v_mfma_f32_16x16x32_bf16 v[36:39], a[100:103], v[168:171], v[36:39]
    v_exp_f32 v189, v189
    v_mfma_f32_16x16x32_bf16 v[40:43], a[104:107], v[168:171], v[40:43]
    ds_read_b128 a[72:75], v234 offset:32768
    v_cvt_pk_bf16_f32 v186, v188, v189
    v_mfma_f32_16x16x32_bf16 v[44:47], a[108:111], v[168:171], v[44:47]
    v_exp_f32 v190, v190
    v_mfma_f32_16x16x32_bf16 v[48:51], a[112:115], v[168:171], v[48:51]
    s_add_u32 m0, s81, 12288
    s_mov_b32 s55, 1245184
    buffer_load_dwordx4 v254, s[32:35], s55 offen lds
    v_mfma_f32_16x16x32_bf16 v[52:55], a[116:119], v[168:171], v[52:55]
    v_exp_f32 v191, v191
    v_mfma_f32_16x16x32_bf16 v[56:59], a[120:123], v[168:171], v[56:59]
    ds_read_b128 a[76:79], v235 offset:32768
    v_cvt_pk_bf16_f32 v187, v190, v191
    v_mfma_f32_16x16x32_bf16 v[60:63], a[124:127], v[168:171], v[60:63]
    buffer_load_dwordx4 a[152:155], v242, s[8:11], s53 offen offset:3072 sc1
    v_mfma_f32_16x16x32_bf16 a[244:247], v[220:223], v[168:171], a[244:247]
    s_waitcnt vmcnt(24) lgkmcnt(4)
    v_mfma_f32_16x16x32_bf16 a[224:227], a[216:219], a[168:171], a[224:227]
    ds_read_b64_tr_b16 a[208:209], v208 offset:32768
    ds_read_b64_tr_b16 a[210:211], v208 offset:33792
    v_mfma_f32_16x16x32_bf16 a[232:235], a[216:219], a[172:175], a[232:235]
    ds_read_b64_tr_b16 a[212:213], v209 offset:32768
    ds_read_b64_tr_b16 a[214:215], v209 offset:33792
    v_mfma_f32_16x16x32_bf16 a[228:231], a[220:223], a[168:171], a[228:231]
    buffer_load_dwordx4 a[156:159], v242, s[8:11], s65 offen offset:3072 sc1
    v_mfma_f32_16x16x32_bf16 a[236:239], a[220:223], a[172:175], a[236:239]
    s_add_u32 s53, s53, 4096
    buffer_load_dwordx4 a[160:163], v242, s[8:11], s53 offen offset:0 sc1
    v_mfma_f32_16x16x32_bf16 v[64:67], a[96:99], v[176:179], v[64:67]
    v_exp_f32 v128, v128
    v_mfma_f32_16x16x32_bf16 v[68:71], a[100:103], v[176:179], v[68:71]
    s_add_u32 s65, s65, 4096
    buffer_load_dwordx4 a[164:167], v242, s[8:11], s65 offen offset:0 sc1
    v_mfma_f32_16x16x32_bf16 v[72:75], a[104:107], v[176:179], v[72:75]
    v_exp_f32 v129, v129
    v_mfma_f32_16x16x32_bf16 v[76:79], a[108:111], v[176:179], v[76:79]
    ds_read_b128 a[80:83], v232 offset:36864
    v_cvt_pk_bf16_f32 v128, v128, v129
    v_mfma_f32_16x16x32_bf16 v[80:83], a[112:115], v[176:179], v[80:83]
    v_exp_f32 v130, v130
    v_mfma_f32_16x16x32_bf16 v[84:87], a[116:119], v[176:179], v[84:87]
    buffer_load_dwordx4 a[168:171], v242, s[8:11], s53 offen offset:1024 sc1
    v_mfma_f32_16x16x32_bf16 v[88:91], a[120:123], v[176:179], v[88:91]
    v_exp_f32 v131, v131
    v_mfma_f32_16x16x32_bf16 v[92:95], a[124:127], v[176:179], v[92:95]
    ds_read_b128 a[84:87], v233 offset:36864
    v_cvt_pk_bf16_f32 v129, v130, v131
    v_mfma_f32_16x16x32_bf16 a[248:251], v[220:223], v[176:179], a[248:251]
    v_exp_f32 v132, v132
    v_mfma_f32_16x16x32_bf16 v[96:99], a[96:99], v[184:187], v[96:99]
    buffer_load_dwordx4 a[172:175], v242, s[8:11], s65 offen offset:1024 sc1
    v_mfma_f32_16x16x32_bf16 v[100:103], a[100:103], v[184:187], v[100:103]
    v_exp_f32 v133, v133
    v_mfma_f32_16x16x32_bf16 v[104:107], a[104:107], v[184:187], v[104:107]
    ds_read_b128 a[88:91], v234 offset:36864
    v_cvt_pk_bf16_f32 v130, v132, v133
    v_mfma_f32_16x16x32_bf16 v[108:111], a[108:111], v[184:187], v[108:111]
    v_exp_f32 v134, v134
    v_mfma_f32_16x16x32_bf16 v[112:115], a[112:115], v[184:187], v[112:115]
    v_mfma_f32_16x16x32_bf16 v[116:119], a[116:119], v[184:187], v[116:119]
    v_exp_f32 v135, v135
    v_mfma_f32_16x16x32_bf16 v[120:123], a[120:123], v[184:187], v[120:123]
    ds_read_b128 a[92:95], v235 offset:36864
    v_cvt_pk_bf16_f32 v131, v134, v135
    v_mfma_f32_16x16x32_bf16 v[124:127], a[124:127], v[184:187], v[124:127]
    v_mfma_f32_16x16x32_bf16 a[252:255], v[220:223], v[184:187], a[252:255]
    s_waitcnt vmcnt(27) lgkmcnt(4)
    v_mfma_f32_16x16x32_bf16 a[224:227], a[208:211], a[176:179], a[224:227]
    ds_read_b64_tr_b16 a[216:217], v208 offset:34816
    ds_read_b64_tr_b16 a[218:219], v208 offset:35840
    v_mfma_f32_16x16x32_bf16 a[232:235], a[208:211], a[180:183], a[232:235]
    ds_read_b64_tr_b16 a[220:221], v209 offset:34816
    ds_read_b64_tr_b16 a[222:223], v209 offset:35840
    v_mfma_f32_16x16x32_bf16 a[228:231], a[212:215], a[176:179], a[228:231]
    v_mfma_f32_16x16x32_bf16 a[236:239], a[212:215], a[180:183], a[236:239]
    s_waitcnt vmcnt(25) lgkmcnt(0)
    v_mfma_f32_16x16x32_bf16 a[224:227], a[216:219], a[184:187], a[224:227]
    ds_read_b64_tr_b16 a[208:209], v208 offset:36864
    ds_read_b64_tr_b16 a[210:211], v208 offset:37888
    v_mfma_f32_16x16x32_bf16 a[232:235], a[216:219], a[188:191], a[232:235]
    ds_read_b64_tr_b16 a[212:213], v209 offset:36864
    ds_read_b64_tr_b16 a[214:215], v209 offset:37888
    v_mfma_f32_16x16x32_bf16 a[228:231], a[220:223], a[184:187], a[228:231]
    v_mfma_f32_16x16x32_bf16 a[236:239], a[220:223], a[188:191], a[236:239]
    v_mfma_f32_16x16x32_bf16 v[160:163], a[64:67], a[0:3], v[192:195]
    v_exp_f32 v136, v136
    v_mfma_f32_16x16x32_bf16 v[160:163], a[68:71], a[4:7], v[160:163]
    ds_read_b64_tr_b16 a[96:97], v224 offset:24576
    ds_read_b64_tr_b16 a[98:99], v224 offset:28672
    v_mfma_f32_16x16x32_bf16 v[160:163], a[72:75], a[8:11], v[160:163]
    v_exp_f32 v137, v137
    v_mfma_f32_16x16x32_bf16 v[160:163], a[76:79], a[12:15], v[160:163]
    ds_read_b64_tr_b16 a[100:101], v225 offset:24576
    v_cvt_pk_bf16_f32 v136, v136, v137
    v_mfma_f32_16x16x32_bf16 v[164:167], a[80:83], a[0:3], v[192:195]
    v_exp_f32 v138, v138
    v_mfma_f32_16x16x32_bf16 v[164:167], a[84:87], a[4:7], v[164:167]
    v_lshrrev_b32 v214, 5, v242
    v_lshlrev_b32 v214, 10, v214
    v_mfma_f32_16x16x32_bf16 v[164:167], a[88:91], a[8:11], v[164:167]
    v_exp_f32 v139, v139
    v_mfma_f32_16x16x32_bf16 v[164:167], a[92:95], a[12:15], v[164:167]
    ds_read_b64_tr_b16 a[102:103], v225 offset:28672
    v_cvt_pk_bf16_f32 v137, v138, v139
    v_mfma_f32_16x16x32_bf16 v[168:171], a[64:67], a[16:19], v[196:199]
    v_exp_f32 v140, v140
    v_mfma_f32_16x16x32_bf16 v[168:171], a[68:71], a[20:23], v[168:171]
    ds_read_b64_tr_b16 a[104:105], v226 offset:24576
    ds_read_b64_tr_b16 a[106:107], v226 offset:28672
    v_mfma_f32_16x16x32_bf16 v[168:171], a[72:75], a[24:27], v[168:171]
    v_exp_f32 v141, v141
    v_mfma_f32_16x16x32_bf16 v[168:171], a[76:79], a[28:31], v[168:171]
    ds_read_b64_tr_b16 a[108:109], v227 offset:24576
    v_cvt_pk_bf16_f32 v138, v140, v141
    v_mfma_f32_16x16x32_bf16 v[172:175], a[80:83], a[16:19], v[196:199]
    v_exp_f32 v142, v142
    v_mfma_f32_16x16x32_bf16 v[172:175], a[84:87], a[20:23], v[172:175]
    s_and_b32 s82, s76, 7
    s_lshl_b32 s82, s82, 2
    s_add_u32 s82, s82, s3
    s_lshl_b32 s82, s82, 15
    v_and_b32 v215, 16, v242
    v_lshl_add_u32 v214, v215, 3, v214
    v_mfma_f32_16x16x32_bf16 v[172:175], a[88:91], a[24:27], v[172:175]
    v_exp_f32 v143, v143
    v_mfma_f32_16x16x32_bf16 v[172:175], a[92:95], a[28:31], v[172:175]
    ds_read_b64_tr_b16 a[110:111], v227 offset:28672
    v_cvt_pk_bf16_f32 v139, v142, v143
    s_waitcnt vmcnt(23) lgkmcnt(8)
    v_mfma_f32_16x16x32_bf16 a[224:227], a[208:211], a[192:195], a[224:227]
    ds_read_b64_tr_b16 a[216:217], v208 offset:38912
    ds_read_b64_tr_b16 a[218:219], v208 offset:39936
    v_mfma_f32_16x16x32_bf16 a[232:235], a[208:211], a[196:199], a[232:235]
    ds_read_b64_tr_b16 a[220:221], v209 offset:38912
    ds_read_b64_tr_b16 a[222:223], v209 offset:39936
    v_mfma_f32_16x16x32_bf16 a[228:231], a[212:215], a[192:195], a[228:231]
    buffer_load_dwordx4 a[176:179], v242, s[8:11], s53 offen offset:2048 sc1
    v_mfma_f32_16x16x32_bf16 a[236:239], a[212:215], a[196:199], a[236:239]
    buffer_load_dwordx4 a[180:183], v242, s[8:11], s65 offen offset:2048 sc1
    v_mfma_f32_16x16x32_bf16 v[176:179], a[64:67], a[32:35], v[200:203]
    v_exp_f32 v144, v144
    v_mfma_f32_16x16x32_bf16 v[176:179], a[68:71], a[36:39], v[176:179]
    ds_read_b64_tr_b16 a[112:113], v228 offset:24576
    ds_read_b64_tr_b16 a[114:115], v228 offset:28672
    v_mfma_f32_16x16x32_bf16 v[176:179], a[72:75], a[40:43], v[176:179]
    v_exp_f32 v145, v145
    v_mfma_f32_16x16x32_bf16 v[176:179], a[76:79], a[44:47], v[176:179]
    ds_read_b64_tr_b16 a[116:117], v229 offset:24576
    v_cvt_pk_bf16_f32 v144, v144, v145
    v_mfma_f32_16x16x32_bf16 v[180:183], a[80:83], a[32:35], v[200:203]
    v_exp_f32 v146, v146
    v_mfma_f32_16x16x32_bf16 v[180:183], a[84:87], a[36:39], v[180:183]
    buffer_load_dwordx4 a[184:187], v242, s[8:11], s53 offen offset:3072 sc1
    v_mfma_f32_16x16x32_bf16 v[180:183], a[88:91], a[40:43], v[180:183]
    v_exp_f32 v147, v147
    v_mfma_f32_16x16x32_bf16 v[180:183], a[92:95], a[44:47], v[180:183]
    ds_read_b64_tr_b16 a[118:119], v229 offset:28672
    v_cvt_pk_bf16_f32 v145, v146, v147
    v_mfma_f32_16x16x32_bf16 v[184:187], a[64:67], a[48:51], v[204:207]
    v_exp_f32 v148, v148
    v_mfma_f32_16x16x32_bf16 v[184:187], a[68:71], a[52:55], v[184:187]
    ds_read_b64_tr_b16 a[120:121], v230 offset:24576
    ds_read_b64_tr_b16 a[122:123], v230 offset:28672
    v_mfma_f32_16x16x32_bf16 v[184:187], a[72:75], a[56:59], v[184:187]
    v_exp_f32 v149, v149
    v_mfma_f32_16x16x32_bf16 v[184:187], a[76:79], a[60:63], v[184:187]
    ds_read_b64_tr_b16 a[124:125], v231 offset:24576
    v_cvt_pk_bf16_f32 v146, v148, v149
    v_mfma_f32_16x16x32_bf16 v[188:191], a[80:83], a[48:51], v[204:207]
    v_exp_f32 v150, v150
    v_mfma_f32_16x16x32_bf16 v[188:191], a[84:87], a[52:55], v[188:191]
    buffer_load_dwordx4 a[188:191], v242, s[8:11], s65 offen offset:3072 sc1
    v_mfma_f32_16x16x32_bf16 v[188:191], a[88:91], a[56:59], v[188:191]
    v_exp_f32 v151, v151
    v_mfma_f32_16x16x32_bf16 v[188:191], a[92:95], a[60:63], v[188:191]
    s_waitcnt lgkmcnt(11)
    ds_read_b64_tr_b16 a[126:127], v231 offset:28672
    v_cvt_pk_bf16_f32 v147, v150, v151
    s_waitcnt vmcnt(24) lgkmcnt(8)
    v_mfma_f32_16x16x32_bf16 a[224:227], a[216:219], a[200:203], a[224:227]
    ds_read_b64_tr_b16 a[208:209], v208 offset:40960
    ds_read_b64_tr_b16 a[210:211], v208 offset:41984
    v_mfma_f32_16x16x32_bf16 a[232:235], a[216:219], a[204:207], a[232:235]
    ds_read_b64_tr_b16 a[212:213], v209 offset:40960
    ds_read_b64_tr_b16 a[214:215], v209 offset:41984
    v_mfma_f32_16x16x32_bf16 a[228:231], a[220:223], a[200:203], a[228:231]
    s_add_u32 s53, s53, 4096
    buffer_load_dwordx4 a[192:195], v242, s[8:11], s53 offen offset:0 sc1
    v_mfma_f32_16x16x32_bf16 a[236:239], a[220:223], a[204:207], a[236:239]
    s_add_u32 s65, s65, 4096
    buffer_load_dwordx4 a[196:199], v242, s[8:11], s65 offen offset:0 sc1
    v_mfma_f32_16x16x32_bf16 v[0:3], a[96:99], v[128:131], v[0:3]
    v_exp_f32 v152, v152
    v_mfma_f32_16x16x32_bf16 v[4:7], a[100:103], v[128:131], v[4:7]
    buffer_load_dwordx4 a[200:203], v242, s[8:11], s53 offen offset:1024 sc1
    v_mfma_f32_16x16x32_bf16 v[8:11], a[104:107], v[128:131], v[8:11]
    v_exp_f32 v153, v153
    v_mfma_f32_16x16x32_bf16 v[12:15], a[108:111], v[128:131], v[12:15]
    s_waitcnt lgkmcnt(4)
    ds_read_b128 a[64:67], v232 offset:40960
    v_cvt_pk_bf16_f32 v152, v152, v153
    v_mfma_f32_16x16x32_bf16 v[16:19], a[112:115], v[128:131], v[16:19]
    v_exp_f32 v154, v154
    v_mfma_f32_16x16x32_bf16 v[20:23], a[116:119], v[128:131], v[20:23]
    buffer_load_dwordx4 a[204:207], v242, s[8:11], s65 offen offset:1024 sc1
    v_mfma_f32_16x16x32_bf16 v[24:27], a[120:123], v[128:131], v[24:27]
    v_exp_f32 v155, v155
    v_mfma_f32_16x16x32_bf16 v[28:31], a[124:127], v[128:131], v[28:31]
    ds_read_b128 a[68:71], v233 offset:40960
    v_cvt_pk_bf16_f32 v153, v154, v155
    v_mfma_f32_16x16x32_bf16 a[240:243], v[220:223], v[128:131], a[240:243]
    v_exp_f32 v156, v156
    v_mfma_f32_16x16x32_bf16 v[32:35], a[96:99], v[136:139], v[32:35]
    v_mfma_f32_16x16x32_bf16 v[36:39], a[100:103], v[136:139], v[36:39]
    v_exp_f32 v157, v157
    v_mfma_f32_16x16x32_bf16 v[40:43], a[104:107], v[136:139], v[40:43]
    ds_read_b128 a[72:75], v234 offset:40960
    v_cvt_pk_bf16_f32 v154, v156, v157
    v_mfma_f32_16x16x32_bf16 v[44:47], a[108:111], v[136:139], v[44:47]
    v_exp_f32 v158, v158
    v_mfma_f32_16x16x32_bf16 v[48:51], a[112:115], v[136:139], v[48:51]
    v_mfma_f32_16x16x32_bf16 v[52:55], a[116:119], v[136:139], v[52:55]
    v_exp_f32 v159, v159
    v_mfma_f32_16x16x32_bf16 v[56:59], a[120:123], v[136:139], v[56:59]
    ds_read_b128 a[76:79], v235 offset:40960
    v_cvt_pk_bf16_f32 v155, v158, v159
    v_mfma_f32_16x16x32_bf16 v[60:63], a[124:127], v[136:139], v[60:63]
    v_mfma_f32_16x16x32_bf16 a[244:247], v[220:223], v[136:139], a[244:247]
    s_waitcnt vmcnt(26) lgkmcnt(4)
    v_mfma_f32_16x16x32_bf16 a[224:227], a[208:211], a[128:131], a[224:227]
    ds_read_b64_tr_b16 a[216:217], v208 offset:43008
    ds_read_b64_tr_b16 a[218:219], v208 offset:44032
    v_mfma_f32_16x16x32_bf16 a[232:235], a[208:211], a[132:135], a[232:235]
    ds_read_b64_tr_b16 a[220:221], v209 offset:43008
    ds_read_b64_tr_b16 a[222:223], v209 offset:44032
    v_mfma_f32_16x16x32_bf16 a[228:231], a[212:215], a[128:131], a[228:231]
    v_mfma_f32_16x16x32_bf16 a[236:239], a[212:215], a[132:135], a[236:239]
    v_mfma_f32_16x16x32_bf16 v[64:67], a[96:99], v[144:147], v[64:67]
    v_exp_f32 v160, v160
    v_mfma_f32_16x16x32_bf16 v[68:71], a[100:103], v[144:147], v[68:71]
    buffer_load_dword v215, v214, s[28:31], s82 offen
    v_mfma_f32_16x16x32_bf16 v[72:75], a[104:107], v[144:147], v[72:75]
    v_exp_f32 v161, v161
    v_mfma_f32_16x16x32_bf16 v[76:79], a[108:111], v[144:147], v[76:79]
    ds_read_b128 a[80:83], v232 offset:45056
    v_cvt_pk_bf16_f32 v160, v160, v161
    v_mfma_f32_16x16x32_bf16 v[80:83], a[112:115], v[144:147], v[80:83]
    v_exp_f32 v162, v162
    v_mfma_f32_16x16x32_bf16 v[84:87], a[116:119], v[144:147], v[84:87]
    buffer_load_dwordx4 a[128:131], v242, s[8:11], s53 offen offset:2048 sc1
    v_mfma_f32_16x16x32_bf16 v[88:91], a[120:123], v[144:147], v[88:91]
    v_exp_f32 v163, v163
    v_mfma_f32_16x16x32_bf16 v[92:95], a[124:127], v[144:147], v[92:95]
    ds_read_b128 a[84:87], v233 offset:45056
    v_cvt_pk_bf16_f32 v161, v162, v163
    v_mfma_f32_16x16x32_bf16 a[248:251], v[220:223], v[144:147], a[248:251]
    v_exp_f32 v164, v164
    v_mfma_f32_16x16x32_bf16 v[96:99], a[96:99], v[152:155], v[96:99]
    buffer_load_dwordx4 a[132:135], v242, s[8:11], s65 offen offset:2048 sc1
    v_mfma_f32_16x16x32_bf16 v[100:103], a[100:103], v[152:155], v[100:103]
    v_exp_f32 v165, v165
    v_mfma_f32_16x16x32_bf16 v[104:107], a[104:107], v[152:155], v[104:107]
    ds_read_b128 a[88:91], v234 offset:45056
    v_cvt_pk_bf16_f32 v162, v164, v165
    v_mfma_f32_16x16x32_bf16 v[108:111], a[108:111], v[152:155], v[108:111]
    v_exp_f32 v166, v166
    v_mfma_f32_16x16x32_bf16 v[112:115], a[112:115], v[152:155], v[112:115]
    v_mfma_f32_16x16x32_bf16 v[116:119], a[116:119], v[152:155], v[116:119]
    v_exp_f32 v167, v167
    v_mfma_f32_16x16x32_bf16 v[120:123], a[120:123], v[152:155], v[120:123]
    ds_read_b128 a[92:95], v235 offset:45056
    v_cvt_pk_bf16_f32 v163, v166, v167
    v_mfma_f32_16x16x32_bf16 v[124:127], a[124:127], v[152:155], v[124:127]
    v_mfma_f32_16x16x32_bf16 a[252:255], v[220:223], v[152:155], a[252:255]
    s_waitcnt vmcnt(27) lgkmcnt(4)
    v_mfma_f32_16x16x32_bf16 a[224:227], a[216:219], a[136:139], a[224:227]
    ds_read_b64_tr_b16 a[208:209], v208 offset:45056
    ds_read_b64_tr_b16 a[210:211], v208 offset:46080
    v_mfma_f32_16x16x32_bf16 a[232:235], a[216:219], a[140:143], a[232:235]
    ds_read_b64_tr_b16 a[212:213], v209 offset:45056
    ds_read_b64_tr_b16 a[214:215], v209 offset:46080
    v_mfma_f32_16x16x32_bf16 a[228:231], a[220:223], a[136:139], a[228:231]
    v_mfma_f32_16x16x32_bf16 a[236:239], a[220:223], a[140:143], a[236:239]
    s_waitcnt vmcnt(25) lgkmcnt(0)
    v_mfma_f32_16x16x32_bf16 v[128:131], a[64:67], a[0:3], v[192:195]
    v_exp_f32 v168, v168
    v_mfma_f32_16x16x32_bf16 v[128:131], a[68:71], a[4:7], v[128:131]
    ds_read_b64_tr_b16 a[96:97], v224 offset:32768
    ds_read_b64_tr_b16 a[98:99], v224 offset:36864
    v_mfma_f32_16x16x32_bf16 v[128:131], a[72:75], a[8:11], v[128:131]
    v_exp_f32 v169, v169
    v_mfma_f32_16x16x32_bf16 v[128:131], a[76:79], a[12:15], v[128:131]
    s_waitcnt vmcnt(21)
    s_barrier
    ds_read_b64_tr_b16 a[100:101], v225 offset:32768
    ds_read_b64_tr_b16 a[102:103], v225 offset:36864
    v_cvt_pk_bf16_f32 v168, v168, v169
    v_mfma_f32_16x16x32_bf16 v[132:135], a[80:83], a[0:3], v[192:195]
    v_exp_f32 v170, v170
    v_mfma_f32_16x16x32_bf16 v[132:135], a[84:87], a[4:7], v[132:135]
    ds_read_b64_tr_b16 a[104:105], v226 offset:32768
    ds_read_b64_tr_b16 a[106:107], v226 offset:36864
    v_mfma_f32_16x16x32_bf16 v[132:135], a[88:91], a[8:11], v[132:135]
    v_exp_f32 v171, v171
    v_mfma_f32_16x16x32_bf16 v[132:135], a[92:95], a[12:15], v[132:135]
    ds_read_b64_tr_b16 a[108:109], v227 offset:32768
    ds_read_b64_tr_b16 a[110:111], v227 offset:36864
    v_cvt_pk_bf16_f32 v169, v170, v171
    v_mfma_f32_16x16x32_bf16 v[136:139], a[64:67], a[16:19], v[196:199]
    v_exp_f32 v172, v172
    v_mfma_f32_16x16x32_bf16 v[136:139], a[68:71], a[20:23], v[136:139]
    ds_read_b64_tr_b16 a[112:113], v228 offset:32768
    ds_read_b64_tr_b16 a[114:115], v228 offset:36864
    v_mfma_f32_16x16x32_bf16 v[136:139], a[72:75], a[24:27], v[136:139]
    v_exp_f32 v173, v173
    v_mfma_f32_16x16x32_bf16 v[136:139], a[76:79], a[28:31], v[136:139]
    ds_read_b64_tr_b16 a[116:117], v229 offset:32768
    ds_read_b64_tr_b16 a[118:119], v229 offset:36864
    v_cvt_pk_bf16_f32 v170, v172, v173
    v_mfma_f32_16x16x32_bf16 v[140:143], a[80:83], a[16:19], v[196:199]
    v_exp_f32 v174, v174
    v_mfma_f32_16x16x32_bf16 v[140:143], a[84:87], a[20:23], v[140:143]
    ds_read_b64_tr_b16 a[120:121], v230 offset:32768
    ds_read_b64_tr_b16 a[122:123], v230 offset:36864
    v_mfma_f32_16x16x32_bf16 v[140:143], a[88:91], a[24:27], v[140:143]
    v_exp_f32 v175, v175
    v_mfma_f32_16x16x32_bf16 v[140:143], a[92:95], a[28:31], v[140:143]
    s_waitcnt lgkmcnt(6)
    ds_read_b64_tr_b16 a[124:125], v231 offset:32768
    ds_read_b64_tr_b16 a[126:127], v231 offset:36864
    v_cvt_pk_bf16_f32 v171, v174, v175
    v_mfma_f32_16x16x32_bf16 v[0:3], a[96:99], v[160:163], v[0:3]
    ds_read_b128 a[64:67], v232 offset:49152
    ds_read_b128 a[68:71], v233 offset:49152
    v_mfma_f32_16x16x32_bf16 v[4:7], a[100:103], v[160:163], v[4:7]
    ds_read_b128 a[72:75], v234 offset:49152
    ds_read_b128 a[76:79], v235 offset:49152
    v_mfma_f32_16x16x32_bf16 v[8:11], a[104:107], v[160:163], v[8:11]
    v_exp_f32 v128, v128
    v_mfma_f32_16x16x32_bf16 v[12:15], a[108:111], v[160:163], v[12:15]
    s_waitcnt lgkmcnt(4)
    v_exp_f32 v129, v129
    v_mfma_f32_16x16x32_bf16 v[16:19], a[112:115], v[160:163], v[16:19]
    v_exp_f32 v130, v130
    v_mfma_f32_16x16x32_bf16 v[20:23], a[116:119], v[160:163], v[20:23]
    v_cvt_pk_bf16_f32 v128, v128, v129
    v_mfma_f32_16x16x32_bf16 v[24:27], a[120:123], v[160:163], v[24:27]
    v_exp_f32 v131, v131
    v_mfma_f32_16x16x32_bf16 v[28:31], a[124:127], v[160:163], v[28:31]
    v_exp_f32 v132, v132
    v_mfma_f32_16x16x32_bf16 a[240:243], v[220:223], v[160:163], a[240:243]
    ds_read_b128 a[80:83], v232 offset:53248
    ds_read_b128 a[84:87], v233 offset:53248
    v_mfma_f32_16x16x32_bf16 v[32:35], a[96:99], v[168:171], v[32:35]
    ds_read_b128 a[88:91], v234 offset:53248
    ds_read_b128 a[92:95], v235 offset:53248
    v_mfma_f32_16x16x32_bf16 v[36:39], a[100:103], v[168:171], v[36:39]
    v_cvt_pk_bf16_f32 v129, v130, v131
    v_mfma_f32_16x16x32_bf16 v[40:43], a[104:107], v[168:171], v[40:43]
    v_exp_f32 v133, v133
    v_mfma_f32_16x16x32_bf16 v[44:47], a[108:111], v[168:171], v[44:47]
    v_exp_f32 v134, v134
    v_mfma_f32_16x16x32_bf16 v[48:51], a[112:115], v[168:171], v[48:51]
    v_cvt_pk_bf16_f32 v130, v132, v133
    v_mfma_f32_16x16x32_bf16 v[52:55], a[116:119], v[168:171], v[52:55]
    v_exp_f32 v135, v135
    v_mfma_f32_16x16x32_bf16 v[56:59], a[120:123], v[168:171], v[56:59]
    v_cvt_pk_bf16_f32 v131, v134, v135
    v_mfma_f32_16x16x32_bf16 v[60:63], a[124:127], v[168:171], v[60:63]
    buffer_load_dwordx4 a[136:139], v242, s[8:11], s53 offen offset:3072 sc1
    v_mfma_f32_16x16x32_bf16 a[244:247], v[220:223], v[168:171], a[244:247]
    s_waitcnt lgkmcnt(0)
    buffer_load_dwordx4 a[140:143], v242, s[8:11], s65 offen offset:3072 sc1
    v_mfma_f32_16x16x32_bf16 v[160:163], a[64:67], a[0:3], v[192:195]
    v_exp_f32 v136, v136
    v_mfma_f32_16x16x32_bf16 v[160:163], a[68:71], a[4:7], v[160:163]
    ds_read_b64_tr_b16 a[96:97], v224 offset:40960
    ds_read_b64_tr_b16 a[98:99], v224 offset:45056
    v_mfma_f32_16x16x32_bf16 v[160:163], a[72:75], a[8:11], v[160:163]
    v_exp_f32 v137, v137
    v_mfma_f32_16x16x32_bf16 v[160:163], a[76:79], a[12:15], v[160:163]
    ds_read_b64_tr_b16 a[100:101], v225 offset:40960
    ds_read_b64_tr_b16 a[102:103], v225 offset:45056
    v_cvt_pk_bf16_f32 v136, v136, v137
    v_mfma_f32_16x16x32_bf16 v[164:167], a[80:83], a[0:3], v[192:195]
    v_exp_f32 v138, v138
    v_mfma_f32_16x16x32_bf16 v[164:167], a[84:87], a[4:7], v[164:167]
    ds_read_b64_tr_b16 a[104:105], v226 offset:40960
    ds_read_b64_tr_b16 a[106:107], v226 offset:45056
    v_mfma_f32_16x16x32_bf16 v[164:167], a[88:91], a[8:11], v[164:167]
    v_exp_f32 v139, v139
    v_mfma_f32_16x16x32_bf16 v[164:167], a[92:95], a[12:15], v[164:167]
    ds_read_b64_tr_b16 a[108:109], v227 offset:40960
    ds_read_b64_tr_b16 a[110:111], v227 offset:45056
    v_cvt_pk_bf16_f32 v137, v138, v139
    v_mfma_f32_16x16x32_bf16 v[168:171], a[64:67], a[16:19], v[196:199]
    v_exp_f32 v140, v140
    v_mfma_f32_16x16x32_bf16 v[168:171], a[68:71], a[20:23], v[168:171]
    ds_read_b64_tr_b16 a[112:113], v228 offset:40960
    ds_read_b64_tr_b16 a[114:115], v228 offset:45056
    v_mfma_f32_16x16x32_bf16 v[168:171], a[72:75], a[24:27], v[168:171]
    v_exp_f32 v141, v141
    v_mfma_f32_16x16x32_bf16 v[168:171], a[76:79], a[28:31], v[168:171]
    ds_read_b64_tr_b16 a[116:117], v229 offset:40960
    ds_read_b64_tr_b16 a[118:119], v229 offset:45056
    v_cvt_pk_bf16_f32 v138, v140, v141
    v_mfma_f32_16x16x32_bf16 v[172:175], a[80:83], a[16:19], v[196:199]
    v_exp_f32 v142, v142
    v_mfma_f32_16x16x32_bf16 v[172:175], a[84:87], a[20:23], v[172:175]
    ds_read_b64_tr_b16 a[120:121], v230 offset:40960
    ds_read_b64_tr_b16 a[122:123], v230 offset:45056
    v_mfma_f32_16x16x32_bf16 v[172:175], a[88:91], a[24:27], v[172:175]
    v_exp_f32 v143, v143
    v_mfma_f32_16x16x32_bf16 v[172:175], a[92:95], a[28:31], v[172:175]
    s_waitcnt lgkmcnt(6)
    ds_read_b64_tr_b16 a[124:125], v231 offset:40960
    ds_read_b64_tr_b16 a[126:127], v231 offset:45056
    v_cvt_pk_bf16_f32 v139, v142, v143
    v_mfma_f32_16x16x32_bf16 v[0:3], a[96:99], v[128:131], v[0:3]
    ds_read_b128 a[64:67], v232 offset:57344
    ds_read_b128 a[68:71], v233 offset:57344
    v_mfma_f32_16x16x32_bf16 v[4:7], a[100:103], v[128:131], v[4:7]
    ds_read_b128 a[72:75], v234 offset:57344
    ds_read_b128 a[76:79], v235 offset:57344
    v_mfma_f32_16x16x32_bf16 v[8:11], a[104:107], v[128:131], v[8:11]
    v_exp_f32 v160, v160
    v_mfma_f32_16x16x32_bf16 v[12:15], a[108:111], v[128:131], v[12:15]
    s_waitcnt lgkmcnt(4)
    v_exp_f32 v161, v161
    v_mfma_f32_16x16x32_bf16 v[16:19], a[112:115], v[128:131], v[16:19]
    v_exp_f32 v162, v162
    v_mfma_f32_16x16x32_bf16 v[20:23], a[116:119], v[128:131], v[20:23]
    v_cvt_pk_bf16_f32 v160, v160, v161
    v_mfma_f32_16x16x32_bf16 v[24:27], a[120:123], v[128:131], v[24:27]
    v_exp_f32 v163, v163
    v_mfma_f32_16x16x32_bf16 v[28:31], a[124:127], v[128:131], v[28:31]
    v_exp_f32 v164, v164
    v_mfma_f32_16x16x32_bf16 a[240:243], v[220:223], v[128:131], a[240:243]
    ds_read_b128 a[80:83], v232 offset:61440
    ds_read_b128 a[84:87], v233 offset:61440
    v_mfma_f32_16x16x32_bf16 v[32:35], a[96:99], v[136:139], v[32:35]
    ds_read_b128 a[88:91], v234 offset:61440
    ds_read_b128 a[92:95], v235 offset:61440
    v_mfma_f32_16x16x32_bf16 v[36:39], a[100:103], v[136:139], v[36:39]
    v_cvt_pk_bf16_f32 v161, v162, v163
    v_mfma_f32_16x16x32_bf16 v[40:43], a[104:107], v[136:139], v[40:43]
    v_exp_f32 v165, v165
    v_mfma_f32_16x16x32_bf16 v[44:47], a[108:111], v[136:139], v[44:47]
    v_exp_f32 v166, v166
    v_mfma_f32_16x16x32_bf16 v[48:51], a[112:115], v[136:139], v[48:51]
    v_cvt_pk_bf16_f32 v162, v164, v165
    v_mfma_f32_16x16x32_bf16 v[52:55], a[116:119], v[136:139], v[52:55]
    v_exp_f32 v167, v167
    v_mfma_f32_16x16x32_bf16 v[56:59], a[120:123], v[136:139], v[56:59]
    v_cvt_pk_bf16_f32 v163, v166, v167
    v_mfma_f32_16x16x32_bf16 v[60:63], a[124:127], v[136:139], v[60:63]
    s_add_u32 m0, s81, 16384
    s_mov_b32 s55, 1310720
    buffer_load_dwordx4 v254, s[32:35], s55 offen lds
    v_mfma_f32_16x16x32_bf16 a[244:247], v[220:223], v[136:139], a[244:247]
    s_waitcnt lgkmcnt(0)
    s_add_u32 m0, s81, 20480
    s_mov_b32 s55, 1376256
    buffer_load_dwordx4 v254, s[32:35], s55 offen lds
    v_mfma_f32_16x16x32_bf16 v[128:131], a[64:67], a[0:3], v[192:195]
    v_exp_f32 v168, v168
    v_mfma_f32_16x16x32_bf16 v[128:131], a[68:71], a[4:7], v[128:131]
    ds_read_b64_tr_b16 a[96:97], v224 offset:49152
    ds_read_b64_tr_b16 a[98:99], v224 offset:53248
    v_mfma_f32_16x16x32_bf16 v[128:131], a[72:75], a[8:11], v[128:131]
    v_exp_f32 v169, v169
    v_mfma_f32_16x16x32_bf16 v[128:131], a[76:79], a[12:15], v[128:131]
    ds_read_b64_tr_b16 a[100:101], v225 offset:49152
    ds_read_b64_tr_b16 a[102:103], v225 offset:53248
    v_cvt_pk_bf16_f32 v168, v168, v169
    v_mfma_f32_16x16x32_bf16 v[132:135], a[80:83], a[0:3], v[192:195]
    v_exp_f32 v170, v170
    v_mfma_f32_16x16x32_bf16 v[132:135], a[84:87], a[4:7], v[132:135]
    ds_read_b64_tr_b16 a[104:105], v226 offset:49152
    ds_read_b64_tr_b16 a[106:107], v226 offset:53248
    v_mfma_f32_16x16x32_bf16 v[132:135], a[88:91], a[8:11], v[132:135]
    v_exp_f32 v171, v171
    v_mfma_f32_16x16x32_bf16 v[132:135], a[92:95], a[12:15], v[132:135]
    ds_read_b64_tr_b16 a[108:109], v227 offset:49152
    ds_read_b64_tr_b16 a[110:111], v227 offset:53248
    v_cvt_pk_bf16_f32 v169, v170, v171
    v_mfma_f32_16x16x32_bf16 v[136:139], a[64:67], a[16:19], v[196:199]
    v_exp_f32 v172, v172
    v_mfma_f32_16x16x32_bf16 v[136:139], a[68:71], a[20:23], v[136:139]
    ds_read_b64_tr_b16 a[112:113], v228 offset:49152
    ds_read_b64_tr_b16 a[114:115], v228 offset:53248
    v_mfma_f32_16x16x32_bf16 v[136:139], a[72:75], a[24:27], v[136:139]
    v_exp_f32 v173, v173
    v_mfma_f32_16x16x32_bf16 v[136:139], a[76:79], a[28:31], v[136:139]
    ds_read_b64_tr_b16 a[116:117], v229 offset:49152
    ds_read_b64_tr_b16 a[118:119], v229 offset:53248
    v_cvt_pk_bf16_f32 v170, v172, v173
    v_mfma_f32_16x16x32_bf16 v[140:143], a[80:83], a[16:19], v[196:199]
    v_exp_f32 v174, v174
    v_mfma_f32_16x16x32_bf16 v[140:143], a[84:87], a[20:23], v[140:143]
    ds_read_b64_tr_b16 a[120:121], v230 offset:49152
    ds_read_b64_tr_b16 a[122:123], v230 offset:53248
    v_mfma_f32_16x16x32_bf16 v[140:143], a[88:91], a[24:27], v[140:143]
    v_exp_f32 v175, v175
    v_mfma_f32_16x16x32_bf16 v[140:143], a[92:95], a[28:31], v[140:143]
    s_waitcnt lgkmcnt(6)
    ds_read_b64_tr_b16 a[124:125], v231 offset:49152
    ds_read_b64_tr_b16 a[126:127], v231 offset:53248
    v_cvt_pk_bf16_f32 v171, v174, v175
    v_mfma_f32_16x16x32_bf16 v[0:3], a[96:99], v[160:163], v[0:3]
    v_exp_f32 v128, v128
    v_mfma_f32_16x16x32_bf16 v[4:7], a[100:103], v[160:163], v[4:7]
    v_exp_f32 v129, v129
    v_mfma_f32_16x16x32_bf16 v[8:11], a[104:107], v[160:163], v[8:11]
    v_exp_f32 v130, v130
    v_mfma_f32_16x16x32_bf16 v[12:15], a[108:111], v[160:163], v[12:15]
    s_waitcnt lgkmcnt(0)
    v_cvt_pk_bf16_f32 v128, v128, v129
    v_mfma_f32_16x16x32_bf16 v[16:19], a[112:115], v[160:163], v[16:19]
    v_exp_f32 v131, v131
    v_mfma_f32_16x16x32_bf16 v[20:23], a[116:119], v[160:163], v[20:23]
    v_exp_f32 v132, v132
    v_mfma_f32_16x16x32_bf16 v[24:27], a[120:123], v[160:163], v[24:27]
    v_cvt_pk_bf16_f32 v129, v130, v131
    v_mfma_f32_16x16x32_bf16 v[28:31], a[124:127], v[160:163], v[28:31]
    v_exp_f32 v133, v133
    v_mfma_f32_16x16x32_bf16 a[240:243], v[220:223], v[160:163], a[240:243]
    v_exp_f32 v134, v134
    v_mfma_f32_16x16x32_bf16 v[32:35], a[96:99], v[168:171], v[32:35]
    v_cvt_pk_bf16_f32 v130, v132, v133
    v_mfma_f32_16x16x32_bf16 v[36:39], a[100:103], v[168:171], v[36:39]
    v_exp_f32 v135, v135
    v_mfma_f32_16x16x32_bf16 v[40:43], a[104:107], v[168:171], v[40:43]
    v_cvt_pk_bf16_f32 v131, v134, v135
    v_mfma_f32_16x16x32_bf16 v[44:47], a[108:111], v[168:171], v[44:47]
    s_add_u32 m0, s57, 65536
    s_add_u32 s54, s4, 0
    s_and_b32 s54, s54, 7
    s_lshl_b32 s54, s54, 17
    buffer_load_dwordx4 v250, s[28:31], s54 offen offset:0 lds
    v_mfma_f32_16x16x32_bf16 v[48:51], a[112:115], v[168:171], v[48:51]
    buffer_load_dwordx4 v251, s[28:31], s54 offen offset:1024 lds
    v_mfma_f32_16x16x32_bf16 v[52:55], a[116:119], v[168:171], v[52:55]
    buffer_load_dwordx4 v252, s[28:31], s54 offen offset:2048 lds
    v_mfma_f32_16x16x32_bf16 v[56:59], a[120:123], v[168:171], v[56:59]
    buffer_load_dwordx4 v253, s[28:31], s54 offen offset:3072 lds
    v_mfma_f32_16x16x32_bf16 v[60:63], a[124:127], v[168:171], v[60:63]
    s_add_u32 m0, s57, 81920
    s_add_u32 s54, s4, 0
    s_and_b32 s54, s54, 7
    s_lshl_b32 s54, s54, 17
    s_add_u32 s54, s54, 65536
    buffer_load_dwordx4 v250, s[28:31], s54 offen offset:0 lds
    v_mfma_f32_16x16x32_bf16 a[244:247], v[220:223], v[168:171], a[244:247]
    buffer_load_dwordx4 v251, s[28:31], s54 offen offset:1024 lds
    s_waitcnt vmcnt(6)
    s_barrier
    v_mfma_f32_16x16x32_bf16 a[224:227], a[208:211], a[144:147], a[224:227]
    ds_read_b64_tr_b16 a[216:217], v208 offset:47104
    ds_read_b64_tr_b16 a[218:219], v208 offset:48128
    v_exp_f32 v136, v136
    v_mfma_f32_16x16x32_bf16 a[232:235], a[208:211], a[148:151], a[232:235]
    ds_read_b64_tr_b16 a[96:97], v224 offset:57344
    ds_read_b64_tr_b16 a[98:99], v224 offset:61440
    ds_read_b64_tr_b16 a[220:221], v209 offset:47104
    ds_read_b64_tr_b16 a[222:223], v209 offset:48128
    v_mfma_f32_16x16x32_bf16 a[228:231], a[212:215], a[144:147], a[228:231]
    buffer_load_dwordx4 v252, s[28:31], s54 offen offset:2048 lds
    v_exp_f32 v137, v137
    v_mfma_f32_16x16x32_bf16 a[236:239], a[212:215], a[148:151], a[236:239]
    s_waitcnt lgkmcnt(0)
    ds_read_b64_tr_b16 a[100:101], v225 offset:57344
    ds_read_b64_tr_b16 a[102:103], v225 offset:61440
    buffer_load_dwordx4 v253, s[28:31], s54 offen offset:3072 lds
    v_cvt_pk_bf16_f32 v136, v136, v137
    v_mfma_f32_16x16x32_bf16 a[224:227], a[216:219], a[152:155], a[224:227]
    ds_read_b64_tr_b16 a[208:209], v208 offset:49152
    ds_read_b64_tr_b16 a[210:211], v208 offset:50176
    v_exp_f32 v138, v138
    v_mfma_f32_16x16x32_bf16 a[232:235], a[216:219], a[156:159], a[232:235]
    ds_read_b64_tr_b16 a[104:105], v226 offset:57344
    ds_read_b64_tr_b16 a[106:107], v226 offset:61440
    ds_read_b64_tr_b16 a[212:213], v209 offset:49152
    ds_read_b64_tr_b16 a[214:215], v209 offset:50176
    v_mfma_f32_16x16x32_bf16 a[228:231], a[220:223], a[152:155], a[228:231]
    s_add_u32 s53, s53, 4096
    buffer_load_dwordx4 a[144:147], v242, s[8:11], s53 offen offset:0 sc1
    v_exp_f32 v139, v139
    v_mfma_f32_16x16x32_bf16 a[236:239], a[220:223], a[156:159], a[236:239]
    s_waitcnt lgkmcnt(0)
    s_add_u32 s65, s65, 4096
    ds_read_b64_tr_b16 a[108:109], v227 offset:57344
    ds_read_b64_tr_b16 a[110:111], v227 offset:61440
    buffer_load_dwordx4 a[148:151], v242, s[8:11], s65 offen offset:0 sc1
    v_cvt_pk_bf16_f32 v137, v138, v139
    v_mfma_f32_16x16x32_bf16 a[224:227], a[208:211], a[160:163], a[224:227]
    ds_read_b64_tr_b16 a[216:217], v208 offset:51200
    ds_read_b64_tr_b16 a[218:219], v208 offset:52224
    v_exp_f32 v140, v140
    v_mfma_f32_16x16x32_bf16 a[232:235], a[208:211], a[164:167], a[232:235]
    ds_read_b64_tr_b16 a[112:113], v228 offset:57344
    ds_read_b64_tr_b16 a[114:115], v228 offset:61440
    ds_read_b64_tr_b16 a[220:221], v209 offset:51200
    ds_read_b64_tr_b16 a[222:223], v209 offset:52224
    v_mfma_f32_16x16x32_bf16 a[228:231], a[212:215], a[160:163], a[228:231]
    buffer_load_dwordx4 a[152:155], v242, s[8:11], s53 offen offset:1024 sc1
    v_exp_f32 v141, v141
    v_mfma_f32_16x16x32_bf16 a[236:239], a[212:215], a[164:167], a[236:239]
    s_waitcnt lgkmcnt(0)
    ds_read_b64_tr_b16 a[116:117], v229 offset:57344
    ds_read_b64_tr_b16 a[118:119], v229 offset:61440
    buffer_load_dwordx4 a[156:159], v242, s[8:11], s65 offen offset:1024 sc1
    v_cvt_pk_bf16_f32 v138, v140, v141
    v_mfma_f32_16x16x32_bf16 a[224:227], a[216:219], a[168:171], a[224:227]
    ds_read_b64_tr_b16 a[208:209], v208 offset:53248
    ds_read_b64_tr_b16 a[210:211], v208 offset:54272
    v_exp_f32 v142, v142
    v_mfma_f32_16x16x32_bf16 a[232:235], a[216:219], a[172:175], a[232:235]
    ds_read_b64_tr_b16 a[120:121], v230 offset:57344
    ds_read_b64_tr_b16 a[122:123], v230 offset:61440
    ds_read_b64_tr_b16 a[212:213], v209 offset:53248
    ds_read_b64_tr_b16 a[214:215], v209 offset:54272
    v_mfma_f32_16x16x32_bf16 a[228:231], a[220:223], a[168:171], a[228:231]
    buffer_load_dwordx4 a[160:163], v242, s[8:11], s53 offen offset:2048 sc1
    v_exp_f32 v143, v143
    v_mfma_f32_16x16x32_bf16 a[236:239], a[220:223], a[172:175], a[236:239]
    s_waitcnt lgkmcnt(0)
    ds_read_b64_tr_b16 a[124:125], v231 offset:57344
    ds_read_b64_tr_b16 a[126:127], v231 offset:61440
    buffer_load_dwordx4 a[164:167], v242, s[8:11], s65 offen offset:2048 sc1
    v_cvt_pk_bf16_f32 v139, v142, v143
    v_mfma_f32_16x16x32_bf16 v[0:3], a[96:99], v[128:131], v[0:3]
    ds_read_b128 a[64:67], v232 offset:40960
    ds_read_b128 a[68:71], v233 offset:40960
    v_mfma_f32_16x16x32_bf16 v[4:7], a[100:103], v[128:131], v[4:7]
    ds_read_b128 a[72:75], v234 offset:40960
    ds_read_b128 a[76:79], v235 offset:40960
    v_mfma_f32_16x16x32_bf16 v[8:11], a[104:107], v[128:131], v[8:11]
    v_exp_f32 v176, v176
    v_mfma_f32_16x16x32_bf16 v[12:15], a[108:111], v[128:131], v[12:15]
    s_waitcnt lgkmcnt(4)
    v_exp_f32 v177, v177
    v_mfma_f32_16x16x32_bf16 v[16:19], a[112:115], v[128:131], v[16:19]
    v_exp_f32 v178, v178
    v_mfma_f32_16x16x32_bf16 v[20:23], a[116:119], v[128:131], v[20:23]
    v_cvt_pk_bf16_f32 v176, v176, v177
    v_mfma_f32_16x16x32_bf16 v[24:27], a[120:123], v[128:131], v[24:27]
    v_exp_f32 v179, v179
    v_mfma_f32_16x16x32_bf16 v[28:31], a[124:127], v[128:131], v[28:31]
    v_exp_f32 v180, v180
    v_mfma_f32_16x16x32_bf16 a[240:243], v[220:223], v[128:131], a[240:243]
    ds_read_b128 a[80:83], v232 offset:45056
    ds_read_b128 a[84:87], v233 offset:45056
    v_mfma_f32_16x16x32_bf16 v[32:35], a[96:99], v[136:139], v[32:35]
    ds_read_b128 a[88:91], v234 offset:45056
    ds_read_b128 a[92:95], v235 offset:45056
    v_mfma_f32_16x16x32_bf16 v[36:39], a[100:103], v[136:139], v[36:39]
    v_cvt_pk_bf16_f32 v177, v178, v179
    v_mfma_f32_16x16x32_bf16 v[40:43], a[104:107], v[136:139], v[40:43]
    v_exp_f32 v181, v181
    v_mfma_f32_16x16x32_bf16 v[44:47], a[108:111], v[136:139], v[44:47]
    v_exp_f32 v182, v182
    v_mfma_f32_16x16x32_bf16 v[48:51], a[112:115], v[136:139], v[48:51]
    v_cvt_pk_bf16_f32 v178, v180, v181
    v_mfma_f32_16x16x32_bf16 v[52:55], a[116:119], v[136:139], v[52:55]
    v_exp_f32 v183, v183
    v_mfma_f32_16x16x32_bf16 v[56:59], a[120:123], v[136:139], v[56:59]
    v_cvt_pk_bf16_f32 v179, v182, v183
    v_mfma_f32_16x16x32_bf16 v[60:63], a[124:127], v[136:139], v[60:63]
    buffer_load_dwordx4 a[168:171], v242, s[8:11], s53 offen offset:3072 sc1
    v_mfma_f32_16x16x32_bf16 a[244:247], v[220:223], v[136:139], a[244:247]
    s_waitcnt lgkmcnt(0)
    buffer_load_dwordx4 a[172:175], v242, s[8:11], s65 offen offset:3072 sc1
    v_mfma_f32_16x16x32_bf16 v[144:147], a[64:67], a[32:35], v[200:203]
    v_exp_f32 v184, v184
    v_mfma_f32_16x16x32_bf16 v[144:147], a[68:71], a[36:39], v[144:147]
    ds_read_b64_tr_b16 a[96:97], v224 offset:32768
    ds_read_b64_tr_b16 a[98:99], v224 offset:36864
    v_mfma_f32_16x16x32_bf16 v[144:147], a[72:75], a[40:43], v[144:147]
    v_exp_f32 v185, v185
    v_mfma_f32_16x16x32_bf16 v[144:147], a[76:79], a[44:47], v[144:147]
    ds_read_b64_tr_b16 a[100:101], v225 offset:32768
    ds_read_b64_tr_b16 a[102:103], v225 offset:36864
    v_cvt_pk_bf16_f32 v184, v184, v185
    v_mfma_f32_16x16x32_bf16 v[148:151], a[80:83], a[32:35], v[200:203]
    v_exp_f32 v186, v186
    v_mfma_f32_16x16x32_bf16 v[148:151], a[84:87], a[36:39], v[148:151]
    ds_read_b64_tr_b16 a[104:105], v226 offset:32768
    ds_read_b64_tr_b16 a[106:107], v226 offset:36864
    v_mfma_f32_16x16x32_bf16 v[148:151], a[88:91], a[40:43], v[148:151]
    v_exp_f32 v187, v187
    v_mfma_f32_16x16x32_bf16 v[148:151], a[92:95], a[44:47], v[148:151]
    ds_read_b64_tr_b16 a[108:109], v227 offset:32768
    ds_read_b64_tr_b16 a[110:111], v227 offset:36864
    v_cvt_pk_bf16_f32 v185, v186, v187
    v_mfma_f32_16x16x32_bf16 a[224:227], a[208:211], a[176:179], a[224:227]
    ds_read_b64_tr_b16 a[216:217], v208 offset:55296
    ds_read_b64_tr_b16 a[218:219], v208 offset:56320
    v_mov_b32 v219, 0x4c000000
    v_accvgpr_read_b32 v247, a240
    v_accvgpr_read_b32 v248, a244
    v_add_f32 v214, v247, v248
    v_cmp_nle_f32 vcc, v214, v219
    s_nop 0
    s_andn2_b64 vcc, vcc, s[60:61]
    s_cselect_b32 s82, 536870912, s69
    s_cselect_b32 s62, 1, 0
    v_mfma_f32_16x16x32_bf16 a[232:235], a[208:211], a[180:183], a[232:235]
    ds_read_b64_tr_b16 a[220:221], v209 offset:55296
    ds_read_b64_tr_b16 a[222:223], v209 offset:56320
    v_rcp_f32 v247, v247
    v_rcp_f32 v248, v248
    s_nop 0
    v_mul_f32 v0, v0, v247
    v_mfma_f32_16x16x32_bf16 a[228:231], a[212:215], a[176:179], a[228:231]
    v_mul_f32 v1, v1, v247
    v_mul_f32 v2, v2, v247
    v_mul_f32 v3, v3, v247
    v_mul_f32 v4, v4, v247
    v_mul_f32 v5, v5, v247
    v_mul_f32 v6, v6, v247
    v_mul_f32 v7, v7, v247
    v_cvt_pk_bf16_f32 v0, v0, v1
    v_mfma_f32_16x16x32_bf16 a[236:239], a[212:215], a[180:183], a[236:239]
    s_waitcnt lgkmcnt(0)
    v_cvt_pk_bf16_f32 v1, v2, v3
    v_cvt_pk_bf16_f32 v2, v4, v5
    v_cvt_pk_bf16_f32 v3, v6, v7
    v_mul_f32 v8, v8, v247
    v_mul_f32 v9, v9, v247
    v_mul_f32 v10, v10, v247
    v_mul_f32 v11, v11, v247
    v_mul_f32 v12, v12, v247
    v_mfma_f32_16x16x32_bf16 v[152:155], a[64:67], a[48:51], v[204:207]
    v_exp_f32 v188, v188
    v_mfma_f32_16x16x32_bf16 v[152:155], a[68:71], a[52:55], v[152:155]
    ds_read_b64_tr_b16 a[112:113], v228 offset:32768
    ds_read_b64_tr_b16 a[114:115], v228 offset:36864
    v_mfma_f32_16x16x32_bf16 v[152:155], a[72:75], a[56:59], v[152:155]
    v_exp_f32 v189, v189
    v_mfma_f32_16x16x32_bf16 v[152:155], a[76:79], a[60:63], v[152:155]
    ds_read_b64_tr_b16 a[116:117], v229 offset:32768
    ds_read_b64_tr_b16 a[118:119], v229 offset:36864
    v_cvt_pk_bf16_f32 v186, v188, v189
    v_mfma_f32_16x16x32_bf16 v[156:159], a[80:83], a[48:51], v[204:207]
    v_exp_f32 v190, v190
    v_mfma_f32_16x16x32_bf16 v[156:159], a[84:87], a[52:55], v[156:159]
    ds_read_b64_tr_b16 a[120:121], v230 offset:32768
    ds_read_b64_tr_b16 a[122:123], v230 offset:36864
    v_mfma_f32_16x16x32_bf16 v[156:159], a[88:91], a[56:59], v[156:159]
    v_exp_f32 v191, v191
    v_mfma_f32_16x16x32_bf16 v[156:159], a[92:95], a[60:63], v[156:159]
    ds_read_b64_tr_b16 a[124:125], v231 offset:32768
    ds_read_b64_tr_b16 a[126:127], v231 offset:36864
    v_cvt_pk_bf16_f32 v187, v190, v191
    v_mfma_f32_16x16x32_bf16 a[224:227], a[216:219], a[184:187], a[224:227]
    ds_read_b64_tr_b16 a[208:209], v208 offset:57344
    ds_read_b64_tr_b16 a[210:211], v208 offset:58368
    v_mul_f32 v13, v13, v247
    v_mul_f32 v14, v14, v247
    v_mul_f32 v15, v15, v247
    v_cvt_pk_bf16_f32 v8, v8, v9
    v_cvt_pk_bf16_f32 v9, v10, v11
    v_cvt_pk_bf16_f32 v10, v12, v13
    v_mfma_f32_16x16x32_bf16 a[232:235], a[216:219], a[188:191], a[232:235]
    ds_read_b64_tr_b16 a[212:213], v209 offset:57344
    ds_read_b64_tr_b16 a[214:215], v209 offset:58368
    v_cvt_pk_bf16_f32 v11, v14, v15
    v_mul_f32 v16, v16, v247
    v_mul_f32 v17, v17, v247
    v_mul_f32 v18, v18, v247
    v_mul_f32 v19, v19, v247
    v_mul_f32 v20, v20, v247
    v_mfma_f32_16x16x32_bf16 a[228:231], a[220:223], a[184:187], a[228:231]
    s_lshl_b32 s56, s6, 6
    s_add_u32 s56, s56, s4
    s_lshl_b32 s56, s56, 2
    s_and_b32 s63, s4, 3
    s_add_u32 s56, s56, s63
    s_lshl_b32 s56, s56, 10
    s_add_u32 s56, s56, 8388608
    s_xor_b32 s63, s56, 0
    buffer_store_dwordx4 v[0:3], v242, s[8:11], s63 offen sc1
    v_mfma_f32_16x16x32_bf16 a[236:239], a[220:223], a[188:191], a[236:239]
    s_waitcnt lgkmcnt(0)
    s_xor_b32 s63, s56, 1024
    buffer_store_dwordx4 v[8:11], v242, s[8:11], s63 offen sc1
    v_mul_f32 v21, v21, v247
    v_mul_f32 v22, v22, v247
    v_mul_f32 v23, v23, v247
    v_cvt_pk_bf16_f32 v16, v16, v17
    v_cvt_pk_bf16_f32 v17, v18, v19
    v_mfma_f32_16x16x32_bf16 v[64:67], a[96:99], v[176:179], v[64:67]
    ds_read_b128 a[64:67], v232 offset:49152
    ds_read_b128 a[68:71], v233 offset:49152
    v_mfma_f32_16x16x32_bf16 v[68:71], a[100:103], v[176:179], v[68:71]
    ds_read_b128 a[72:75], v234 offset:49152
    ds_read_b128 a[76:79], v235 offset:49152
    v_mfma_f32_16x16x32_bf16 v[72:75], a[104:107], v[176:179], v[72:75]
    v_exp_f32 v144, v144
    v_mfma_f32_16x16x32_bf16 v[76:79], a[108:111], v[176:179], v[76:79]
    v_exp_f32 v145, v145
    v_mfma_f32_16x16x32_bf16 v[80:83], a[112:115], v[176:179], v[80:83]
    v_exp_f32 v146, v146
    v_mfma_f32_16x16x32_bf16 v[84:87], a[116:119], v[176:179], v[84:87]
    v_cvt_pk_bf16_f32 v144, v144, v145
    v_cvt_pk_bf16_f32 v18, v20, v21
    v_mfma_f32_16x16x32_bf16 v[88:91], a[120:123], v[176:179], v[88:91]
    v_exp_f32 v147, v147
    v_mfma_f32_16x16x32_bf16 v[92:95], a[124:127], v[176:179], v[92:95]
    v_exp_f32 v148, v148
    v_mfma_f32_16x16x32_bf16 a[248:251], v[220:223], v[176:179], a[248:251]
    ds_read_b128 a[80:83], v232 offset:53248
    ds_read_b128 a[84:87], v233 offset:53248
    v_mfma_f32_16x16x32_bf16 a[224:227], a[208:211], a[192:195], a[224:227]
    ds_read_b64_tr_b16 a[216:217], v208 offset:59392
    ds_read_b64_tr_b16 a[218:219], v208 offset:60416
    v_cvt_pk_bf16_f32 v19, v22, v23
    v_mul_f32 v24, v24, v247
    v_mul_f32 v25, v25, v247
    v_mul_f32 v26, v26, v247
    v_mul_f32 v27, v27, v247
    v_mul_f32 v28, v28, v247
    v_mfma_f32_16x16x32_bf16 a[232:235], a[208:211], a[196:199], a[232:235]
    ds_read_b64_tr_b16 a[220:221], v209 offset:59392
    ds_read_b64_tr_b16 a[222:223], v209 offset:60416
    v_mul_f32 v29, v29, v247
    v_mul_f32 v30, v30, v247
    v_mul_f32 v31, v31, v247
    v_cvt_pk_bf16_f32 v24, v24, v25
    v_cvt_pk_bf16_f32 v25, v26, v27
    v_cvt_pk_bf16_f32 v26, v28, v29
    v_mfma_f32_16x16x32_bf16 a[228:231], a[212:215], a[192:195], a[228:231]
    s_xor_b32 s63, s56, 2048
    buffer_store_dwordx4 v[16:19], v242, s[8:11], s63 offen sc1
    v_cvt_pk_bf16_f32 v27, v30, v31
    v_mul_f32 v32, v32, v248
    v_mul_f32 v33, v33, v248
    v_mul_f32 v34, v34, v248
    v_mul_f32 v35, v35, v248
    v_mul_f32 v36, v36, v248
    v_mfma_f32_16x16x32_bf16 a[236:239], a[212:215], a[196:199], a[236:239]
    s_waitcnt lgkmcnt(0)
    s_xor_b32 s63, s56, 3072
    buffer_store_dwordx4 v[24:27], v242, s[8:11], s63 offen sc1
    v_mul_f32 v37, v37, v248
    v_mul_f32 v38, v38, v248
    v_mul_f32 v39, v39, v248
    v_cvt_pk_bf16_f32 v32, v32, v33
    v_cvt_pk_bf16_f32 v33, v34, v35
    v_mfma_f32_16x16x32_bf16 v[96:99], a[96:99], v[184:187], v[96:99]
    ds_read_b128 a[88:91], v234 offset:53248
    ds_read_b128 a[92:95], v235 offset:53248
    v_mfma_f32_16x16x32_bf16 v[100:103], a[100:103], v[184:187], v[100:103]
    v_cvt_pk_bf16_f32 v145, v146, v147
    v_cvt_pk_bf16_f32 v34, v36, v37
    v_mfma_f32_16x16x32_bf16 v[104:107], a[104:107], v[184:187], v[104:107]
    v_exp_f32 v149, v149
    v_mfma_f32_16x16x32_bf16 v[108:111], a[108:111], v[184:187], v[108:111]
    v_exp_f32 v150, v150
    v_mfma_f32_16x16x32_bf16 v[112:115], a[112:115], v[184:187], v[112:115]
    v_cvt_pk_bf16_f32 v146, v148, v149
    v_cvt_pk_bf16_f32 v35, v38, v39
    v_mfma_f32_16x16x32_bf16 v[116:119], a[116:119], v[184:187], v[116:119]
    v_exp_f32 v151, v151
    v_mfma_f32_16x16x32_bf16 v[120:123], a[120:123], v[184:187], v[120:123]
    v_cvt_pk_bf16_f32 v147, v150, v151
    v_mul_f32 v40, v40, v248
    v_mfma_f32_16x16x32_bf16 v[124:127], a[124:127], v[184:187], v[124:127]
    v_mul_f32 v41, v41, v248
    v_mul_f32 v42, v42, v248
    v_mfma_f32_16x16x32_bf16 a[252:255], v[220:223], v[184:187], a[252:255]
    s_waitcnt lgkmcnt(0)
    v_mul_f32 v43, v43, v248
    v_mul_f32 v44, v44, v248
    v_mfma_f32_16x16x32_bf16 a[224:227], a[216:219], a[200:203], a[224:227]
    ds_read_b64_tr_b16 a[208:209], v208 offset:61440
    ds_read_b64_tr_b16 a[210:211], v208 offset:62464
    v_mul_f32 v45, v45, v248
    v_mul_f32 v46, v46, v248
    v_mul_f32 v47, v47, v248
    v_cvt_pk_bf16_f32 v40, v40, v41
    v_cvt_pk_bf16_f32 v41, v42, v43
    v_cvt_pk_bf16_f32 v42, v44, v45
    v_mfma_f32_16x16x32_bf16 a[232:235], a[216:219], a[204:207], a[232:235]
    ds_read_b64_tr_b16 a[212:213], v209 offset:61440
    ds_read_b64_tr_b16 a[214:215], v209 offset:62464
    v_cvt_pk_bf16_f32 v43, v46, v47
    v_mul_f32 v48, v48, v248
    v_mul_f32 v49, v49, v248
    v_mul_f32 v50, v50, v248
    v_mul_f32 v51, v51, v248
    v_mul_f32 v52, v52, v248
    v_mfma_f32_16x16x32_bf16 a[228:231], a[220:223], a[200:203], a[228:231]
    s_add_u32 s56, s56, 131072
    s_xor_b32 s63, s56, 0
    buffer_store_dwordx4 v[32:35], v242, s[8:11], s63 offen sc1
    v_mul_f32 v53, v53, v248
    v_mul_f32 v54, v54, v248
    v_mul_f32 v55, v55, v248
    v_cvt_pk_bf16_f32 v48, v48, v49
    v_cvt_pk_bf16_f32 v49, v50, v51
    v_mfma_f32_16x16x32_bf16 a[236:239], a[220:223], a[204:207], a[236:239]
    s_waitcnt lgkmcnt(0)
    s_xor_b32 s63, s56, 1024
    buffer_store_dwordx4 v[40:43], v242, s[8:11], s63 offen sc1
    v_cvt_pk_bf16_f32 v50, v52, v53
    v_cvt_pk_bf16_f32 v51, v54, v55
    v_mul_f32 v56, v56, v248
    v_mul_f32 v57, v57, v248
    v_mul_f32 v58, v58, v248
    v_mfma_f32_16x16x32_bf16 v[176:179], a[64:67], a[32:35], v[200:203]
    v_exp_f32 v152, v152
    v_mfma_f32_16x16x32_bf16 v[176:179], a[68:71], a[36:39], v[176:179]
    ds_read_b64_tr_b16 a[96:97], v224 offset:40960
    ds_read_b64_tr_b16 a[98:99], v224 offset:45056
    v_mfma_f32_16x16x32_bf16 v[176:179], a[72:75], a[40:43], v[176:179]
    v_exp_f32 v153, v153
    v_mfma_f32_16x16x32_bf16 v[176:179], a[76:79], a[44:47], v[176:179]
    ds_read_b64_tr_b16 a[100:101], v225 offset:40960
    ds_read_b64_tr_b16 a[102:103], v225 offset:45056
    v_cvt_pk_bf16_f32 v152, v152, v153
    v_mfma_f32_16x16x32_bf16 v[180:183], a[80:83], a[32:35], v[200:203]
    v_exp_f32 v154, v154
    v_mfma_f32_16x16x32_bf16 v[180:183], a[84:87], a[36:39], v[180:183]
    ds_read_b64_tr_b16 a[104:105], v226 offset:40960
    ds_read_b64_tr_b16 a[106:107], v226 offset:45056
    v_mfma_f32_16x16x32_bf16 v[180:183], a[88:91], a[40:43], v[180:183]
    v_exp_f32 v155, v155
    v_mfma_f32_16x16x32_bf16 v[180:183], a[92:95], a[44:47], v[180:183]
    ds_read_b64_tr_b16 a[108:109], v227 offset:40960
    ds_read_b64_tr_b16 a[110:111], v227 offset:45056
    v_cvt_pk_bf16_f32 v153, v154, v155
    v_mfma_f32_16x16x32_bf16 v[184:187], a[64:67], a[48:51], v[204:207]
    v_exp_f32 v156, v156
    v_mfma_f32_16x16x32_bf16 v[184:187], a[68:71], a[52:55], v[184:187]
    ds_read_b64_tr_b16 a[112:113], v228 offset:40960
    ds_read_b64_tr_b16 a[114:115], v228 offset:45056
    v_mfma_f32_16x16x32_bf16 v[184:187], a[72:75], a[56:59], v[184:187]
    v_exp_f32 v157, v157
    v_mfma_f32_16x16x32_bf16 v[184:187], a[76:79], a[60:63], v[184:187]
    ds_read_b64_tr_b16 a[116:117], v229 offset:40960
    ds_read_b64_tr_b16 a[118:119], v229 offset:45056
    v_cvt_pk_bf16_f32 v154, v156, v157
    v_mfma_f32_16x16x32_bf16 v[188:191], a[80:83], a[48:51], v[204:207]
    v_exp_f32 v158, v158
    v_mfma_f32_16x16x32_bf16 v[188:191], a[84:87], a[52:55], v[188:191]
    ds_read_b64_tr_b16 a[120:121], v230 offset:40960
    ds_read_b64_tr_b16 a[122:123], v230 offset:45056
    v_mfma_f32_16x16x32_bf16 v[188:191], a[88:91], a[56:59], v[188:191]
    v_exp_f32 v159, v159
    v_mfma_f32_16x16x32_bf16 v[188:191], a[92:95], a[60:63], v[188:191]
    s_waitcnt lgkmcnt(6)
    ds_read_b64_tr_b16 a[124:125], v231 offset:40960
    ds_read_b64_tr_b16 a[126:127], v231 offset:45056
    v_cvt_pk_bf16_f32 v155, v158, v159
    v_mfma_f32_16x16x32_bf16 a[224:227], a[208:211], a[128:131], a[224:227]
    ds_read_b64_tr_b16 a[216:217], v208 offset:63488
    ds_read_b64_tr_b16 a[218:219], v208 offset:64512
    v_mul_f32 v59, v59, v248
    v_mul_f32 v60, v60, v248
    v_mul_f32 v61, v61, v248
    v_mul_f32 v62, v62, v248
    v_mul_f32 v63, v63, v248
    v_cvt_pk_bf16_f32 v56, v56, v57
    v_mfma_f32_16x16x32_bf16 a[232:235], a[208:211], a[132:135], a[232:235]
    ds_read_b64_tr_b16 a[220:221], v209 offset:63488
    ds_read_b64_tr_b16 a[222:223], v209 offset:64512
    v_cvt_pk_bf16_f32 v57, v58, v59
    v_cvt_pk_bf16_f32 v58, v60, v61
    v_cvt_pk_bf16_f32 v59, v62, v63
    v_min_u32 v249, 1, v242
    v_lshlrev_b32 v249, 31, v249
    v_mov_b32 v248, s64
    v_mfma_f32_16x16x32_bf16 a[228:231], a[212:215], a[128:131], a[228:231]
    s_xor_b32 s63, s56, 2048
    buffer_store_dwordx4 v[48:51], v242, s[8:11], s63 offen sc1
    v_mfma_f32_16x16x32_bf16 a[236:239], a[212:215], a[132:135], a[236:239]
    s_waitcnt lgkmcnt(0)
    s_xor_b32 s63, s56, 3072
    buffer_store_dwordx4 v[56:59], v242, s[8:11], s63 offen sc1
    v_mfma_f32_16x16x32_bf16 v[64:67], a[96:99], v[144:147], v[64:67]
    ds_read_b128 a[64:67], v232 offset:57344
    ds_read_b128 a[68:71], v233 offset:57344
    v_mfma_f32_16x16x32_bf16 v[68:71], a[100:103], v[144:147], v[68:71]
    ds_read_b128 a[72:75], v234 offset:57344
    ds_read_b128 a[76:79], v235 offset:57344
    v_mfma_f32_16x16x32_bf16 v[72:75], a[104:107], v[144:147], v[72:75]
    v_exp_f32 v176, v176
    v_mfma_f32_16x16x32_bf16 v[76:79], a[108:111], v[144:147], v[76:79]
    v_exp_f32 v177, v177
    v_mfma_f32_16x16x32_bf16 v[80:83], a[112:115], v[144:147], v[80:83]
    v_exp_f32 v178, v178
    v_mfma_f32_16x16x32_bf16 v[84:87], a[116:119], v[144:147], v[84:87]
    v_cvt_pk_bf16_f32 v176, v176, v177
    v_mfma_f32_16x16x32_bf16 v[88:91], a[120:123], v[144:147], v[88:91]
    v_exp_f32 v179, v179
    v_mfma_f32_16x16x32_bf16 v[92:95], a[124:127], v[144:147], v[92:95]
    v_exp_f32 v180, v180
    v_mfma_f32_16x16x32_bf16 a[248:251], v[220:223], v[144:147], a[248:251]
    ds_read_b128 a[80:83], v232 offset:61440
    ds_read_b128 a[84:87], v233 offset:61440
    v_mfma_f32_16x16x32_bf16 v[96:99], a[96:99], v[152:155], v[96:99]
    ds_read_b128 a[88:91], v234 offset:61440
    ds_read_b128 a[92:95], v235 offset:61440
    v_mfma_f32_16x16x32_bf16 v[100:103], a[100:103], v[152:155], v[100:103]
    v_cvt_pk_bf16_f32 v177, v178, v179
    v_mfma_f32_16x16x32_bf16 v[104:107], a[104:107], v[152:155], v[104:107]
    v_exp_f32 v181, v181
    v_mfma_f32_16x16x32_bf16 v[108:111], a[108:111], v[152:155], v[108:111]
    v_exp_f32 v182, v182
    v_mfma_f32_16x16x32_bf16 v[112:115], a[112:115], v[152:155], v[112:115]
    v_cvt_pk_bf16_f32 v178, v180, v181
    v_mfma_f32_16x16x32_bf16 v[116:119], a[116:119], v[152:155], v[116:119]
    v_exp_f32 v183, v183
    v_mfma_f32_16x16x32_bf16 v[120:123], a[120:123], v[152:155], v[120:123]
    v_cvt_pk_bf16_f32 v179, v182, v183
    v_mfma_f32_16x16x32_bf16 v[124:127], a[124:127], v[152:155], v[124:127]
    s_add_u32 s53, s53, 4096
    buffer_load_dwordx4 a[176:179], v242, s[8:11], s53 offen offset:0 sc1
    v_mfma_f32_16x16x32_bf16 a[252:255], v[220:223], v[152:155], a[252:255]
    s_waitcnt lgkmcnt(0)
    s_add_u32 s65, s65, 4096
    buffer_load_dwordx4 a[180:183], v242, s[8:11], s65 offen offset:0 sc1
    v_mfma_f32_16x16x32_bf16 a[224:227], a[216:219], a[136:139], a[224:227]
    ds_read_b64_tr_b16 a[208:209], v210 offset:0
    ds_read_b64_tr_b16 a[210:211], v210 offset:1024
    v_mfma_f32_16x16x32_bf16 a[232:235], a[216:219], a[140:143], a[232:235]
    ds_read_b64_tr_b16 a[212:213], v211 offset:0
    ds_read_b64_tr_b16 a[214:215], v211 offset:1024
    v_mfma_f32_16x16x32_bf16 a[228:231], a[220:223], a[136:139], a[228:231]
    buffer_load_dwordx4 a[184:187], v242, s[8:11], s53 offen offset:1024 sc1
    v_mfma_f32_16x16x32_bf16 a[236:239], a[220:223], a[140:143], a[236:239]
    s_waitcnt vmcnt(17) lgkmcnt(0)
    buffer_load_dwordx4 a[188:191], v242, s[8:11], s65 offen offset:1024 sc1
    buffer_load_dwordx4 a[192:195], v242, s[8:11], s53 offen offset:2048 sc1
    buffer_load_dwordx4 a[196:199], v242, s[8:11], s65 offen offset:2048 sc1
    buffer_load_dwordx4 a[200:203], v242, s[8:11], s53 offen offset:3072 sc1
    buffer_load_dwordx4 a[204:207], v242, s[8:11], s65 offen offset:3072 sc1
    s_barrier
    v_mfma_f32_16x16x32_bf16 v[144:147], a[64:67], a[32:35], v[200:203]
    v_exp_f32 v184, v184
    v_mfma_f32_16x16x32_bf16 v[144:147], a[68:71], a[36:39], v[144:147]
    ds_read_b64_tr_b16 a[96:97], v224 offset:49152
    ds_read_b64_tr_b16 a[98:99], v224 offset:53248
    v_mfma_f32_16x16x32_bf16 v[144:147], a[72:75], a[40:43], v[144:147]
    v_exp_f32 v185, v185
    v_mfma_f32_16x16x32_bf16 v[144:147], a[76:79], a[44:47], v[144:147]
    ds_read_b64_tr_b16 a[100:101], v225 offset:49152
    ds_read_b64_tr_b16 a[102:103], v225 offset:53248
    v_cvt_pk_bf16_f32 v184, v184, v185
    v_mfma_f32_16x16x32_bf16 v[148:151], a[80:83], a[32:35], v[200:203]
    v_exp_f32 v186, v186
    v_mfma_f32_16x16x32_bf16 v[148:151], a[84:87], a[36:39], v[148:151]
    ds_read_b64_tr_b16 a[104:105], v226 offset:49152
    ds_read_b64_tr_b16 a[106:107], v226 offset:53248
    v_mfma_f32_16x16x32_bf16 v[148:151], a[88:91], a[40:43], v[148:151]
    v_exp_f32 v187, v187
    v_mfma_f32_16x16x32_bf16 v[148:151], a[92:95], a[44:47], v[148:151]
    ds_read_b64_tr_b16 a[108:109], v227 offset:49152
    ds_read_b64_tr_b16 a[110:111], v227 offset:53248
    v_cvt_pk_bf16_f32 v185, v186, v187
    v_mfma_f32_16x16x32_bf16 v[152:155], a[64:67], a[48:51], v[204:207]
    v_exp_f32 v188, v188
    v_mfma_f32_16x16x32_bf16 v[152:155], a[68:71], a[52:55], v[152:155]
    ds_read_b64_tr_b16 a[112:113], v228 offset:49152
    ds_read_b64_tr_b16 a[114:115], v228 offset:53248
    v_mfma_f32_16x16x32_bf16 v[152:155], a[72:75], a[56:59], v[152:155]
    v_exp_f32 v189, v189
    v_mfma_f32_16x16x32_bf16 v[152:155], a[76:79], a[60:63], v[152:155]
    ds_read_b64_tr_b16 a[116:117], v229 offset:49152
    ds_read_b64_tr_b16 a[118:119], v229 offset:53248
    v_cvt_pk_bf16_f32 v186, v188, v189
    v_mfma_f32_16x16x32_bf16 v[156:159], a[80:83], a[48:51], v[204:207]
    v_exp_f32 v190, v190
    v_mfma_f32_16x16x32_bf16 v[156:159], a[84:87], a[52:55], v[156:159]
    ds_read_b64_tr_b16 a[120:121], v230 offset:49152
    ds_read_b64_tr_b16 a[122:123], v230 offset:53248
    v_mfma_f32_16x16x32_bf16 v[156:159], a[88:91], a[56:59], v[156:159]
    v_exp_f32 v191, v191
    v_mfma_f32_16x16x32_bf16 v[156:159], a[92:95], a[60:63], v[156:159]
    s_waitcnt lgkmcnt(6)
    ds_read_b64_tr_b16 a[124:125], v231 offset:49152
    ds_read_b64_tr_b16 a[126:127], v231 offset:53248
    v_cvt_pk_bf16_f32 v187, v190, v191
    v_mfma_f32_16x16x32_bf16 a[224:227], a[208:211], a[144:147], a[224:227]
    ds_read_b64_tr_b16 a[216:217], v210 offset:2048
    ds_read_b64_tr_b16 a[218:219], v210 offset:3072
    v_mfma_f32_16x16x32_bf16 a[232:235], a[208:211], a[148:151], a[232:235]
    ds_read_b64_tr_b16 a[220:221], v211 offset:2048
    ds_read_b64_tr_b16 a[222:223], v211 offset:3072
    v_mfma_f32_16x16x32_bf16 a[228:231], a[212:215], a[144:147], a[228:231]
    s_add_u32 s53, s53, 4096
    buffer_load_dwordx4 a[128:131], v242, s[8:11], s53 offen offset:0 sc1
    v_mfma_f32_16x16x32_bf16 a[236:239], a[212:215], a[148:151], a[236:239]
    s_waitcnt vmcnt(21) lgkmcnt(0)
    s_add_u32 s65, s65, 4096
    buffer_load_dwordx4 a[132:135], v242, s[8:11], s65 offen offset:0 sc1
    v_mfma_f32_16x16x32_bf16 v[64:67], a[96:99], v[176:179], v[64:67]
    v_exp_f32 v144, v144
    v_mfma_f32_16x16x32_bf16 v[68:71], a[100:103], v[176:179], v[68:71]
    ds_read_b64_tr_b16 a[64:65], v224 offset:57344
    ds_read_b64_tr_b16 a[66:67], v224 offset:61440
    v_mfma_f32_16x16x32_bf16 v[72:75], a[104:107], v[176:179], v[72:75]
    v_exp_f32 v145, v145
    v_mfma_f32_16x16x32_bf16 v[76:79], a[108:111], v[176:179], v[76:79]
    ds_read_b64_tr_b16 a[68:69], v225 offset:57344
    ds_read_b64_tr_b16 a[70:71], v225 offset:61440
    v_mfma_f32_16x16x32_bf16 v[80:83], a[112:115], v[176:179], v[80:83]
    v_exp_f32 v146, v146
    v_mfma_f32_16x16x32_bf16 v[84:87], a[116:119], v[176:179], v[84:87]
    ds_read_b64_tr_b16 a[72:73], v226 offset:57344
    ds_read_b64_tr_b16 a[74:75], v226 offset:61440
    v_mfma_f32_16x16x32_bf16 v[88:91], a[120:123], v[176:179], v[88:91]
    v_cvt_pk_bf16_f32 v144, v144, v145
    v_mfma_f32_16x16x32_bf16 v[92:95], a[124:127], v[176:179], v[92:95]
    ds_read_b64_tr_b16 a[76:77], v227 offset:57344
    ds_read_b64_tr_b16 a[78:79], v227 offset:61440
    v_mfma_f32_16x16x32_bf16 a[248:251], v[220:223], v[176:179], a[248:251]
    v_exp_f32 v147, v147
    v_mfma_f32_16x16x32_bf16 v[96:99], a[96:99], v[184:187], v[96:99]
    ds_read_b64_tr_b16 a[80:81], v228 offset:57344
    ds_read_b64_tr_b16 a[82:83], v228 offset:61440
    v_mfma_f32_16x16x32_bf16 v[100:103], a[100:103], v[184:187], v[100:103]
    v_exp_f32 v148, v148
    v_mfma_f32_16x16x32_bf16 v[104:107], a[104:107], v[184:187], v[104:107]
    ds_read_b64_tr_b16 a[84:85], v229 offset:57344
    ds_read_b64_tr_b16 a[86:87], v229 offset:61440
    v_mfma_f32_16x16x32_bf16 v[108:111], a[108:111], v[184:187], v[108:111]
    v_cvt_pk_bf16_f32 v145, v146, v147
    v_mfma_f32_16x16x32_bf16 v[112:115], a[112:115], v[184:187], v[112:115]
    ds_read_b64_tr_b16 a[88:89], v230 offset:57344
    ds_read_b64_tr_b16 a[90:91], v230 offset:61440
    v_mfma_f32_16x16x32_bf16 v[116:119], a[116:119], v[184:187], v[116:119]
    v_exp_f32 v149, v149
    v_mfma_f32_16x16x32_bf16 v[120:123], a[120:123], v[184:187], v[120:123]
    ds_read_b64_tr_b16 a[92:93], v231 offset:57344
    ds_read_b64_tr_b16 a[94:95], v231 offset:61440
    v_mfma_f32_16x16x32_bf16 v[124:127], a[124:127], v[184:187], v[124:127]
    v_exp_f32 v150, v150
    v_mfma_f32_16x16x32_bf16 a[252:255], v[220:223], v[184:187], a[252:255]
    v_cvt_pk_bf16_f32 v146, v148, v149
    v_exp_f32 v151, v151
    s_nop 0
    v_cvt_pk_bf16_f32 v147, v150, v151
    v_mfma_f32_16x16x32_bf16 a[224:227], a[216:219], a[152:155], a[224:227]
    ds_read_b64_tr_b16 a[208:209], v210 offset:4096
    ds_read_b64_tr_b16 a[210:211], v210 offset:5120
    v_mfma_f32_16x16x32_bf16 a[232:235], a[216:219], a[156:159], a[232:235]
    ds_read_b64_tr_b16 a[212:213], v211 offset:4096
    ds_read_b64_tr_b16 a[214:215], v211 offset:5120
    v_mfma_f32_16x16x32_bf16 a[228:231], a[220:223], a[152:155], a[228:231]
    buffer_load_dwordx4 a[136:139], v242, s[8:11], s53 offen offset:1024 sc1
    v_mfma_f32_16x16x32_bf16 a[236:239], a[220:223], a[156:159], a[236:239]
    s_waitcnt vmcnt(21) lgkmcnt(0)
    buffer_load_dwordx4 a[140:143], v242, s[8:11], s65 offen offset:1024 sc1
    buffer_load_dwordx4 a[144:147], v242, s[8:11], s53 offen offset:2048 sc1
    buffer_load_dwordx4 a[148:151], v242, s[8:11], s65 offen offset:2048 sc1
    s_waitcnt vmcnt(14)
    buffer_store_dword v248, v249, s[8:11], s82 offen sc1
    v_mfma_f32_16x16x32_bf16 v[64:67], a[64:67], v[144:147], v[64:67]
    v_exp_f32 v152, v152
    v_mfma_f32_16x16x32_bf16 v[68:71], a[68:71], v[144:147], v[68:71]
    v_exp_f32 v153, v153
    v_mfma_f32_16x16x32_bf16 v[72:75], a[72:75], v[144:147], v[72:75]
    v_exp_f32 v154, v154
    v_cvt_pk_bf16_f32 v152, v152, v153
    v_mfma_f32_16x16x32_bf16 v[76:79], a[76:79], v[144:147], v[76:79]
    v_exp_f32 v155, v155
    v_mfma_f32_16x16x32_bf16 v[80:83], a[80:83], v[144:147], v[80:83]
    v_exp_f32 v156, v156
    v_cvt_pk_bf16_f32 v153, v154, v155
    v_mfma_f32_16x16x32_bf16 v[84:87], a[84:87], v[144:147], v[84:87]
    v_exp_f32 v157, v157
    v_mfma_f32_16x16x32_bf16 v[88:91], a[88:91], v[144:147], v[88:91]
    v_exp_f32 v158, v158
    v_cvt_pk_bf16_f32 v154, v156, v157
    v_mfma_f32_16x16x32_bf16 v[92:95], a[92:95], v[144:147], v[92:95]
    v_exp_f32 v159, v159
    s_nop 0
    v_mfma_f32_16x16x32_bf16 a[248:251], v[220:223], v[144:147], a[248:251]
    v_cvt_pk_bf16_f32 v155, v158, v159
    s_nop 1
    v_mfma_f32_16x16x32_bf16 v[96:99], a[64:67], v[152:155], v[96:99]
    v_mfma_f32_16x16x32_bf16 v[100:103], a[68:71], v[152:155], v[100:103]
    v_mfma_f32_16x16x32_bf16 v[104:107], a[72:75], v[152:155], v[104:107]
    v_mfma_f32_16x16x32_bf16 v[108:111], a[76:79], v[152:155], v[108:111]
    v_mfma_f32_16x16x32_bf16 v[112:115], a[80:83], v[152:155], v[112:115]
    v_mfma_f32_16x16x32_bf16 v[116:119], a[84:87], v[152:155], v[116:119]
    v_mfma_f32_16x16x32_bf16 v[120:123], a[88:91], v[152:155], v[120:123]
    v_mfma_f32_16x16x32_bf16 v[124:127], a[92:95], v[152:155], v[124:127]
    v_mfma_f32_16x16x32_bf16 a[252:255], v[220:223], v[152:155], a[252:255]
    v_mfma_f32_16x16x32_bf16 a[224:227], a[208:211], a[160:163], a[224:227]
    ds_read_b64_tr_b16 a[216:217], v210 offset:6144
    ds_read_b64_tr_b16 a[218:219], v210 offset:7168
    v_mfma_f32_16x16x32_bf16 a[232:235], a[208:211], a[164:167], a[232:235]
    ds_read_b64_tr_b16 a[220:221], v211 offset:6144
    ds_read_b64_tr_b16 a[222:223], v211 offset:7168
    v_mfma_f32_16x16x32_bf16 a[228:231], a[212:215], a[160:163], a[228:231]
    v_mfma_f32_16x16x32_bf16 a[236:239], a[212:215], a[164:167], a[236:239]
    s_waitcnt lgkmcnt(0)
    v_mfma_f32_16x16x32_bf16 a[224:227], a[216:219], a[168:171], a[224:227]
    ds_read_b64_tr_b16 a[208:209], v210 offset:8192
    ds_read_b64_tr_b16 a[210:211], v210 offset:9216
    v_accvgpr_read_b32 v214, a248
    v_accvgpr_read_b32 v215, a252
    v_add_f32 v212, v214, v215
    v_cmp_nle_f32 vcc, v212, v219
    s_lshl_b32 s59, s3, 2
    s_add_u32 s59, s59, 28672
    v_mfma_f32_16x16x32_bf16 a[232:235], a[216:219], a[172:175], a[232:235]
    ds_read_b64_tr_b16 a[212:213], v211 offset:8192
    ds_read_b64_tr_b16 a[214:215], v211 offset:9216
    v_mov_b32 v212, s59
    s_andn2_b64 vcc, vcc, s[60:61]
    s_cselect_b32 s59, 1, s62
    s_add_u32 s83, s69, 524288
    v_mov_b32 v213, s59
    s_cmp_lg_u32 s59, 0
    s_cselect_b32 s83, 536870912, s83
    v_mfma_f32_16x16x32_bf16 a[228:231], a[220:223], a[168:171], a[228:231]
    v_rcp_f32 v214, v214
    v_rcp_f32 v215, v215
    s_nop 0
    v_mul_f32 v64, v64, v214
    v_mul_f32 v65, v65, v214
    v_mfma_f32_16x16x32_bf16 a[236:239], a[220:223], a[172:175], a[236:239]
    s_waitcnt vmcnt(13) lgkmcnt(0)
    v_mul_f32 v66, v66, v214
    v_mul_f32 v67, v67, v214
    v_mul_f32 v68, v68, v214
    v_mul_f32 v69, v69, v214
    v_mul_f32 v70, v70, v214
    v_mul_f32 v71, v71, v214
    v_cvt_pk_bf16_f32 v64, v64, v65
    v_mfma_f32_16x16x32_bf16 a[224:227], a[208:211], a[176:179], a[224:227]
    ds_read_b64_tr_b16 a[216:217], v210 offset:10240
    ds_read_b64_tr_b16 a[218:219], v210 offset:11264
    v_cvt_pk_bf16_f32 v65, v66, v67
    v_cvt_pk_bf16_f32 v66, v68, v69
    v_cvt_pk_bf16_f32 v67, v70, v71
    v_mul_f32 v72, v72, v214
    v_mul_f32 v73, v73, v214
    v_mfma_f32_16x16x32_bf16 a[232:235], a[208:211], a[180:183], a[232:235]
    ds_read_b64_tr_b16 a[220:221], v211 offset:10240
    ds_read_b64_tr_b16 a[222:223], v211 offset:11264
    v_mul_f32 v74, v74, v214
    v_mul_f32 v75, v75, v214
    v_mul_f32 v76, v76, v214
    v_mul_f32 v77, v77, v214
    v_mul_f32 v78, v78, v214
    v_mfma_f32_16x16x32_bf16 a[228:231], a[212:215], a[176:179], a[228:231]
    s_lshl_b32 s56, s7, 6
    s_add_u32 s56, s56, s4
    s_lshl_b32 s56, s56, 2
    s_and_b32 s63, s4, 3
    s_add_u32 s56, s56, s63
    s_lshl_b32 s56, s56, 10
    s_add_u32 s56, s56, 8388608
    s_xor_b32 s63, s56, 0
    buffer_store_dwordx4 v[64:67], v242, s[8:11], s63 offen sc1
    v_mfma_f32_16x16x32_bf16 a[236:239], a[212:215], a[180:183], a[236:239]
    s_waitcnt vmcnt(12) lgkmcnt(0)
    v_mul_f32 v79, v79, v214
    v_cvt_pk_bf16_f32 v72, v72, v73
    v_cvt_pk_bf16_f32 v73, v74, v75
    v_cvt_pk_bf16_f32 v74, v76, v77
    v_cvt_pk_bf16_f32 v75, v78, v79
    v_mul_f32 v80, v80, v214
    v_mul_f32 v81, v81, v214
    v_mfma_f32_16x16x32_bf16 a[224:227], a[216:219], a[184:187], a[224:227]
    ds_read_b64_tr_b16 a[208:209], v210 offset:12288
    ds_read_b64_tr_b16 a[210:211], v210 offset:13312
    v_mul_f32 v82, v82, v214
    v_mul_f32 v83, v83, v214
    v_mul_f32 v84, v84, v214
    v_mul_f32 v85, v85, v214
    v_mul_f32 v86, v86, v214
    v_mfma_f32_16x16x32_bf16 a[232:235], a[216:219], a[188:191], a[232:235]
    ds_read_b64_tr_b16 a[212:213], v211 offset:12288
    ds_read_b64_tr_b16 a[214:215], v211 offset:13312
    v_mul_f32 v87, v87, v214
    v_cvt_pk_bf16_f32 v80, v80, v81
    v_cvt_pk_bf16_f32 v81, v82, v83
    v_cvt_pk_bf16_f32 v82, v84, v85
    v_cvt_pk_bf16_f32 v83, v86, v87
    v_mfma_f32_16x16x32_bf16 a[228:231], a[220:223], a[184:187], a[228:231]
    s_xor_b32 s63, s56, 1024
    buffer_store_dwordx4 v[72:75], v242, s[8:11], s63 offen sc1
    v_mul_f32 v88, v88, v214
    v_mul_f32 v89, v89, v214
    v_mul_f32 v90, v90, v214
    v_mul_f32 v91, v91, v214
    v_mul_f32 v92, v92, v214
    v_mfma_f32_16x16x32_bf16 a[236:239], a[220:223], a[188:191], a[236:239]
    s_waitcnt vmcnt(11) lgkmcnt(0)
    s_xor_b32 s63, s56, 2048
    buffer_store_dwordx4 v[80:83], v242, s[8:11], s63 offen sc1
    v_mul_f32 v93, v93, v214
    v_mul_f32 v94, v94, v214
    v_mul_f32 v95, v95, v214
    v_cvt_pk_bf16_f32 v88, v88, v89
    v_mfma_f32_16x16x32_bf16 a[224:227], a[208:211], a[192:195], a[224:227]
    ds_read_b64_tr_b16 a[216:217], v210 offset:14336
    ds_read_b64_tr_b16 a[218:219], v210 offset:15360
    v_cvt_pk_bf16_f32 v89, v90, v91
    v_cvt_pk_bf16_f32 v90, v92, v93
    v_cvt_pk_bf16_f32 v91, v94, v95
    v_mul_f32 v96, v96, v215
    v_mul_f32 v97, v97, v215
    v_mfma_f32_16x16x32_bf16 a[232:235], a[208:211], a[196:199], a[232:235]
    ds_read_b64_tr_b16 a[220:221], v211 offset:14336
    ds_read_b64_tr_b16 a[222:223], v211 offset:15360
    v_mul_f32 v98, v98, v215
    v_mul_f32 v99, v99, v215
    v_mul_f32 v100, v100, v215
    v_mul_f32 v101, v101, v215
    v_mul_f32 v102, v102, v215
    v_mfma_f32_16x16x32_bf16 a[228:231], a[212:215], a[192:195], a[228:231]
    s_xor_b32 s63, s56, 3072
    buffer_store_dwordx4 v[88:91], v242, s[8:11], s63 offen sc1
    v_mul_f32 v103, v103, v215
    v_cvt_pk_bf16_f32 v96, v96, v97
    v_cvt_pk_bf16_f32 v97, v98, v99
    v_cvt_pk_bf16_f32 v98, v100, v101
    v_cvt_pk_bf16_f32 v99, v102, v103
    v_mfma_f32_16x16x32_bf16 a[236:239], a[212:215], a[196:199], a[236:239]
    s_waitcnt vmcnt(11) lgkmcnt(0)
    s_add_u32 s56, s56, 131072
    s_xor_b32 s63, s56, 0
    buffer_store_dwordx4 v[96:99], v242, s[8:11], s63 offen sc1
    v_mul_f32 v104, v104, v215
    v_mul_f32 v105, v105, v215
    v_mul_f32 v106, v106, v215
    ds_write_b32 v212, v213
    v_mov_b32 v247, 28672
    v_mfma_f32_16x16x32_bf16 a[224:227], a[216:219], a[200:203], a[224:227]
    ds_read_b64_tr_b16 a[208:209], v210 offset:16384
    ds_read_b64_tr_b16 a[210:211], v210 offset:17408
    v_mul_f32 v107, v107, v215
    v_mul_f32 v108, v108, v215
    v_mul_f32 v109, v109, v215
    v_mul_f32 v110, v110, v215
    v_mul_f32 v111, v111, v215
    v_mfma_f32_16x16x32_bf16 a[232:235], a[216:219], a[204:207], a[232:235]
    ds_read_b64_tr_b16 a[212:213], v211 offset:16384
    ds_read_b64_tr_b16 a[214:215], v211 offset:17408
    v_cvt_pk_bf16_f32 v104, v104, v105
    v_cvt_pk_bf16_f32 v105, v106, v107
    v_cvt_pk_bf16_f32 v106, v108, v109
    v_cvt_pk_bf16_f32 v107, v110, v111
    v_mul_f32 v112, v112, v215
    v_mfma_f32_16x16x32_bf16 a[228:231], a[220:223], a[200:203], a[228:231]
    s_xor_b32 s63, s56, 1024
    buffer_store_dwordx4 v[104:107], v242, s[8:11], s63 offen sc1
    v_mul_f32 v113, v113, v215
    v_mul_f32 v114, v114, v215
    v_mul_f32 v115, v115, v215
    v_mul_f32 v116, v116, v215
    v_mul_f32 v117, v117, v215
    v_mfma_f32_16x16x32_bf16 a[236:239], a[220:223], a[204:207], a[236:239]
    s_waitcnt vmcnt(11) lgkmcnt(0)
    v_mul_f32 v118, v118, v215
    v_mul_f32 v119, v119, v215
    v_cvt_pk_bf16_f32 v112, v112, v113
    v_cvt_pk_bf16_f32 v113, v114, v115
    v_cvt_pk_bf16_f32 v114, v116, v117
    v_cvt_pk_bf16_f32 v115, v118, v119
    v_mul_f32 v120, v120, v215
    s_barrier
    ds_read_b128 v[220:223], v247
    v_mfma_f32_16x16x32_bf16 a[224:227], a[208:211], a[128:131], a[224:227]
    ds_read_b64_tr_b16 a[216:217], v210 offset:18432
    ds_read_b64_tr_b16 a[218:219], v210 offset:19456
    v_mul_f32 v121, v121, v215
    v_mul_f32 v122, v122, v215
    v_mul_f32 v123, v123, v215
    v_mul_f32 v124, v124, v215
    v_mul_f32 v125, v125, v215
    v_mfma_f32_16x16x32_bf16 a[232:235], a[208:211], a[132:135], a[232:235]
    ds_read_b64_tr_b16 a[220:221], v211 offset:18432
    ds_read_b64_tr_b16 a[222:223], v211 offset:19456
    v_mul_f32 v126, v126, v215
    v_mul_f32 v127, v127, v215
    v_cvt_pk_bf16_f32 v120, v120, v121
    v_cvt_pk_bf16_f32 v121, v122, v123
    v_cvt_pk_bf16_f32 v122, v124, v125
    v_mfma_f32_16x16x32_bf16 a[228:231], a[212:215], a[128:131], a[228:231]
    s_xor_b32 s63, s56, 2048
    buffer_store_dwordx4 v[112:115], v242, s[8:11], s63 offen sc1
    v_cvt_pk_bf16_f32 v123, v126, v127
    s_add_u32 s59, s75, 1
    s_and_b32 s59, s59, 3
    s_lshl_b32 s59, s59, 6
    v_xor_b32 v68, s59, v224
    v_mfma_f32_16x16x32_bf16 a[236:239], a[212:215], a[132:135], a[236:239]
    s_waitcnt vmcnt(10) lgkmcnt(0)
    s_xor_b32 s63, s56, 3072
    buffer_store_dwordx4 v[120:123], v242, s[8:11], s63 offen sc1
    v_add_u32 v84, 0x10000, v68
    v_add_u32 v100, 0x20000, v68
    v_xor_b32 v69, s59, v225
    v_add_u32 v85, 0x10000, v69
    v_or3_b32 v220, v220, v221, v222
    v_or_b32 v220, v220, v223
    v_lshrrev_b32 v247, 4, v242
    v_xor_b32 v221, s78, v247
    v_readfirstlane_b32 s80, v220
    v_and_b32 v221, 1, v221
    v_and_b32 v247, 7, v247
    v_lshlrev_b32 v247, 7, v247
    v_lshl_add_u32 v247, v221, 19, v247
    s_lshl_b32 s52, s78, 18
    s_cmp_lg_u32 s80, 0
    s_cbranch_scc1 restart
    s_lshl_b32 s80, s75, 15
    s_add_u32 s52, s52, s80
    s_add_u32 s52, s52, 8388608
    v_mfma_f32_16x16x32_bf16 a[224:227], a[216:219], a[136:139], a[224:227]
    ds_read_b64_tr_b16 a[208:209], v210 offset:20480
    ds_read_b64_tr_b16 a[210:211], v210 offset:21504
    v_add_u32 v101, 0x20000, v69
    s_add_u32 s59, s75, 2
    s_and_b32 s59, s59, 3
    s_lshl_b32 s59, s59, 6
    v_xor_b32 v70, s59, v224
    v_mfma_f32_16x16x32_bf16 a[232:235], a[216:219], a[140:143], a[232:235]
    ds_read_b64_tr_b16 a[212:213], v211 offset:20480
    ds_read_b64_tr_b16 a[214:215], v211 offset:21504
    v_add_u32 v86, 0x10000, v70
    v_add_u32 v102, 0x20000, v70
    v_xor_b32 v71, s59, v225
    v_add_u32 v87, 0x10000, v71
    v_add_u32 v103, 0x20000, v71
    s_add_u32 s59, s75, 3
    s_and_b32 s59, s59, 3
    s_lshl_b32 s59, s59, 6
    v_mfma_f32_16x16x32_bf16 a[228:231], a[220:223], a[136:139], a[228:231]
    v_xor_b32 v76, s59, v224
    v_add_u32 v92, 0x10000, v76
    v_add_u32 v108, 0x20000, v76
    v_xor_b32 v77, s59, v225
    v_add_u32 v93, 0x10000, v77
    v_add_u32 v109, 0x20000, v77
    s_add_u32 s59, s75, 4
    s_and_b32 s59, s59, 3
    s_lshl_b32 s59, s59, 6
    v_mfma_f32_16x16x32_bf16 a[236:239], a[220:223], a[140:143], a[236:239]
    s_waitcnt vmcnt(9) lgkmcnt(0)
    v_xor_b32 v78, s59, v224
    v_add_u32 v94, 0x10000, v78
    v_add_u32 v110, 0x20000, v78
    v_xor_b32 v79, s59, v225
    v_add_u32 v95, 0x10000, v79
    v_add_u32 v111, 0x20000, v79
    v_and_b32 v124, 0x18, v255
    v_mfma_f32_16x16x32_bf16 a[224:227], a[208:211], a[144:147], a[224:227]
    v_mfma_f32_16x16x32_bf16 a[232:235], a[208:211], a[148:151], a[232:235]
    v_mfma_f32_16x16x32_bf16 a[228:231], a[212:215], a[144:147], a[228:231]
    v_mfma_f32_16x16x32_bf16 a[236:239], a[212:215], a[148:151], a[236:239]
    s_add_u32 m0, s57, 98304
    s_add_u32 s54, s4, 1
    s_and_b32 s54, s54, 7
    s_lshl_b32 s54, s54, 17
    buffer_load_dwordx4 v250, s[28:31], s54 offen offset:0 lds
    buffer_load_dwordx4 v251, s[28:31], s54 offen offset:1024 lds
    buffer_load_dwordx4 v252, s[28:31], s54 offen offset:2048 lds
    buffer_load_dwordx4 v253, s[28:31], s54 offen offset:3072 lds
    s_add_u32 m0, s57, 114688
    s_add_u32 s54, s4, 1
    s_and_b32 s54, s54, 7
    s_lshl_b32 s54, s54, 17
    s_add_u32 s54, s54, 65536
    buffer_load_dwordx4 v250, s[28:31], s54 offen offset:0 lds
    buffer_load_dwordx4 v251, s[28:31], s54 offen offset:1024 lds
    buffer_load_dwordx4 v252, s[28:31], s54 offen offset:2048 lds
    buffer_load_dwordx4 v253, s[28:31], s54 offen offset:3072 lds
    buffer_load_dwordx2 v[216:217], v124, s[48:51], 0 offen
    buffer_load_dwordx2 v[218:219], v124, s[48:51], 0 offen offset:32
    s_lshr_b32 s59, s3, 1
    s_xor_b32 s59, s59, s76
    s_bitcmp1_b32 s59, 0
    s_cbranch_scc1 own_skip
    s_and_b32 s59, s6, 3
    s_lshl_b32 s59, s59, 13
    s_add_u32 s59, s59, 131072
    v_add_u32 v214, s59, v242
    ds_write_b128 v214, v[0:3] offset:0
    ds_write_b128 v214, v[8:11] offset:1024
    ds_write_b128 v214, v[16:19] offset:2048
    ds_write_b128 v214, v[24:27] offset:3072
    ds_write_b128 v214, v[32:35] offset:4096
    ds_write_b128 v214, v[40:43] offset:5120
    ds_write_b128 v214, v[48:51] offset:6144
    ds_write_b128 v214, v[56:59] offset:7168
    s_and_b32 s59, s7, 3
    s_lshl_b32 s59, s59, 13
    s_add_u32 s59, s59, 131072
    v_add_u32 v215, s59, v242
    ds_write_b128 v215, v[64:67] offset:0
    ds_write_b128 v215, v[72:75] offset:1024
    ds_write_b128 v215, v[80:83] offset:2048
    ds_write_b128 v215, v[88:91] offset:3072
    ds_write_b128 v215, v[96:99] offset:4096
    ds_write_b128 v215, v[104:107] offset:5120
    ds_write_b128 v215, v[112:115] offset:6144
    ds_write_b128 v215, v[120:123] offset:7168
    s_waitcnt lgkmcnt(0)
own_skip:
    s_waitcnt vmcnt(10)
    buffer_store_dword v248, v249, s[8:11], s83 offen sc1
    s_barrier
    s_lshl_b32 s59, s3, 13
    s_add_u32 s59, s59, 131072
    v_add_u32 v214, s59, v242
    ds_read_b128 a[0:3], v214 offset:0
    ds_read_b128 a[4:7], v214 offset:4096
    ds_read_b128 a[8:11], v214 offset:1024
    ds_read_b128 a[12:15], v214 offset:5120
    ds_read_b128 a[16:19], v214 offset:2048
    ds_read_b128 a[20:23], v214 offset:6144
    ds_read_b128 a[24:27], v214 offset:3072
    ds_read_b128 a[28:31], v214 offset:7168
    ds_read_b64_tr_b16 v[4:5], v84 offset:0
    ds_read_b64_tr_b16 v[6:7], v84 offset:4096
    ds_read_b64_tr_b16 v[12:13], v85 offset:0
    ds_read_b64_tr_b16 v[14:15], v85 offset:4096
    ds_read_b64_tr_b16 v[20:21], v86 offset:0
    ds_read_b64_tr_b16 v[22:23], v86 offset:4096
    ds_read_b64_tr_b16 v[28:29], v87 offset:0
    ds_read_b64_tr_b16 v[30:31], v87 offset:4096
    ds_read_b64_tr_b16 v[36:37], v92 offset:0
    ds_read_b64_tr_b16 v[38:39], v92 offset:4096
    ds_read_b64_tr_b16 v[44:45], v93 offset:0
    ds_read_b64_tr_b16 v[46:47], v93 offset:4096
    ds_read_b64_tr_b16 v[52:53], v94 offset:0
    ds_read_b64_tr_b16 v[54:55], v94 offset:4096
    ds_read_b64_tr_b16 v[60:61], v95 offset:0
    ds_read_b64_tr_b16 v[62:63], v95 offset:4096
    s_waitcnt lgkmcnt(8)
    v_mfma_f32_16x16x32_bf16 v[128:131], v[4:7], a[0:3], 0
    s_add_u32 m0, s57, 32768
    s_add_u32 s54, s4, 2
    s_and_b32 s54, s54, 7
    s_lshl_b32 s54, s54, 17
    buffer_load_dwordx4 v250, s[28:31], s54 offen offset:0 lds
    v_mfma_f32_16x16x32_bf16 v[160:163], v[4:7], a[4:7], 0
    ds_read_b64_tr_b16 v[4:5], v84 offset:8192
    ds_read_b64_tr_b16 v[6:7], v84 offset:12288
    v_mfma_f32_16x16x32_bf16 v[132:135], v[12:15], a[0:3], 0
    buffer_load_dwordx4 v251, s[28:31], s54 offen offset:1024 lds
    v_mfma_f32_16x16x32_bf16 v[164:167], v[12:15], a[4:7], 0
    ds_read_b64_tr_b16 v[12:13], v85 offset:8192
    ds_read_b64_tr_b16 v[14:15], v85 offset:12288
    v_mfma_f32_16x16x32_bf16 v[136:139], v[20:23], a[0:3], 0
    buffer_load_dwordx4 v252, s[28:31], s54 offen offset:2048 lds
    v_mfma_f32_16x16x32_bf16 v[168:171], v[20:23], a[4:7], 0
    ds_read_b64_tr_b16 v[20:21], v86 offset:8192
    ds_read_b64_tr_b16 v[22:23], v86 offset:12288
    v_mfma_f32_16x16x32_bf16 v[140:143], v[28:31], a[0:3], 0
    buffer_load_dwordx4 v253, s[28:31], s54 offen offset:3072 lds
    v_mfma_f32_16x16x32_bf16 v[172:175], v[28:31], a[4:7], 0
    s_waitcnt lgkmcnt(8)
    ds_read_b64_tr_b16 v[28:29], v87 offset:8192
    ds_read_b64_tr_b16 v[30:31], v87 offset:12288
    v_mfma_f32_16x16x32_bf16 v[144:147], v[36:39], a[0:3], 0
    s_add_u32 m0, s57, 49152
    s_add_u32 s54, s4, 2
    s_and_b32 s54, s54, 7
    s_lshl_b32 s54, s54, 17
    s_add_u32 s54, s54, 65536
    buffer_load_dwordx4 v250, s[28:31], s54 offen offset:0 lds
    v_mfma_f32_16x16x32_bf16 v[176:179], v[36:39], a[4:7], 0
    ds_read_b64_tr_b16 v[36:37], v92 offset:8192
    ds_read_b64_tr_b16 v[38:39], v92 offset:12288
    v_mfma_f32_16x16x32_bf16 v[148:151], v[44:47], a[0:3], 0
    buffer_load_dwordx4 v251, s[28:31], s54 offen offset:1024 lds
    v_mfma_f32_16x16x32_bf16 v[180:183], v[44:47], a[4:7], 0
    ds_read_b64_tr_b16 v[44:45], v93 offset:8192
    ds_read_b64_tr_b16 v[46:47], v93 offset:12288
    v_mfma_f32_16x16x32_bf16 v[152:155], v[52:55], a[0:3], 0
    buffer_load_dwordx4 v252, s[28:31], s54 offen offset:2048 lds
    v_mfma_f32_16x16x32_bf16 v[184:187], v[52:55], a[4:7], 0
    s_waitcnt lgkmcnt(12)
    ds_read_b64_tr_b16 v[52:53], v94 offset:8192
    ds_read_b64_tr_b16 v[54:55], v94 offset:12288
    v_mfma_f32_16x16x32_bf16 v[156:159], v[60:63], a[0:3], 0
    buffer_load_dwordx4 v253, s[28:31], s54 offen offset:3072 lds
    v_mfma_f32_16x16x32_bf16 v[188:191], v[60:63], a[4:7], 0
    s_waitcnt lgkmcnt(6)
    ds_read_b64_tr_b16 v[60:61], v95 offset:8192
    ds_read_b64_tr_b16 v[62:63], v95 offset:12288
    v_mfma_f32_16x16x32_bf16 v[128:131], v[4:7], a[8:11], v[128:131]
    s_waitcnt vmcnt(9)
    s_mov_b32 s59, 0xbfb8aa3b
    v_mfma_f32_16x16x32_bf16 v[160:163], v[4:7], a[12:15], v[160:163]
    ds_read_b64_tr_b16 v[4:5], v84 offset:16384
    ds_read_b64_tr_b16 v[6:7], v84 offset:20480
    v_mfma_f32_16x16x32_bf16 v[132:135], v[12:15], a[8:11], v[132:135]
    s_mov_b32 s63, 0x4275fdf0
    v_accvgpr_read_b32 v192, a224
    v_mfma_f32_16x16x32_bf16 v[164:167], v[12:15], a[12:15], v[164:167]
    ds_read_b64_tr_b16 v[12:13], v85 offset:16384
    ds_read_b64_tr_b16 v[14:15], v85 offset:20480
    v_mfma_f32_16x16x32_bf16 v[136:139], v[20:23], a[8:11], v[136:139]
    v_accvgpr_read_b32 v193, a225
    v_accvgpr_read_b32 v194, a226
    v_mfma_f32_16x16x32_bf16 v[168:171], v[20:23], a[12:15], v[168:171]
    ds_read_b64_tr_b16 v[20:21], v86 offset:16384
    ds_read_b64_tr_b16 v[22:23], v86 offset:20480
    v_mfma_f32_16x16x32_bf16 v[140:143], v[28:31], a[8:11], v[140:143]
    v_accvgpr_read_b32 v195, a227
    v_lshlrev_b32 v124, 16, v216
    v_mfma_f32_16x16x32_bf16 v[172:175], v[28:31], a[12:15], v[172:175]
    s_waitcnt lgkmcnt(8)
    ds_read_b64_tr_b16 v[28:29], v87 offset:16384
    ds_read_b64_tr_b16 v[30:31], v87 offset:20480
    v_mfma_f32_16x16x32_bf16 v[144:147], v[36:39], a[8:11], v[144:147]
    v_and_b32 v125, 0xffff0000, v216
    v_lshlrev_b32 v126, 16, v217
    v_mfma_f32_16x16x32_bf16 v[176:179], v[36:39], a[12:15], v[176:179]
    ds_read_b64_tr_b16 v[36:37], v92 offset:16384
    ds_read_b64_tr_b16 v[38:39], v92 offset:20480
    v_mfma_f32_16x16x32_bf16 v[148:151], v[44:47], a[8:11], v[148:151]
    v_and_b32 v127, 0xffff0000, v217
    v_fma_f32 v192, v192, s63, v124
    v_mfma_f32_16x16x32_bf16 v[180:183], v[44:47], a[12:15], v[180:183]
    ds_read_b64_tr_b16 v[44:45], v93 offset:16384
    ds_read_b64_tr_b16 v[46:47], v93 offset:20480
    v_mfma_f32_16x16x32_bf16 v[152:155], v[52:55], a[8:11], v[152:155]
    v_fma_f32 v193, v193, s63, v125
    v_fma_f32 v194, v194, s63, v126
    v_mfma_f32_16x16x32_bf16 v[184:187], v[52:55], a[12:15], v[184:187]
    s_waitcnt lgkmcnt(12)
    ds_read_b64_tr_b16 v[52:53], v94 offset:16384
    ds_read_b64_tr_b16 v[54:55], v94 offset:20480
    v_mfma_f32_16x16x32_bf16 v[156:159], v[60:63], a[8:11], v[156:159]
    v_fma_f32 v195, v195, s63, v127
    v_mul_f32 v124, s59, v192
    v_mfma_f32_16x16x32_bf16 v[188:191], v[60:63], a[12:15], v[188:191]
    s_waitcnt lgkmcnt(6)
    ds_read_b64_tr_b16 v[60:61], v95 offset:16384
    ds_read_b64_tr_b16 v[62:63], v95 offset:20480
    v_mfma_f32_16x16x32_bf16 v[128:131], v[4:7], a[16:19], v[128:131]
    buffer_load_dword v212, v247, s[8:11], s70 offen sc1
    v_mfma_f32_16x16x32_bf16 v[160:163], v[4:7], a[20:23], v[160:163]
    ds_read_b64_tr_b16 v[4:5], v84 offset:24576
    ds_read_b64_tr_b16 v[6:7], v84 offset:28672
    v_mfma_f32_16x16x32_bf16 v[132:135], v[12:15], a[16:19], v[132:135]
    s_add_u32 m0, s57, 0
    s_add_u32 s54, s4, 3
    s_and_b32 s54, s54, 7
    s_lshl_b32 s54, s54, 17
    buffer_load_dwordx4 v250, s[28:31], s54 offen offset:0 lds
    v_mfma_f32_16x16x32_bf16 v[164:167], v[12:15], a[20:23], v[164:167]
    ds_read_b64_tr_b16 v[12:13], v85 offset:24576
    ds_read_b64_tr_b16 v[14:15], v85 offset:28672
    v_mfma_f32_16x16x32_bf16 v[136:139], v[20:23], a[16:19], v[136:139]
    buffer_load_dwordx4 v251, s[28:31], s54 offen offset:1024 lds
    v_mfma_f32_16x16x32_bf16 v[168:171], v[20:23], a[20:23], v[168:171]
    ds_read_b64_tr_b16 v[20:21], v86 offset:24576
    ds_read_b64_tr_b16 v[22:23], v86 offset:28672
    v_mfma_f32_16x16x32_bf16 v[140:143], v[28:31], a[16:19], v[140:143]
    buffer_load_dwordx4 v252, s[28:31], s54 offen offset:2048 lds
    v_mfma_f32_16x16x32_bf16 v[172:175], v[28:31], a[20:23], v[172:175]
    s_waitcnt lgkmcnt(8)
    ds_read_b64_tr_b16 v[28:29], v87 offset:24576
    ds_read_b64_tr_b16 v[30:31], v87 offset:28672
    v_mfma_f32_16x16x32_bf16 v[144:147], v[36:39], a[16:19], v[144:147]
    buffer_load_dwordx4 v253, s[28:31], s54 offen offset:3072 lds
    v_mfma_f32_16x16x32_bf16 v[176:179], v[36:39], a[20:23], v[176:179]
    ds_read_b64_tr_b16 v[36:37], v92 offset:24576
    ds_read_b64_tr_b16 v[38:39], v92 offset:28672
    v_mfma_f32_16x16x32_bf16 v[148:151], v[44:47], a[16:19], v[148:151]
    v_mul_f32 v125, s59, v193
    v_mul_f32 v126, s59, v194
    v_mfma_f32_16x16x32_bf16 v[180:183], v[44:47], a[20:23], v[180:183]
    ds_read_b64_tr_b16 v[44:45], v93 offset:24576
    ds_read_b64_tr_b16 v[46:47], v93 offset:28672
    v_mfma_f32_16x16x32_bf16 v[152:155], v[52:55], a[16:19], v[152:155]
    v_mul_f32 v127, s59, v195
    v_mfma_f32_16x16x32_bf16 v[184:187], v[52:55], a[20:23], v[184:187]
    s_waitcnt lgkmcnt(12)
    ds_read_b64_tr_b16 v[52:53], v94 offset:24576
    ds_read_b64_tr_b16 v[54:55], v94 offset:28672
    v_mfma_f32_16x16x32_bf16 v[156:159], v[60:63], a[16:19], v[156:159]
    v_exp_f32 v124, v124
    v_mfma_f32_16x16x32_bf16 v[188:191], v[60:63], a[20:23], v[188:191]
    s_waitcnt lgkmcnt(6)
    s_barrier
    ds_read_b64_tr_b16 v[60:61], v95 offset:24576
    ds_read_b64_tr_b16 v[62:63], v95 offset:28672
    v_mfma_f32_16x16x32_bf16 v[128:131], v[4:7], a[24:27], v[128:131]
    s_add_u32 m0, s57, 16384
    s_add_u32 s54, s4, 3
    s_and_b32 s54, s54, 7
    s_lshl_b32 s54, s54, 17
    s_add_u32 s54, s54, 65536
    buffer_load_dwordx4 v250, s[28:31], s54 offen offset:0 lds
    v_mfma_f32_16x16x32_bf16 v[160:163], v[4:7], a[28:31], v[160:163]
    ds_read_b64_tr_b16 v[4:5], v84 offset:32768
    ds_read_b64_tr_b16 v[6:7], v84 offset:36864
    v_mfma_f32_16x16x32_bf16 v[132:135], v[12:15], a[24:27], v[132:135]
    buffer_load_dwordx4 v251, s[28:31], s54 offen offset:1024 lds
    v_mfma_f32_16x16x32_bf16 v[164:167], v[12:15], a[28:31], v[164:167]
    ds_read_b64_tr_b16 v[12:13], v85 offset:32768
    ds_read_b64_tr_b16 v[14:15], v85 offset:36864
    v_mfma_f32_16x16x32_bf16 v[136:139], v[20:23], a[24:27], v[136:139]
    buffer_load_dwordx4 v252, s[28:31], s54 offen offset:2048 lds
    v_mfma_f32_16x16x32_bf16 v[168:171], v[20:23], a[28:31], v[168:171]
    ds_read_b64_tr_b16 v[20:21], v86 offset:32768
    ds_read_b64_tr_b16 v[22:23], v86 offset:36864
    v_mfma_f32_16x16x32_bf16 v[140:143], v[28:31], a[24:27], v[140:143]
    buffer_load_dwordx4 v253, s[28:31], s54 offen offset:3072 lds
    v_mfma_f32_16x16x32_bf16 v[172:175], v[28:31], a[28:31], v[172:175]
    s_waitcnt lgkmcnt(8)
    ds_read_b64_tr_b16 v[28:29], v87 offset:32768
    ds_read_b64_tr_b16 v[30:31], v87 offset:36864
    v_mfma_f32_16x16x32_bf16 v[144:147], v[36:39], a[24:27], v[144:147]
    v_exp_f32 v125, v125
    v_mfma_f32_16x16x32_bf16 v[176:179], v[36:39], a[28:31], v[176:179]
    ds_read_b64_tr_b16 v[36:37], v92 offset:32768
    ds_read_b64_tr_b16 v[38:39], v92 offset:36864
    v_mfma_f32_16x16x32_bf16 v[148:151], v[44:47], a[24:27], v[148:151]
    v_exp_f32 v126, v126
    v_mfma_f32_16x16x32_bf16 v[180:183], v[44:47], a[28:31], v[180:183]
    ds_read_b64_tr_b16 v[44:45], v93 offset:32768
    ds_read_b64_tr_b16 v[46:47], v93 offset:36864
    v_mfma_f32_16x16x32_bf16 v[152:155], v[52:55], a[24:27], v[152:155]
    v_exp_f32 v127, v127
    v_mfma_f32_16x16x32_bf16 v[184:187], v[52:55], a[28:31], v[184:187]
    s_waitcnt lgkmcnt(12)
    ds_read_b64_tr_b16 v[52:53], v94 offset:32768
    ds_read_b64_tr_b16 v[54:55], v94 offset:36864
    v_mfma_f32_16x16x32_bf16 v[156:159], v[60:63], a[24:27], v[156:159]
    s_nop 0
    v_add_f32 v124, 1.0, v124
    v_mfma_f32_16x16x32_bf16 v[188:191], v[60:63], a[28:31], v[188:191]
    s_waitcnt lgkmcnt(6)
    ds_read_b64_tr_b16 v[60:61], v95 offset:32768
    ds_read_b64_tr_b16 v[62:63], v95 offset:36864
    v_add_f32 v125, 1.0, v125
    v_add_f32 v126, 1.0, v126
    v_add_f32 v127, 1.0, v127
    v_rcp_f32 v124, v124
    v_rcp_f32 v125, v125
    v_rcp_f32 v126, v126
    v_rcp_f32 v127, v127
    s_nop 0
    v_mul_f32 v192, v192, v124
    v_mul_f32 v193, v193, v125
    v_mul_f32 v194, v194, v126
    v_mul_f32 v195, v195, v127
    v_accvgpr_read_b32 v196, a228
    v_accvgpr_read_b32 v197, a229
    v_accvgpr_read_b32 v198, a230
    v_accvgpr_read_b32 v199, a231
    v_lshlrev_b32 v124, 16, v218
    v_and_b32 v125, 0xffff0000, v218
    v_lshlrev_b32 v126, 16, v219
    v_and_b32 v127, 0xffff0000, v219
    v_fma_f32 v196, v196, s63, v124
    v_fma_f32 v197, v197, s63, v125
    v_fma_f32 v198, v198, s63, v126
    v_fma_f32 v199, v199, s63, v127
    v_mul_f32 v124, s59, v196
    v_mul_f32 v125, s59, v197
    v_mul_f32 v126, s59, v198
    v_mul_f32 v127, s59, v199
    v_exp_f32 v124, v124
    v_exp_f32 v125, v125
    v_exp_f32 v126, v126
    v_exp_f32 v127, v127
    s_nop 0
    v_add_f32 v124, 1.0, v124
    v_add_f32 v125, 1.0, v125
    v_add_f32 v126, 1.0, v126
    v_add_f32 v127, 1.0, v127
    v_rcp_f32 v124, v124
    v_rcp_f32 v125, v125
    v_rcp_f32 v126, v126
    v_rcp_f32 v127, v127
    s_nop 0
    v_mul_f32 v196, v196, v124
    v_mul_f32 v197, v197, v125
    v_mul_f32 v198, v198, v126
    v_mul_f32 v199, v199, v127
    v_accvgpr_read_b32 v200, a232
    v_accvgpr_read_b32 v201, a233
    v_accvgpr_read_b32 v202, a234
    v_accvgpr_read_b32 v203, a235
    v_lshlrev_b32 v124, 16, v216
    v_and_b32 v125, 0xffff0000, v216
    v_lshlrev_b32 v126, 16, v217
    v_and_b32 v127, 0xffff0000, v217
    v_fma_f32 v200, v200, s63, v124
    v_fma_f32 v201, v201, s63, v125
    v_fma_f32 v202, v202, s63, v126
    v_fma_f32 v203, v203, s63, v127
    v_mul_f32 v124, s59, v200
    v_mul_f32 v125, s59, v201
    v_mul_f32 v126, s59, v202
    v_mul_f32 v127, s59, v203
    v_exp_f32 v124, v124
    v_exp_f32 v125, v125
    v_exp_f32 v126, v126
    v_exp_f32 v127, v127
    s_nop 0
    v_add_f32 v124, 1.0, v124
    v_add_f32 v125, 1.0, v125
    v_add_f32 v126, 1.0, v126
    v_add_f32 v127, 1.0, v127
    v_rcp_f32 v124, v124
    v_rcp_f32 v125, v125
    v_rcp_f32 v126, v126
    v_rcp_f32 v127, v127
    s_nop 0
    v_mul_f32 v200, v200, v124
    v_mul_f32 v201, v201, v125
    v_mul_f32 v202, v202, v126
    v_mul_f32 v203, v203, v127
    v_accvgpr_read_b32 v204, a236
    v_accvgpr_read_b32 v205, a237
    v_accvgpr_read_b32 v206, a238
    v_accvgpr_read_b32 v207, a239
    v_lshlrev_b32 v124, 16, v218
    v_and_b32 v125, 0xffff0000, v218
    v_lshlrev_b32 v126, 16, v219
    v_and_b32 v127, 0xffff0000, v219
    v_fma_f32 v204, v204, s63, v124
    v_fma_f32 v205, v205, s63, v125
    v_fma_f32 v206, v206, s63, v126
    v_fma_f32 v207, v207, s63, v127
    v_mul_f32 v124, s59, v204
    v_mul_f32 v125, s59, v205
    v_mul_f32 v126, s59, v206
    v_mul_f32 v127, s59, v207
    v_exp_f32 v124, v124
    v_exp_f32 v125, v125
    v_exp_f32 v126, v126
    v_exp_f32 v127, v127
    s_nop 0
    v_add_f32 v124, 1.0, v124
    v_add_f32 v125, 1.0, v125
    v_add_f32 v126, 1.0, v126
    v_add_f32 v127, 1.0, v127
    v_rcp_f32 v124, v124
    v_rcp_f32 v125, v125
    v_rcp_f32 v126, v126
    v_rcp_f32 v127, v127
    s_nop 0
    v_mul_f32 v204, v204, v124
    v_mul_f32 v205, v205, v125
    v_mul_f32 v206, v206, v126
    v_mul_f32 v207, v207, v127
    s_waitcnt vmcnt(8)
    v_cmp_ne_u32 vcc, s64, v212
    s_cbranch_vccnz h3_spin
h3_ok:
    s_add_u32 s55, s4, 1
    s_and_b32 s55, s55, 7
    s_and_b32 s53, s55, 3
    s_lshl_b32 s55, s55, 2
    s_add_u32 s55, s55, s53
    s_lshl_b32 s55, s55, 10
    s_add_u32 s55, s55, s52
    s_xor_b32 s53, s55, 0
    buffer_load_dwordx4 a[32:35], v242, s[8:11], s53 offen sc1
    s_add_u32 s53, s53, 131072
    buffer_load_dwordx4 a[36:39], v242, s[8:11], s53 offen sc1
    s_xor_b32 s53, s55, 1024
    buffer_load_dwordx4 a[40:43], v242, s[8:11], s53 offen sc1
    s_add_u32 s53, s53, 131072
    buffer_load_dwordx4 a[44:47], v242, s[8:11], s53 offen sc1
    s_xor_b32 s53, s55, 2048
    buffer_load_dwordx4 a[48:51], v242, s[8:11], s53 offen sc1
    s_add_u32 s53, s53, 131072
    buffer_load_dwordx4 a[52:55], v242, s[8:11], s53 offen sc1
    s_xor_b32 s53, s55, 3072
    buffer_load_dwordx4 a[56:59], v242, s[8:11], s53 offen sc1
    s_add_u32 s53, s53, 131072
    buffer_load_dwordx4 a[60:63], v242, s[8:11], s53 offen sc1
    s_waitcnt vmcnt(6)
    v_mfma_f32_16x16x32_bf16 v[128:131], v[4:7], a[32:35], v[128:131]
    s_add_u32 s55, s4, 2
    s_and_b32 s55, s55, 7
    s_and_b32 s53, s55, 3
    s_lshl_b32 s55, s55, 2
    s_add_u32 s55, s55, s53
    s_lshl_b32 s55, s55, 10
    s_add_u32 s55, s55, s52
    s_xor_b32 s53, s55, 0
    buffer_load_dwordx4 a[64:67], v242, s[8:11], s53 offen sc1
    v_mfma_f32_16x16x32_bf16 v[160:163], v[4:7], a[36:39], v[160:163]
    ds_read_b64_tr_b16 v[4:5], v84 offset:40960
    ds_read_b64_tr_b16 v[6:7], v84 offset:45056
    v_mfma_f32_16x16x32_bf16 v[132:135], v[12:15], a[32:35], v[132:135]
    v_mfma_f32_16x16x32_bf16 v[164:167], v[12:15], a[36:39], v[164:167]
    ds_read_b64_tr_b16 v[12:13], v85 offset:40960
    ds_read_b64_tr_b16 v[14:15], v85 offset:45056
    v_mfma_f32_16x16x32_bf16 v[136:139], v[20:23], a[32:35], v[136:139]
    s_add_u32 s53, s53, 131072
    buffer_load_dwordx4 a[68:71], v242, s[8:11], s53 offen sc1
    v_mfma_f32_16x16x32_bf16 v[168:171], v[20:23], a[36:39], v[168:171]
    ds_read_b64_tr_b16 v[20:21], v86 offset:40960
    ds_read_b64_tr_b16 v[22:23], v86 offset:45056
    v_mfma_f32_16x16x32_bf16 v[140:143], v[28:31], a[32:35], v[140:143]
    s_xor_b32 s53, s55, 1024
    buffer_load_dwordx4 a[72:75], v242, s[8:11], s53 offen sc1
    v_mfma_f32_16x16x32_bf16 v[172:175], v[28:31], a[36:39], v[172:175]
    s_waitcnt lgkmcnt(8)
    ds_read_b64_tr_b16 v[28:29], v87 offset:40960
    ds_read_b64_tr_b16 v[30:31], v87 offset:45056
    v_mfma_f32_16x16x32_bf16 v[144:147], v[36:39], a[32:35], v[144:147]
    v_mfma_f32_16x16x32_bf16 v[176:179], v[36:39], a[36:39], v[176:179]
    ds_read_b64_tr_b16 v[36:37], v92 offset:40960
    ds_read_b64_tr_b16 v[38:39], v92 offset:45056
    v_mfma_f32_16x16x32_bf16 v[148:151], v[44:47], a[32:35], v[148:151]
    s_add_u32 s53, s53, 131072
    buffer_load_dwordx4 a[76:79], v242, s[8:11], s53 offen sc1
    v_mfma_f32_16x16x32_bf16 v[180:183], v[44:47], a[36:39], v[180:183]
    ds_read_b64_tr_b16 v[44:45], v93 offset:40960
    ds_read_b64_tr_b16 v[46:47], v93 offset:45056
    v_mfma_f32_16x16x32_bf16 v[152:155], v[52:55], a[32:35], v[152:155]
    v_mfma_f32_16x16x32_bf16 v[184:187], v[52:55], a[36:39], v[184:187]
    s_waitcnt lgkmcnt(12)
    ds_read_b64_tr_b16 v[52:53], v94 offset:40960
    ds_read_b64_tr_b16 v[54:55], v94 offset:45056
    v_mfma_f32_16x16x32_bf16 v[156:159], v[60:63], a[32:35], v[156:159]
    s_xor_b32 s53, s55, 2048
    buffer_load_dwordx4 a[80:83], v242, s[8:11], s53 offen sc1
    v_mfma_f32_16x16x32_bf16 v[188:191], v[60:63], a[36:39], v[188:191]
    s_waitcnt vmcnt(9) lgkmcnt(6)
    ds_read_b64_tr_b16 v[60:61], v95 offset:40960
    ds_read_b64_tr_b16 v[62:63], v95 offset:45056
    v_mfma_f32_16x16x32_bf16 v[128:131], v[4:7], a[40:43], v[128:131]
    s_lshl_b32 s56, s76, 2
    s_add_u32 s56, s56, s77
    v_mfma_f32_16x16x32_bf16 v[160:163], v[4:7], a[44:47], v[160:163]
    ds_read_b64_tr_b16 v[4:5], v84 offset:49152
    ds_read_b64_tr_b16 v[6:7], v84 offset:53248
    v_mfma_f32_16x16x32_bf16 v[132:135], v[12:15], a[40:43], v[132:135]
    s_add_u32 s53, s53, 131072
    buffer_load_dwordx4 a[84:87], v242, s[8:11], s53 offen sc1
    v_mfma_f32_16x16x32_bf16 v[164:167], v[12:15], a[44:47], v[164:167]
    ds_read_b64_tr_b16 v[12:13], v85 offset:49152
    ds_read_b64_tr_b16 v[14:15], v85 offset:53248
    v_mfma_f32_16x16x32_bf16 v[136:139], v[20:23], a[40:43], v[136:139]
    s_xor_b32 s53, s55, 3072
    buffer_load_dwordx4 a[88:91], v242, s[8:11], s53 offen sc1
    v_mfma_f32_16x16x32_bf16 v[168:171], v[20:23], a[44:47], v[168:171]
    ds_read_b64_tr_b16 v[20:21], v86 offset:49152
    ds_read_b64_tr_b16 v[22:23], v86 offset:53248
    v_mfma_f32_16x16x32_bf16 v[140:143], v[28:31], a[40:43], v[140:143]
    s_lshl_b32 s56, s56, 17
    s_add_u32 s56, s56, 25165824
    v_mfma_f32_16x16x32_bf16 v[172:175], v[28:31], a[44:47], v[172:175]
    s_waitcnt lgkmcnt(8)
    ds_read_b64_tr_b16 v[28:29], v87 offset:49152
    ds_read_b64_tr_b16 v[30:31], v87 offset:53248
    v_mfma_f32_16x16x32_bf16 v[144:147], v[36:39], a[40:43], v[144:147]
    s_add_u32 s53, s53, 131072
    buffer_load_dwordx4 a[92:95], v242, s[8:11], s53 offen sc1
    v_mfma_f32_16x16x32_bf16 v[176:179], v[36:39], a[44:47], v[176:179]
    ds_read_b64_tr_b16 v[36:37], v92 offset:49152
    ds_read_b64_tr_b16 v[38:39], v92 offset:53248
    v_mfma_f32_16x16x32_bf16 v[148:151], v[44:47], a[40:43], v[148:151]
    s_add_u32 s56, s56, s58
    v_min_u32 v249, 1, v242
    v_mfma_f32_16x16x32_bf16 v[180:183], v[44:47], a[44:47], v[180:183]
    ds_read_b64_tr_b16 v[44:45], v93 offset:49152
    ds_read_b64_tr_b16 v[46:47], v93 offset:53248
    v_mfma_f32_16x16x32_bf16 v[152:155], v[52:55], a[40:43], v[152:155]
    s_add_u32 s55, s4, 3
    s_and_b32 s55, s55, 7
    s_and_b32 s53, s55, 3
    s_lshl_b32 s55, s55, 2
    s_add_u32 s55, s55, s53
    s_lshl_b32 s55, s55, 10
    s_add_u32 s55, s55, s52
    s_xor_b32 s53, s55, 0
    buffer_load_dwordx4 a[96:99], v242, s[8:11], s53 offen sc1
    v_mfma_f32_16x16x32_bf16 v[184:187], v[52:55], a[44:47], v[184:187]
    s_waitcnt lgkmcnt(12)
    ds_read_b64_tr_b16 v[52:53], v94 offset:49152
    ds_read_b64_tr_b16 v[54:55], v94 offset:53248
    v_mfma_f32_16x16x32_bf16 v[156:159], v[60:63], a[40:43], v[156:159]
    s_add_u32 s53, s53, 131072
    buffer_load_dwordx4 a[100:103], v242, s[8:11], s53 offen sc1
    v_mfma_f32_16x16x32_bf16 v[188:191], v[60:63], a[44:47], v[188:191]
    s_waitcnt vmcnt(12) lgkmcnt(6)
    ds_read_b64_tr_b16 v[60:61], v95 offset:49152
    ds_read_b64_tr_b16 v[62:63], v95 offset:53248
    v_mfma_f32_16x16x32_bf16 v[128:131], v[4:7], a[48:51], v[128:131]
    v_lshlrev_b32 v249, 31, v249
    v_mov_b32 v248, s64
    v_mfma_f32_16x16x32_bf16 v[160:163], v[4:7], a[52:55], v[160:163]
    ds_read_b64_tr_b16 v[4:5], v84 offset:57344
    ds_read_b64_tr_b16 v[6:7], v84 offset:61440
    v_mfma_f32_16x16x32_bf16 v[132:135], v[12:15], a[48:51], v[132:135]
    s_xor_b32 s53, s55, 1024
    buffer_load_dwordx4 a[104:107], v242, s[8:11], s53 offen sc1
    v_mfma_f32_16x16x32_bf16 v[164:167], v[12:15], a[52:55], v[164:167]
    ds_read_b64_tr_b16 v[12:13], v85 offset:57344
    ds_read_b64_tr_b16 v[14:15], v85 offset:61440
    v_mfma_f32_16x16x32_bf16 v[136:139], v[20:23], a[48:51], v[136:139]
    v_and_b32 v247, 48, v242
    v_lshlrev_b32 v247, 6, v247
    v_mfma_f32_16x16x32_bf16 v[168:171], v[20:23], a[52:55], v[168:171]
    ds_read_b64_tr_b16 v[20:21], v86 offset:57344
    ds_read_b64_tr_b16 v[22:23], v86 offset:61440
    v_mfma_f32_16x16x32_bf16 v[140:143], v[28:31], a[48:51], v[140:143]
    s_add_u32 s53, s53, 131072
    buffer_load_dwordx4 a[108:111], v242, s[8:11], s53 offen sc1
    v_mfma_f32_16x16x32_bf16 v[172:175], v[28:31], a[52:55], v[172:175]
    s_waitcnt lgkmcnt(8)
    ds_read_b64_tr_b16 v[28:29], v87 offset:57344
    ds_read_b64_tr_b16 v[30:31], v87 offset:61440
    v_mfma_f32_16x16x32_bf16 v[144:147], v[36:39], a[48:51], v[144:147]
    s_xor_b32 s53, s55, 2048
    buffer_load_dwordx4 a[112:115], v242, s[8:11], s53 offen sc1
    v_mfma_f32_16x16x32_bf16 v[176:179], v[36:39], a[52:55], v[176:179]
    ds_read_b64_tr_b16 v[36:37], v92 offset:57344
    ds_read_b64_tr_b16 v[38:39], v92 offset:61440
    v_mfma_f32_16x16x32_bf16 v[148:151], v[44:47], a[48:51], v[148:151]
    v_mfma_f32_16x16x32_bf16 v[180:183], v[44:47], a[52:55], v[180:183]
    ds_read_b64_tr_b16 v[44:45], v93 offset:57344
    ds_read_b64_tr_b16 v[46:47], v93 offset:61440
    v_mfma_f32_16x16x32_bf16 v[152:155], v[52:55], a[48:51], v[152:155]
    s_add_u32 s53, s53, 131072
    buffer_load_dwordx4 a[116:119], v242, s[8:11], s53 offen sc1
    v_mfma_f32_16x16x32_bf16 v[184:187], v[52:55], a[52:55], v[184:187]
    s_waitcnt lgkmcnt(12)
    ds_read_b64_tr_b16 v[52:53], v94 offset:57344
    ds_read_b64_tr_b16 v[54:55], v94 offset:61440
    v_mfma_f32_16x16x32_bf16 v[156:159], v[60:63], a[48:51], v[156:159]
    v_mfma_f32_16x16x32_bf16 v[188:191], v[60:63], a[52:55], v[188:191]
    s_waitcnt vmcnt(14) lgkmcnt(6)
    s_barrier
    ds_read_b64_tr_b16 v[60:61], v95 offset:57344
    ds_read_b64_tr_b16 v[62:63], v95 offset:61440
    v_mfma_f32_16x16x32_bf16 v[128:131], v[4:7], a[56:59], v[128:131]
    s_add_u32 m0, s57, 131072
    s_add_u32 s54, s4, 4
    s_and_b32 s54, s54, 7
    s_lshl_b32 s54, s54, 17
    buffer_load_dwordx4 v250, s[28:31], s54 offen offset:0 lds
    v_mfma_f32_16x16x32_bf16 v[160:163], v[4:7], a[60:63], v[160:163]
    ds_read_b64_tr_b16 v[4:5], v68 offset:32768
    ds_read_b64_tr_b16 v[6:7], v68 offset:36864
    v_mfma_f32_16x16x32_bf16 v[132:135], v[12:15], a[56:59], v[132:135]
    v_mfma_f32_16x16x32_bf16 v[164:167], v[12:15], a[60:63], v[164:167]
    ds_read_b64_tr_b16 v[12:13], v69 offset:32768
    ds_read_b64_tr_b16 v[14:15], v69 offset:36864
    v_mfma_f32_16x16x32_bf16 v[136:139], v[20:23], a[56:59], v[136:139]
    buffer_load_dwordx4 v251, s[28:31], s54 offen offset:1024 lds
    v_mfma_f32_16x16x32_bf16 v[168:171], v[20:23], a[60:63], v[168:171]
    ds_read_b64_tr_b16 v[20:21], v70 offset:32768
    ds_read_b64_tr_b16 v[22:23], v70 offset:36864
    v_mfma_f32_16x16x32_bf16 v[140:143], v[28:31], a[56:59], v[140:143]
    buffer_load_dwordx4 v252, s[28:31], s54 offen offset:2048 lds
    v_mfma_f32_16x16x32_bf16 v[172:175], v[28:31], a[60:63], v[172:175]
    s_waitcnt lgkmcnt(8)
    ds_read_b64_tr_b16 v[28:29], v71 offset:32768
    ds_read_b64_tr_b16 v[30:31], v71 offset:36864
    v_mfma_f32_16x16x32_bf16 v[144:147], v[36:39], a[56:59], v[144:147]
    v_mfma_f32_16x16x32_bf16 v[176:179], v[36:39], a[60:63], v[176:179]
    ds_read_b64_tr_b16 v[36:37], v76 offset:32768
    ds_read_b64_tr_b16 v[38:39], v76 offset:36864
    v_mfma_f32_16x16x32_bf16 v[148:151], v[44:47], a[56:59], v[148:151]
    buffer_load_dwordx4 v253, s[28:31], s54 offen offset:3072 lds
    v_mfma_f32_16x16x32_bf16 v[180:183], v[44:47], a[60:63], v[180:183]
    ds_read_b64_tr_b16 v[44:45], v77 offset:32768
    ds_read_b64_tr_b16 v[46:47], v77 offset:36864
    v_mfma_f32_16x16x32_bf16 v[152:155], v[52:55], a[56:59], v[152:155]
    v_mfma_f32_16x16x32_bf16 v[184:187], v[52:55], a[60:63], v[184:187]
    s_waitcnt lgkmcnt(12)
    ds_read_b64_tr_b16 v[52:53], v78 offset:32768
    ds_read_b64_tr_b16 v[54:55], v78 offset:36864
    v_mfma_f32_16x16x32_bf16 v[156:159], v[60:63], a[56:59], v[156:159]
    s_add_u32 m0, s57, 147456
    s_add_u32 s54, s4, 4
    s_and_b32 s54, s54, 7
    s_lshl_b32 s54, s54, 17
    s_add_u32 s54, s54, 65536
    buffer_load_dwordx4 v250, s[28:31], s54 offen offset:0 lds
    v_mfma_f32_16x16x32_bf16 v[188:191], v[60:63], a[60:63], v[188:191]
    s_waitcnt vmcnt(17) lgkmcnt(6)
    ds_read_b64_tr_b16 v[60:61], v79 offset:32768
    ds_read_b64_tr_b16 v[62:63], v79 offset:36864
    v_mfma_f32_16x16x32_bf16 v[128:131], v[4:7], a[64:67], v[128:131]
    buffer_load_dwordx4 v251, s[28:31], s54 offen offset:1024 lds
    v_mfma_f32_16x16x32_bf16 v[160:163], v[4:7], a[68:71], v[160:163]
    ds_read_b64_tr_b16 v[4:5], v68 offset:40960
    ds_read_b64_tr_b16 v[6:7], v68 offset:45056
    v_mfma_f32_16x16x32_bf16 v[132:135], v[12:15], a[64:67], v[132:135]
    v_mfma_f32_16x16x32_bf16 v[164:167], v[12:15], a[68:71], v[164:167]
    ds_read_b64_tr_b16 v[12:13], v69 offset:40960
    ds_read_b64_tr_b16 v[14:15], v69 offset:45056
    v_mfma_f32_16x16x32_bf16 v[136:139], v[20:23], a[64:67], v[136:139]
    buffer_load_dwordx4 v252, s[28:31], s54 offen offset:2048 lds
    v_mfma_f32_16x16x32_bf16 v[168:171], v[20:23], a[68:71], v[168:171]
    ds_read_b64_tr_b16 v[20:21], v70 offset:40960
    ds_read_b64_tr_b16 v[22:23], v70 offset:45056
    v_mfma_f32_16x16x32_bf16 v[140:143], v[28:31], a[64:67], v[140:143]
    v_mfma_f32_16x16x32_bf16 v[172:175], v[28:31], a[68:71], v[172:175]
    s_waitcnt lgkmcnt(8)
    ds_read_b64_tr_b16 v[28:29], v71 offset:40960
    ds_read_b64_tr_b16 v[30:31], v71 offset:45056
    v_mfma_f32_16x16x32_bf16 v[144:147], v[36:39], a[64:67], v[144:147]
    buffer_load_dwordx4 v253, s[28:31], s54 offen offset:3072 lds
    v_mfma_f32_16x16x32_bf16 v[176:179], v[36:39], a[68:71], v[176:179]
    ds_read_b64_tr_b16 v[36:37], v76 offset:40960
    ds_read_b64_tr_b16 v[38:39], v76 offset:45056
    v_mfma_f32_16x16x32_bf16 v[148:151], v[44:47], a[64:67], v[148:151]
    s_xor_b32 s53, s55, 3072
    buffer_load_dwordx4 a[120:123], v242, s[8:11], s53 offen sc1
    v_mfma_f32_16x16x32_bf16 v[180:183], v[44:47], a[68:71], v[180:183]
    ds_read_b64_tr_b16 v[44:45], v77 offset:40960
    ds_read_b64_tr_b16 v[46:47], v77 offset:45056
    v_mfma_f32_16x16x32_bf16 v[152:155], v[52:55], a[64:67], v[152:155]
    v_mfma_f32_16x16x32_bf16 v[184:187], v[52:55], a[68:71], v[184:187]
    s_waitcnt lgkmcnt(12)
    ds_read_b64_tr_b16 v[52:53], v78 offset:40960
    ds_read_b64_tr_b16 v[54:55], v78 offset:45056
    v_mfma_f32_16x16x32_bf16 v[156:159], v[60:63], a[64:67], v[156:159]
    s_add_u32 s53, s53, 131072
    buffer_load_dwordx4 a[124:127], v242, s[8:11], s53 offen sc1
    v_mfma_f32_16x16x32_bf16 v[188:191], v[60:63], a[68:71], v[188:191]
    s_waitcnt vmcnt(20) lgkmcnt(6)
    ds_read_b64_tr_b16 v[60:61], v79 offset:40960
    ds_read_b64_tr_b16 v[62:63], v79 offset:45056
    v_mfma_f32_16x16x32_bf16 v[128:131], v[4:7], a[72:75], v[128:131]
    v_mfma_f32_16x16x32_bf16 v[160:163], v[4:7], a[76:79], v[160:163]
    ds_read_b64_tr_b16 v[4:5], v68 offset:49152
    ds_read_b64_tr_b16 v[6:7], v68 offset:53248
    v_mfma_f32_16x16x32_bf16 v[132:135], v[12:15], a[72:75], v[132:135]
    s_add_u32 s55, s4, 4
    s_and_b32 s55, s55, 7
    s_and_b32 s53, s55, 3
    s_lshl_b32 s55, s55, 2
    s_add_u32 s55, s55, s53
    s_lshl_b32 s55, s55, 10
    s_add_u32 s55, s55, s52
    s_xor_b32 s53, s55, 0
    buffer_load_dwordx4 a[152:155], v242, s[8:11], s53 offen sc1
    v_mfma_f32_16x16x32_bf16 v[164:167], v[12:15], a[76:79], v[164:167]
    ds_read_b64_tr_b16 v[12:13], v69 offset:49152
    ds_read_b64_tr_b16 v[14:15], v69 offset:53248
    v_mfma_f32_16x16x32_bf16 v[136:139], v[20:23], a[72:75], v[136:139]
    v_mfma_f32_16x16x32_bf16 v[168:171], v[20:23], a[76:79], v[168:171]
    ds_read_b64_tr_b16 v[20:21], v70 offset:49152
    ds_read_b64_tr_b16 v[22:23], v70 offset:53248
    v_mfma_f32_16x16x32_bf16 v[140:143], v[28:31], a[72:75], v[140:143]
    s_add_u32 s53, s53, 131072
    buffer_load_dwordx4 a[156:159], v242, s[8:11], s53 offen sc1
    v_mfma_f32_16x16x32_bf16 v[172:175], v[28:31], a[76:79], v[172:175]
    s_waitcnt lgkmcnt(8)
    ds_read_b64_tr_b16 v[28:29], v71 offset:49152
    ds_read_b64_tr_b16 v[30:31], v71 offset:53248
    v_mfma_f32_16x16x32_bf16 v[144:147], v[36:39], a[72:75], v[144:147]
    s_xor_b32 s53, s55, 1024
    buffer_load_dwordx4 a[160:163], v242, s[8:11], s53 offen sc1
    v_mfma_f32_16x16x32_bf16 v[176:179], v[36:39], a[76:79], v[176:179]
    ds_read_b64_tr_b16 v[36:37], v76 offset:49152
    ds_read_b64_tr_b16 v[38:39], v76 offset:53248
    v_mfma_f32_16x16x32_bf16 v[148:151], v[44:47], a[72:75], v[148:151]
    v_mfma_f32_16x16x32_bf16 v[180:183], v[44:47], a[76:79], v[180:183]
    ds_read_b64_tr_b16 v[44:45], v77 offset:49152
    ds_read_b64_tr_b16 v[46:47], v77 offset:53248
    v_mfma_f32_16x16x32_bf16 v[152:155], v[52:55], a[72:75], v[152:155]
    s_add_u32 s53, s53, 131072
    buffer_load_dwordx4 a[164:167], v242, s[8:11], s53 offen sc1
    v_mfma_f32_16x16x32_bf16 v[184:187], v[52:55], a[76:79], v[184:187]
    s_waitcnt lgkmcnt(12)
    ds_read_b64_tr_b16 v[52:53], v78 offset:49152
    ds_read_b64_tr_b16 v[54:55], v78 offset:53248
    v_mfma_f32_16x16x32_bf16 v[156:159], v[60:63], a[72:75], v[156:159]
    v_mfma_f32_16x16x32_bf16 v[188:191], v[60:63], a[76:79], v[188:191]
    s_waitcnt vmcnt(22) lgkmcnt(6)
    ds_read_b64_tr_b16 v[60:61], v79 offset:49152
    ds_read_b64_tr_b16 v[62:63], v79 offset:53248
    v_mfma_f32_16x16x32_bf16 v[128:131], v[4:7], a[80:83], v[128:131]
    s_xor_b32 s53, s55, 2048
    buffer_load_dwordx4 a[168:171], v242, s[8:11], s53 offen sc1
    v_mfma_f32_16x16x32_bf16 v[160:163], v[4:7], a[84:87], v[160:163]
    ds_read_b64_tr_b16 v[4:5], v68 offset:57344
    ds_read_b64_tr_b16 v[6:7], v68 offset:61440
    v_mfma_f32_16x16x32_bf16 v[132:135], v[12:15], a[80:83], v[132:135]
    s_add_u32 s53, s53, 131072
    buffer_load_dwordx4 a[172:175], v242, s[8:11], s53 offen sc1
    v_mfma_f32_16x16x32_bf16 v[164:167], v[12:15], a[84:87], v[164:167]
    ds_read_b64_tr_b16 v[12:13], v69 offset:57344
    ds_read_b64_tr_b16 v[14:15], v69 offset:61440
    v_mfma_f32_16x16x32_bf16 v[136:139], v[20:23], a[80:83], v[136:139]
    v_mfma_f32_16x16x32_bf16 v[168:171], v[20:23], a[84:87], v[168:171]
    ds_read_b64_tr_b16 v[20:21], v70 offset:57344
    ds_read_b64_tr_b16 v[22:23], v70 offset:61440
    v_mfma_f32_16x16x32_bf16 v[140:143], v[28:31], a[80:83], v[140:143]
    s_add_u32 m0, s57, 65536
    s_add_u32 s54, s4, 5
    s_and_b32 s54, s54, 7
    s_lshl_b32 s54, s54, 17
    buffer_load_dwordx4 v250, s[28:31], s54 offen offset:0 lds
    v_mfma_f32_16x16x32_bf16 v[172:175], v[28:31], a[84:87], v[172:175]
    s_waitcnt lgkmcnt(8)
    ds_read_b64_tr_b16 v[28:29], v71 offset:57344
    ds_read_b64_tr_b16 v[30:31], v71 offset:61440
    v_mfma_f32_16x16x32_bf16 v[144:147], v[36:39], a[80:83], v[144:147]
    v_mfma_f32_16x16x32_bf16 v[176:179], v[36:39], a[84:87], v[176:179]
    ds_read_b64_tr_b16 v[36:37], v76 offset:57344
    ds_read_b64_tr_b16 v[38:39], v76 offset:61440
    v_mfma_f32_16x16x32_bf16 v[148:151], v[44:47], a[80:83], v[148:151]
    buffer_load_dwordx4 v251, s[28:31], s54 offen offset:1024 lds
    v_mfma_f32_16x16x32_bf16 v[180:183], v[44:47], a[84:87], v[180:183]
    ds_read_b64_tr_b16 v[44:45], v77 offset:57344
    ds_read_b64_tr_b16 v[46:47], v77 offset:61440
    v_mfma_f32_16x16x32_bf16 v[152:155], v[52:55], a[80:83], v[152:155]
    buffer_load_dwordx4 v252, s[28:31], s54 offen offset:2048 lds
    v_mfma_f32_16x16x32_bf16 v[184:187], v[52:55], a[84:87], v[184:187]
    s_waitcnt lgkmcnt(12)
    ds_read_b64_tr_b16 v[52:53], v78 offset:57344
    ds_read_b64_tr_b16 v[54:55], v78 offset:61440
    v_mfma_f32_16x16x32_bf16 v[156:159], v[60:63], a[80:83], v[156:159]
    v_mfma_f32_16x16x32_bf16 v[188:191], v[60:63], a[84:87], v[188:191]
    s_waitcnt vmcnt(25) lgkmcnt(6)
    s_barrier
    ds_read_b64_tr_b16 v[60:61], v79 offset:57344
    ds_read_b64_tr_b16 v[62:63], v79 offset:61440
    v_mfma_f32_16x16x32_bf16 v[128:131], v[4:7], a[88:91], v[128:131]
    buffer_load_dwordx4 v253, s[28:31], s54 offen offset:3072 lds
    v_mfma_f32_16x16x32_bf16 v[160:163], v[4:7], a[92:95], v[160:163]
    ds_read_b64_tr_b16 v[4:5], v68 offset:0
    ds_read_b64_tr_b16 v[6:7], v68 offset:4096
    v_mfma_f32_16x16x32_bf16 v[132:135], v[12:15], a[88:91], v[132:135]
    v_mfma_f32_16x16x32_bf16 v[164:167], v[12:15], a[92:95], v[164:167]
    ds_read_b64_tr_b16 v[12:13], v69 offset:0
    ds_read_b64_tr_b16 v[14:15], v69 offset:4096
    v_mfma_f32_16x16x32_bf16 v[136:139], v[20:23], a[88:91], v[136:139]
    s_add_u32 m0, s57, 81920
    s_add_u32 s54, s4, 5
    s_and_b32 s54, s54, 7
    s_lshl_b32 s54, s54, 17
    s_add_u32 s54, s54, 65536
    buffer_load_dwordx4 v250, s[28:31], s54 offen offset:0 lds
    v_mfma_f32_16x16x32_bf16 v[168:171], v[20:23], a[92:95], v[168:171]
    ds_read_b64_tr_b16 v[20:21], v70 offset:0
    ds_read_b64_tr_b16 v[22:23], v70 offset:4096
    v_mfma_f32_16x16x32_bf16 v[140:143], v[28:31], a[88:91], v[140:143]
    v_mfma_f32_16x16x32_bf16 v[172:175], v[28:31], a[92:95], v[172:175]
    s_waitcnt lgkmcnt(8)
    ds_read_b64_tr_b16 v[28:29], v71 offset:0
    ds_read_b64_tr_b16 v[30:31], v71 offset:4096
    v_mfma_f32_16x16x32_bf16 v[144:147], v[36:39], a[88:91], v[144:147]
    buffer_load_dwordx4 v251, s[28:31], s54 offen offset:1024 lds
    v_mfma_f32_16x16x32_bf16 v[176:179], v[36:39], a[92:95], v[176:179]
    ds_read_b64_tr_b16 v[36:37], v76 offset:0
    ds_read_b64_tr_b16 v[38:39], v76 offset:4096
    v_mfma_f32_16x16x32_bf16 v[148:151], v[44:47], a[88:91], v[148:151]
    buffer_load_dwordx4 v252, s[28:31], s54 offen offset:2048 lds
    v_mfma_f32_16x16x32_bf16 v[180:183], v[44:47], a[92:95], v[180:183]
    ds_read_b64_tr_b16 v[44:45], v77 offset:0
    ds_read_b64_tr_b16 v[46:47], v77 offset:4096
    v_mfma_f32_16x16x32_bf16 v[152:155], v[52:55], a[88:91], v[152:155]
    v_mfma_f32_16x16x32_bf16 v[184:187], v[52:55], a[92:95], v[184:187]
    s_waitcnt lgkmcnt(12)
    v_mfma_f32_16x16x32_bf16 v[156:159], v[60:63], a[88:91], v[156:159]
    buffer_load_dwordx4 v253, s[28:31], s54 offen offset:3072 lds
    v_mfma_f32_16x16x32_bf16 v[188:191], v[60:63], a[92:95], v[188:191]
    s_waitcnt vmcnt(28) lgkmcnt(4)
    v_mfma_f32_16x16x32_bf16 v[128:131], v[4:7], a[96:99], v[128:131]
    v_mfma_f32_16x16x32_bf16 v[160:163], v[4:7], a[100:103], v[160:163]
    ds_read_b64_tr_b16 v[4:5], v68 offset:8192
    ds_read_b64_tr_b16 v[6:7], v68 offset:12288
    v_mfma_f32_16x16x32_bf16 v[132:135], v[12:15], a[96:99], v[132:135]
    s_xor_b32 s53, s55, 3072
    buffer_load_dwordx4 a[176:179], v242, s[8:11], s53 offen sc1
    v_mfma_f32_16x16x32_bf16 v[164:167], v[12:15], a[100:103], v[164:167]
    ds_read_b64_tr_b16 v[12:13], v69 offset:8192
    ds_read_b64_tr_b16 v[14:15], v69 offset:12288
    v_mfma_f32_16x16x32_bf16 v[136:139], v[20:23], a[96:99], v[136:139]
    s_add_u32 s53, s53, 131072
    buffer_load_dwordx4 a[180:183], v242, s[8:11], s53 offen sc1
    v_mfma_f32_16x16x32_bf16 v[168:171], v[20:23], a[100:103], v[168:171]
    ds_read_b64_tr_b16 v[20:21], v70 offset:8192
    ds_read_b64_tr_b16 v[22:23], v70 offset:12288
    v_mfma_f32_16x16x32_bf16 v[140:143], v[28:31], a[96:99], v[140:143]
    v_mfma_f32_16x16x32_bf16 v[172:175], v[28:31], a[100:103], v[172:175]
    s_waitcnt lgkmcnt(8)
    ds_read_b64_tr_b16 v[28:29], v71 offset:8192
    ds_read_b64_tr_b16 v[30:31], v71 offset:12288
    v_mfma_f32_16x16x32_bf16 v[144:147], v[36:39], a[96:99], v[144:147]
    s_add_u32 s55, s4, 5
    s_and_b32 s55, s55, 7
    s_and_b32 s53, s55, 3
    s_lshl_b32 s55, s55, 2
    s_add_u32 s55, s55, s53
    s_lshl_b32 s55, s55, 10
    s_add_u32 s55, s55, s52
    s_xor_b32 s53, s55, 0
    buffer_load_dwordx4 a[184:187], v242, s[8:11], s53 offen sc1
    v_mfma_f32_16x16x32_bf16 v[176:179], v[36:39], a[100:103], v[176:179]
    s_waitcnt lgkmcnt(8)
    ds_read_b64_tr_b16 v[36:37], v76 offset:8192
    ds_read_b64_tr_b16 v[38:39], v76 offset:12288
    v_mfma_f32_16x16x32_bf16 v[148:151], v[44:47], a[96:99], v[148:151]
    v_mfma_f32_16x16x32_bf16 v[180:183], v[44:47], a[100:103], v[180:183]
    s_waitcnt vmcnt(29) lgkmcnt(2)
    ds_read_b64_tr_b16 v[44:45], v77 offset:8192
    ds_read_b64_tr_b16 v[46:47], v77 offset:12288
    v_mfma_f32_16x16x32_bf16 v[128:131], v[4:7], a[104:107], v[128:131]
    s_add_u32 s53, s53, 131072
    buffer_load_dwordx4 a[188:191], v242, s[8:11], s53 offen sc1
    v_mfma_f32_16x16x32_bf16 v[160:163], v[4:7], a[108:111], v[160:163]
    ds_read_b64_tr_b16 v[4:5], v68 offset:16384
    ds_read_b64_tr_b16 v[6:7], v68 offset:20480
    v_mfma_f32_16x16x32_bf16 v[132:135], v[12:15], a[104:107], v[132:135]
    s_xor_b32 s53, s55, 1024
    buffer_load_dwordx4 a[192:195], v242, s[8:11], s53 offen sc1
    v_mfma_f32_16x16x32_bf16 v[164:167], v[12:15], a[108:111], v[164:167]
    ds_read_b64_tr_b16 v[12:13], v69 offset:16384
    ds_read_b64_tr_b16 v[14:15], v69 offset:20480
    v_mfma_f32_16x16x32_bf16 v[136:139], v[20:23], a[104:107], v[136:139]
    v_mfma_f32_16x16x32_bf16 v[168:171], v[20:23], a[108:111], v[168:171]
    ds_read_b64_tr_b16 v[20:21], v70 offset:16384
    ds_read_b64_tr_b16 v[22:23], v70 offset:20480
    v_mfma_f32_16x16x32_bf16 v[140:143], v[28:31], a[104:107], v[140:143]
    s_add_u32 s53, s53, 131072
    buffer_load_dwordx4 a[196:199], v242, s[8:11], s53 offen sc1
    v_mfma_f32_16x16x32_bf16 v[172:175], v[28:31], a[108:111], v[172:175]
    s_waitcnt lgkmcnt(8)
    ds_read_b64_tr_b16 v[28:29], v71 offset:16384
    ds_read_b64_tr_b16 v[30:31], v71 offset:20480
    v_mfma_f32_16x16x32_bf16 v[144:147], v[36:39], a[104:107], v[144:147]
    v_mfma_f32_16x16x32_bf16 v[176:179], v[36:39], a[108:111], v[176:179]
    s_waitcnt lgkmcnt(8)
    ds_read_b64_tr_b16 v[36:37], v76 offset:16384
    ds_read_b64_tr_b16 v[38:39], v76 offset:20480
    v_mfma_f32_16x16x32_bf16 v[148:151], v[44:47], a[104:107], v[148:151]
    s_xor_b32 s53, s55, 2048
    buffer_load_dwordx4 a[200:203], v242, s[8:11], s53 offen sc1
    v_mfma_f32_16x16x32_bf16 v[180:183], v[44:47], a[108:111], v[180:183]
    s_waitcnt vmcnt(31) lgkmcnt(2)
    ds_read_b64_tr_b16 v[44:45], v77 offset:16384
    ds_read_b64_tr_b16 v[46:47], v77 offset:20480
    v_mfma_f32_16x16x32_bf16 v[128:131], v[4:7], a[112:115], v[128:131]
    v_mfma_f32_16x16x32_bf16 v[160:163], v[4:7], a[116:119], v[160:163]
    ds_read_b64_tr_b16 v[4:5], v68 offset:24576
    ds_read_b64_tr_b16 v[6:7], v68 offset:28672
    v_mfma_f32_16x16x32_bf16 v[132:135], v[12:15], a[112:115], v[132:135]
    s_add_u32 s53, s53, 131072
    buffer_load_dwordx4 a[204:207], v242, s[8:11], s53 offen sc1
    v_mfma_f32_16x16x32_bf16 v[164:167], v[12:15], a[116:119], v[164:167]
    ds_read_b64_tr_b16 v[12:13], v69 offset:24576
    ds_read_b64_tr_b16 v[14:15], v69 offset:28672
    v_mfma_f32_16x16x32_bf16 v[136:139], v[20:23], a[112:115], v[136:139]
    s_add_u32 m0, s57, 98304
    s_add_u32 s54, s4, 6
    s_and_b32 s54, s54, 7
    s_lshl_b32 s54, s54, 17
    buffer_load_dwordx4 v250, s[28:31], s54 offen offset:0 lds
    v_mfma_f32_16x16x32_bf16 v[168:171], v[20:23], a[116:119], v[168:171]
    ds_read_b64_tr_b16 v[20:21], v70 offset:24576
    ds_read_b64_tr_b16 v[22:23], v70 offset:28672
    v_mfma_f32_16x16x32_bf16 v[140:143], v[28:31], a[112:115], v[140:143]
    v_mfma_f32_16x16x32_bf16 v[172:175], v[28:31], a[116:119], v[172:175]
    s_waitcnt lgkmcnt(8)
    ds_read_b64_tr_b16 v[28:29], v71 offset:24576
    ds_read_b64_tr_b16 v[30:31], v71 offset:28672
    v_mfma_f32_16x16x32_bf16 v[144:147], v[36:39], a[112:115], v[144:147]
    buffer_load_dwordx4 v251, s[28:31], s54 offen offset:1024 lds
    v_mfma_f32_16x16x32_bf16 v[176:179], v[36:39], a[116:119], v[176:179]
    s_waitcnt lgkmcnt(8)
    ds_read_b64_tr_b16 v[36:37], v76 offset:24576
    ds_read_b64_tr_b16 v[38:39], v76 offset:28672
    v_mfma_f32_16x16x32_bf16 v[148:151], v[44:47], a[112:115], v[148:151]
    v_mfma_f32_16x16x32_bf16 v[180:183], v[44:47], a[116:119], v[180:183]
    s_waitcnt vmcnt(24) lgkmcnt(2)
    s_barrier
    ds_read_b64_tr_b16 v[44:45], v77 offset:24576
    ds_read_b64_tr_b16 v[46:47], v77 offset:28672
    v_mfma_f32_16x16x32_bf16 v[128:131], v[4:7], a[120:123], v[128:131]
    buffer_load_dwordx4 v252, s[28:31], s54 offen offset:2048 lds
    v_mfma_f32_16x16x32_bf16 v[160:163], v[4:7], a[124:127], v[160:163]
    ds_read_b64_tr_b16 v[4:5], v100 offset:0
    ds_read_b64_tr_b16 v[6:7], v100 offset:4096
    v_mfma_f32_16x16x32_bf16 v[132:135], v[12:15], a[120:123], v[132:135]
    buffer_load_dwordx4 v253, s[28:31], s54 offen offset:3072 lds
    v_mfma_f32_16x16x32_bf16 v[164:167], v[12:15], a[124:127], v[164:167]
    ds_read_b64_tr_b16 v[12:13], v101 offset:0
    ds_read_b64_tr_b16 v[14:15], v101 offset:4096
    v_mfma_f32_16x16x32_bf16 v[136:139], v[20:23], a[120:123], v[136:139]
    v_mfma_f32_16x16x32_bf16 v[168:171], v[20:23], a[124:127], v[168:171]
    ds_read_b64_tr_b16 v[20:21], v102 offset:0
    ds_read_b64_tr_b16 v[22:23], v102 offset:4096
    v_mfma_f32_16x16x32_bf16 v[140:143], v[28:31], a[120:123], v[140:143]
    s_add_u32 m0, s57, 114688
    s_add_u32 s54, s4, 6
    s_and_b32 s54, s54, 7
    s_lshl_b32 s54, s54, 17
    s_add_u32 s54, s54, 65536
    buffer_load_dwordx4 v250, s[28:31], s54 offen offset:0 lds
    v_mfma_f32_16x16x32_bf16 v[172:175], v[28:31], a[124:127], v[172:175]
    s_waitcnt lgkmcnt(8)
    ds_read_b64_tr_b16 v[28:29], v103 offset:0
    ds_read_b64_tr_b16 v[30:31], v103 offset:4096
    v_mfma_f32_16x16x32_bf16 v[144:147], v[36:39], a[120:123], v[144:147]
    v_mfma_f32_16x16x32_bf16 v[176:179], v[36:39], a[124:127], v[176:179]
    s_waitcnt lgkmcnt(8)
    ds_read_b64_tr_b16 v[36:37], v108 offset:0
    ds_read_b64_tr_b16 v[38:39], v108 offset:4096
    v_mfma_f32_16x16x32_bf16 v[148:151], v[44:47], a[120:123], v[148:151]
    buffer_load_dwordx4 v251, s[28:31], s54 offen offset:1024 lds
    v_mfma_f32_16x16x32_bf16 v[180:183], v[44:47], a[124:127], v[180:183]
    s_waitcnt vmcnt(26) lgkmcnt(2)
    ds_read_b64_tr_b16 v[44:45], v109 offset:0
    ds_read_b64_tr_b16 v[46:47], v109 offset:4096
    v_mfma_f32_16x16x32_bf16 v[128:131], v[4:7], a[152:155], v[128:131]
    buffer_load_dwordx4 v252, s[28:31], s54 offen offset:2048 lds
    v_mfma_f32_16x16x32_bf16 v[160:163], v[4:7], a[156:159], v[160:163]
    ds_read_b64_tr_b16 v[4:5], v100 offset:8192
    ds_read_b64_tr_b16 v[6:7], v100 offset:12288
    v_mfma_f32_16x16x32_bf16 v[132:135], v[12:15], a[152:155], v[132:135]
    v_mfma_f32_16x16x32_bf16 v[164:167], v[12:15], a[156:159], v[164:167]
    ds_read_b64_tr_b16 v[12:13], v101 offset:8192
    ds_read_b64_tr_b16 v[14:15], v101 offset:12288
    v_mfma_f32_16x16x32_bf16 v[136:139], v[20:23], a[152:155], v[136:139]
    buffer_load_dwordx4 v253, s[28:31], s54 offen offset:3072 lds
    v_mfma_f32_16x16x32_bf16 v[168:171], v[20:23], a[156:159], v[168:171]
    ds_read_b64_tr_b16 v[20:21], v102 offset:8192
    ds_read_b64_tr_b16 v[22:23], v102 offset:12288
    v_mfma_f32_16x16x32_bf16 v[140:143], v[28:31], a[152:155], v[140:143]
    v_mfma_f32_16x16x32_bf16 v[172:175], v[28:31], a[156:159], v[172:175]
    s_waitcnt lgkmcnt(8)
    ds_read_b64_tr_b16 v[28:29], v103 offset:8192
    ds_read_b64_tr_b16 v[30:31], v103 offset:12288
    v_mfma_f32_16x16x32_bf16 v[144:147], v[36:39], a[152:155], v[144:147]
    s_xor_b32 s53, s55, 3072
    buffer_load_dwordx4 a[128:131], v242, s[8:11], s53 offen sc1
    v_mfma_f32_16x16x32_bf16 v[176:179], v[36:39], a[156:159], v[176:179]
    s_waitcnt lgkmcnt(8)
    ds_read_b64_tr_b16 v[36:37], v108 offset:8192
    ds_read_b64_tr_b16 v[38:39], v108 offset:12288
    v_mfma_f32_16x16x32_bf16 v[148:151], v[44:47], a[152:155], v[148:151]
    v_mfma_f32_16x16x32_bf16 v[180:183], v[44:47], a[156:159], v[180:183]
    s_waitcnt vmcnt(27) lgkmcnt(2)
    ds_read_b64_tr_b16 v[44:45], v109 offset:8192
    ds_read_b64_tr_b16 v[46:47], v109 offset:12288
    v_mfma_f32_16x16x32_bf16 v[128:131], v[4:7], a[160:163], v[128:131]
    s_add_u32 s53, s53, 131072
    buffer_load_dwordx4 a[132:135], v242, s[8:11], s53 offen sc1
    v_mfma_f32_16x16x32_bf16 v[160:163], v[4:7], a[164:167], v[160:163]
    ds_read_b64_tr_b16 v[4:5], v100 offset:16384
    ds_read_b64_tr_b16 v[6:7], v100 offset:20480
    v_mfma_f32_16x16x32_bf16 v[132:135], v[12:15], a[160:163], v[132:135]
    s_add_u32 s55, s4, 6
    s_and_b32 s55, s55, 7
    s_and_b32 s53, s55, 3
    s_lshl_b32 s55, s55, 2
    s_add_u32 s55, s55, s53
    s_lshl_b32 s55, s55, 10
    s_add_u32 s55, s55, s52
    s_xor_b32 s53, s55, 0
    buffer_load_dwordx4 a[136:139], v242, s[8:11], s53 offen sc1
    v_mfma_f32_16x16x32_bf16 v[164:167], v[12:15], a[164:167], v[164:167]
    ds_read_b64_tr_b16 v[12:13], v101 offset:16384
    ds_read_b64_tr_b16 v[14:15], v101 offset:20480
    v_mfma_f32_16x16x32_bf16 v[136:139], v[20:23], a[160:163], v[136:139]
    v_mfma_f32_16x16x32_bf16 v[168:171], v[20:23], a[164:167], v[168:171]
    ds_read_b64_tr_b16 v[20:21], v102 offset:16384
    ds_read_b64_tr_b16 v[22:23], v102 offset:20480
    v_mfma_f32_16x16x32_bf16 v[140:143], v[28:31], a[160:163], v[140:143]
    s_add_u32 s53, s53, 131072
    buffer_load_dwordx4 a[140:143], v242, s[8:11], s53 offen sc1
    v_mfma_f32_16x16x32_bf16 v[172:175], v[28:31], a[164:167], v[172:175]
    s_waitcnt lgkmcnt(8)
    ds_read_b64_tr_b16 v[28:29], v103 offset:16384
    ds_read_b64_tr_b16 v[30:31], v103 offset:20480
    v_mfma_f32_16x16x32_bf16 v[144:147], v[36:39], a[160:163], v[144:147]
    v_mfma_f32_16x16x32_bf16 v[176:179], v[36:39], a[164:167], v[176:179]
    s_waitcnt lgkmcnt(8)
    ds_read_b64_tr_b16 v[36:37], v108 offset:16384
    ds_read_b64_tr_b16 v[38:39], v108 offset:20480
    v_mfma_f32_16x16x32_bf16 v[148:151], v[44:47], a[160:163], v[148:151]
    s_xor_b32 s53, s55, 1024
    buffer_load_dwordx4 a[144:147], v242, s[8:11], s53 offen sc1
    v_mfma_f32_16x16x32_bf16 v[180:183], v[44:47], a[164:167], v[180:183]
    s_waitcnt vmcnt(29) lgkmcnt(2)
    ds_read_b64_tr_b16 v[44:45], v109 offset:16384
    ds_read_b64_tr_b16 v[46:47], v109 offset:20480
    v_mfma_f32_16x16x32_bf16 v[128:131], v[4:7], a[168:171], v[128:131]
    s_add_u32 s53, s53, 131072
    buffer_load_dwordx4 a[148:151], v242, s[8:11], s53 offen sc1
    v_mfma_f32_16x16x32_bf16 v[160:163], v[4:7], a[172:175], v[160:163]
    ds_read_b64_tr_b16 v[4:5], v100 offset:24576
    ds_read_b64_tr_b16 v[6:7], v100 offset:28672
    v_mfma_f32_16x16x32_bf16 v[132:135], v[12:15], a[168:171], v[132:135]
    v_mfma_f32_16x16x32_bf16 v[164:167], v[12:15], a[172:175], v[164:167]
    ds_read_b64_tr_b16 v[12:13], v101 offset:24576
    ds_read_b64_tr_b16 v[14:15], v101 offset:28672
    v_mfma_f32_16x16x32_bf16 v[136:139], v[20:23], a[168:171], v[136:139]
    s_xor_b32 s53, s55, 2048
    buffer_load_dwordx4 a[208:211], v242, s[8:11], s53 offen sc1
    v_mfma_f32_16x16x32_bf16 v[168:171], v[20:23], a[172:175], v[168:171]
    ds_read_b64_tr_b16 v[20:21], v102 offset:24576
    ds_read_b64_tr_b16 v[22:23], v102 offset:28672
    v_mfma_f32_16x16x32_bf16 v[140:143], v[28:31], a[168:171], v[140:143]
    v_mfma_f32_16x16x32_bf16 v[172:175], v[28:31], a[172:175], v[172:175]
    s_waitcnt lgkmcnt(8)
    ds_read_b64_tr_b16 v[28:29], v103 offset:24576
    ds_read_b64_tr_b16 v[30:31], v103 offset:28672
    v_mfma_f32_16x16x32_bf16 v[144:147], v[36:39], a[168:171], v[144:147]
    s_add_u32 s53, s53, 131072
    buffer_load_dwordx4 a[212:215], v242, s[8:11], s53 offen sc1
    v_mfma_f32_16x16x32_bf16 v[176:179], v[36:39], a[172:175], v[176:179]
    s_waitcnt lgkmcnt(8)
    ds_read_b64_tr_b16 v[36:37], v108 offset:24576
    ds_read_b64_tr_b16 v[38:39], v108 offset:28672
    v_mfma_f32_16x16x32_bf16 v[148:151], v[44:47], a[168:171], v[148:151]
    s_add_u32 m0, s57, 32768
    s_add_u32 s54, s4, 7
    s_and_b32 s54, s54, 7
    s_lshl_b32 s54, s54, 17
    buffer_load_dwordx4 v250, s[28:31], s54 offen offset:0 lds
    v_mfma_f32_16x16x32_bf16 v[180:183], v[44:47], a[172:175], v[180:183]
    s_waitcnt vmcnt(23) lgkmcnt(2)
    s_barrier
    ds_read_b64_tr_b16 v[44:45], v109 offset:24576
    ds_read_b64_tr_b16 v[46:47], v109 offset:28672
    v_mfma_f32_16x16x32_bf16 v[128:131], v[4:7], a[176:179], v[128:131]
    v_mfma_f32_16x16x32_bf16 v[160:163], v[4:7], a[180:183], v[160:163]
    ds_read_b64_tr_b16 v[4:5], v84 offset:0
    ds_read_b64_tr_b16 v[6:7], v84 offset:4096
    v_mfma_f32_16x16x32_bf16 v[132:135], v[12:15], a[176:179], v[132:135]
    buffer_load_dwordx4 v251, s[28:31], s54 offen offset:1024 lds
    v_mfma_f32_16x16x32_bf16 v[164:167], v[12:15], a[180:183], v[164:167]
    ds_read_b64_tr_b16 v[12:13], v85 offset:0
    ds_read_b64_tr_b16 v[14:15], v85 offset:4096
    v_mfma_f32_16x16x32_bf16 v[136:139], v[20:23], a[176:179], v[136:139]
    v_mfma_f32_16x16x32_bf16 v[168:171], v[20:23], a[180:183], v[168:171]
    ds_read_b64_tr_b16 v[20:21], v86 offset:0
    ds_read_b64_tr_b16 v[22:23], v86 offset:4096
    v_mfma_f32_16x16x32_bf16 v[140:143], v[28:31], a[176:179], v[140:143]
    buffer_load_dwordx4 v252, s[28:31], s54 offen offset:2048 lds
    v_mfma_f32_16x16x32_bf16 v[172:175], v[28:31], a[180:183], v[172:175]
    s_waitcnt lgkmcnt(8)
    ds_read_b64_tr_b16 v[28:29], v87 offset:0
    ds_read_b64_tr_b16 v[30:31], v87 offset:4096
    v_mfma_f32_16x16x32_bf16 v[144:147], v[36:39], a[176:179], v[144:147]
    v_mfma_f32_16x16x32_bf16 v[176:179], v[36:39], a[180:183], v[176:179]
    s_waitcnt lgkmcnt(8)
    ds_read_b64_tr_b16 v[36:37], v92 offset:0
    ds_read_b64_tr_b16 v[38:39], v92 offset:4096
    v_mfma_f32_16x16x32_bf16 v[148:151], v[44:47], a[176:179], v[148:151]
    buffer_load_dwordx4 v253, s[28:31], s54 offen offset:3072 lds
    v_mfma_f32_16x16x32_bf16 v[180:183], v[44:47], a[180:183], v[180:183]
    s_waitcnt vmcnt(24) lgkmcnt(2)
    ds_read_b64_tr_b16 v[44:45], v93 offset:0
    ds_read_b64_tr_b16 v[46:47], v93 offset:4096
    v_mfma_f32_16x16x32_bf16 v[128:131], v[4:7], a[184:187], v[128:131]
    s_add_u32 m0, s57, 49152
    s_add_u32 s54, s4, 7
    s_and_b32 s54, s54, 7
    s_lshl_b32 s54, s54, 17
    s_add_u32 s54, s54, 65536
    buffer_load_dwordx4 v250, s[28:31], s54 offen offset:0 lds
    v_mfma_f32_16x16x32_bf16 v[160:163], v[4:7], a[188:191], v[160:163]
    ds_read_b64_tr_b16 v[4:5], v84 offset:8192
    ds_read_b64_tr_b16 v[6:7], v84 offset:12288
    v_mfma_f32_16x16x32_bf16 v[132:135], v[12:15], a[184:187], v[132:135]
    v_mfma_f32_16x16x32_bf16 v[164:167], v[12:15], a[188:191], v[164:167]
    ds_read_b64_tr_b16 v[12:13], v85 offset:8192
    ds_read_b64_tr_b16 v[14:15], v85 offset:12288
    v_mfma_f32_16x16x32_bf16 v[136:139], v[20:23], a[184:187], v[136:139]
    buffer_load_dwordx4 v251, s[28:31], s54 offen offset:1024 lds
    v_mfma_f32_16x16x32_bf16 v[168:171], v[20:23], a[188:191], v[168:171]
    ds_read_b64_tr_b16 v[20:21], v86 offset:8192
    ds_read_b64_tr_b16 v[22:23], v86 offset:12288
    v_mfma_f32_16x16x32_bf16 v[140:143], v[28:31], a[184:187], v[140:143]
    v_mfma_f32_16x16x32_bf16 v[172:175], v[28:31], a[188:191], v[172:175]
    s_waitcnt lgkmcnt(8)
    ds_read_b64_tr_b16 v[28:29], v87 offset:8192
    ds_read_b64_tr_b16 v[30:31], v87 offset:12288
    v_mfma_f32_16x16x32_bf16 v[144:147], v[36:39], a[184:187], v[144:147]
    buffer_load_dwordx4 v252, s[28:31], s54 offen offset:2048 lds
    v_mfma_f32_16x16x32_bf16 v[176:179], v[36:39], a[188:191], v[176:179]
    s_waitcnt lgkmcnt(8)
    ds_read_b64_tr_b16 v[36:37], v92 offset:8192
    ds_read_b64_tr_b16 v[38:39], v92 offset:12288
    v_mfma_f32_16x16x32_bf16 v[148:151], v[44:47], a[184:187], v[148:151]
    buffer_load_dwordx4 v253, s[28:31], s54 offen offset:3072 lds
    v_mfma_f32_16x16x32_bf16 v[180:183], v[44:47], a[188:191], v[180:183]
    s_waitcnt vmcnt(26) lgkmcnt(2)
    ds_read_b64_tr_b16 v[44:45], v93 offset:8192
    ds_read_b64_tr_b16 v[46:47], v93 offset:12288
    v_mfma_f32_16x16x32_bf16 v[128:131], v[4:7], a[192:195], v[128:131]
    v_mfma_f32_16x16x32_bf16 v[160:163], v[4:7], a[196:199], v[160:163]
    ds_read_b64_tr_b16 v[4:5], v84 offset:16384
    ds_read_b64_tr_b16 v[6:7], v84 offset:20480
    v_mfma_f32_16x16x32_bf16 v[132:135], v[12:15], a[192:195], v[132:135]
    s_xor_b32 s53, s55, 3072
    buffer_load_dwordx4 a[216:219], v242, s[8:11], s53 offen sc1
    v_mfma_f32_16x16x32_bf16 v[164:167], v[12:15], a[196:199], v[164:167]
    ds_read_b64_tr_b16 v[12:13], v85 offset:16384
    ds_read_b64_tr_b16 v[14:15], v85 offset:20480
    v_mfma_f32_16x16x32_bf16 v[136:139], v[20:23], a[192:195], v[136:139]
    v_mfma_f32_16x16x32_bf16 v[168:171], v[20:23], a[196:199], v[168:171]
    ds_read_b64_tr_b16 v[20:21], v86 offset:16384
    ds_read_b64_tr_b16 v[22:23], v86 offset:20480
    v_mfma_f32_16x16x32_bf16 v[140:143], v[28:31], a[192:195], v[140:143]
    s_add_u32 s53, s53, 131072
    buffer_load_dwordx4 a[220:223], v242, s[8:11], s53 offen sc1
    v_mfma_f32_16x16x32_bf16 v[172:175], v[28:31], a[196:199], v[172:175]
    s_waitcnt lgkmcnt(8)
    ds_read_b64_tr_b16 v[28:29], v87 offset:16384
    ds_read_b64_tr_b16 v[30:31], v87 offset:20480
    v_mfma_f32_16x16x32_bf16 v[144:147], v[36:39], a[192:195], v[144:147]
    s_add_u32 s83, s79, 0
    buffer_load_dwordx2 v[64:65], v255, s[36:39], s83 offen offset:0
    v_mfma_f32_16x16x32_bf16 v[176:179], v[36:39], a[196:199], v[176:179]
    s_waitcnt lgkmcnt(8)
    ds_read_b64_tr_b16 v[36:37], v92 offset:16384
    ds_read_b64_tr_b16 v[38:39], v92 offset:20480
    v_mfma_f32_16x16x32_bf16 v[148:151], v[44:47], a[192:195], v[148:151]
    v_mfma_f32_16x16x32_bf16 v[180:183], v[44:47], a[196:199], v[180:183]
    s_waitcnt vmcnt(27) lgkmcnt(2)
    ds_read_b64_tr_b16 v[44:45], v93 offset:16384
    ds_read_b64_tr_b16 v[46:47], v93 offset:20480
    v_mfma_f32_16x16x32_bf16 v[128:131], v[4:7], a[200:203], v[128:131]
    buffer_load_dwordx2 v[66:67], v255, s[36:39], s83 offen offset:32
    v_mfma_f32_16x16x32_bf16 v[160:163], v[4:7], a[204:207], v[160:163]
    ds_read_b64_tr_b16 v[4:5], v84 offset:24576
    ds_read_b64_tr_b16 v[6:7], v84 offset:28672
    v_mfma_f32_16x16x32_bf16 v[132:135], v[12:15], a[200:203], v[132:135]
    v_mfma_f32_16x16x32_bf16 v[164:167], v[12:15], a[204:207], v[164:167]
    ds_read_b64_tr_b16 v[12:13], v85 offset:24576
    ds_read_b64_tr_b16 v[14:15], v85 offset:28672
    v_mfma_f32_16x16x32_bf16 v[136:139], v[20:23], a[200:203], v[136:139]
    s_add_u32 s83, s79, 16384
    buffer_load_dwordx2 v[72:73], v255, s[36:39], s83 offen offset:0
    v_mfma_f32_16x16x32_bf16 v[168:171], v[20:23], a[204:207], v[168:171]
    ds_read_b64_tr_b16 v[20:21], v86 offset:24576
    ds_read_b64_tr_b16 v[22:23], v86 offset:28672
    v_mfma_f32_16x16x32_bf16 v[140:143], v[28:31], a[200:203], v[140:143]
    buffer_load_dwordx2 v[74:75], v255, s[36:39], s83 offen offset:32
    v_mfma_f32_16x16x32_bf16 v[172:175], v[28:31], a[204:207], v[172:175]
    s_waitcnt lgkmcnt(8)
    ds_read_b64_tr_b16 v[28:29], v87 offset:24576
    ds_read_b64_tr_b16 v[30:31], v87 offset:28672
    v_mfma_f32_16x16x32_bf16 v[144:147], v[36:39], a[200:203], v[144:147]
    v_mfma_f32_16x16x32_bf16 v[176:179], v[36:39], a[204:207], v[176:179]
    s_waitcnt lgkmcnt(8)
    ds_read_b64_tr_b16 v[36:37], v92 offset:24576
    ds_read_b64_tr_b16 v[38:39], v92 offset:28672
    v_mfma_f32_16x16x32_bf16 v[148:151], v[44:47], a[200:203], v[148:151]
    s_add_u32 s55, s4, 7
    s_and_b32 s55, s55, 7
    s_and_b32 s53, s55, 3
    s_lshl_b32 s55, s55, 2
    s_add_u32 s55, s55, s53
    s_lshl_b32 s55, s55, 10
    s_add_u32 s55, s55, s52
    s_xor_b32 s53, s55, 0
    buffer_load_dwordx4 a[224:227], v242, s[8:11], s53 offen sc1
    v_mfma_f32_16x16x32_bf16 v[180:183], v[44:47], a[204:207], v[180:183]
    s_waitcnt vmcnt(21) lgkmcnt(2)
    s_barrier
    ds_read_b64_tr_b16 v[44:45], v93 offset:24576
    ds_read_b64_tr_b16 v[46:47], v93 offset:28672
    v_mfma_f32_16x16x32_bf16 v[128:131], v[4:7], a[128:131], v[128:131]
    v_mfma_f32_16x16x32_bf16 v[160:163], v[4:7], a[132:135], v[160:163]
    ds_read_b64_tr_b16 v[4:5], v84 offset:32768
    ds_read_b64_tr_b16 v[6:7], v84 offset:36864
    v_mfma_f32_16x16x32_bf16 v[132:135], v[12:15], a[128:131], v[132:135]
    s_add_u32 s53, s53, 131072
    buffer_load_dwordx4 a[228:231], v242, s[8:11], s53 offen sc1
    v_mfma_f32_16x16x32_bf16 v[164:167], v[12:15], a[132:135], v[164:167]
    ds_read_b64_tr_b16 v[12:13], v85 offset:32768
    ds_read_b64_tr_b16 v[14:15], v85 offset:36864
    v_mfma_f32_16x16x32_bf16 v[136:139], v[20:23], a[128:131], v[136:139]
    v_mfma_f32_16x16x32_bf16 v[168:171], v[20:23], a[132:135], v[168:171]
    ds_read_b64_tr_b16 v[20:21], v86 offset:32768
    ds_read_b64_tr_b16 v[22:23], v86 offset:36864
    v_mfma_f32_16x16x32_bf16 v[140:143], v[28:31], a[128:131], v[140:143]
    s_xor_b32 s53, s55, 1024
    buffer_load_dwordx4 a[232:235], v242, s[8:11], s53 offen sc1
    v_mfma_f32_16x16x32_bf16 v[172:175], v[28:31], a[132:135], v[172:175]
    s_waitcnt lgkmcnt(8)
    ds_read_b64_tr_b16 v[28:29], v87 offset:32768
    ds_read_b64_tr_b16 v[30:31], v87 offset:36864
    v_mfma_f32_16x16x32_bf16 v[144:147], v[36:39], a[128:131], v[144:147]
    s_add_u32 s53, s53, 131072
    buffer_load_dwordx4 a[236:239], v242, s[8:11], s53 offen sc1
    v_mfma_f32_16x16x32_bf16 v[176:179], v[36:39], a[132:135], v[176:179]
    s_waitcnt lgkmcnt(8)
    ds_read_b64_tr_b16 v[36:37], v92 offset:32768
    ds_read_b64_tr_b16 v[38:39], v92 offset:36864
    v_mfma_f32_16x16x32_bf16 v[148:151], v[44:47], a[128:131], v[148:151]
    v_mfma_f32_16x16x32_bf16 v[180:183], v[44:47], a[132:135], v[180:183]
    s_waitcnt vmcnt(22) lgkmcnt(2)
    ds_read_b64_tr_b16 v[44:45], v93 offset:32768
    ds_read_b64_tr_b16 v[46:47], v93 offset:36864
    v_mfma_f32_16x16x32_bf16 v[128:131], v[4:7], a[136:139], v[128:131]
    s_xor_b32 s53, s55, 2048
    buffer_load_dwordx4 a[240:243], v242, s[8:11], s53 offen sc1
    v_mfma_f32_16x16x32_bf16 v[160:163], v[4:7], a[140:143], v[160:163]
    ds_read_b64_tr_b16 v[4:5], v84 offset:40960
    ds_read_b64_tr_b16 v[6:7], v84 offset:45056
    v_mfma_f32_16x16x32_bf16 v[132:135], v[12:15], a[136:139], v[132:135]
    v_mfma_f32_16x16x32_bf16 v[164:167], v[12:15], a[140:143], v[164:167]
    ds_read_b64_tr_b16 v[12:13], v85 offset:40960
    ds_read_b64_tr_b16 v[14:15], v85 offset:45056
    v_mfma_f32_16x16x32_bf16 v[136:139], v[20:23], a[136:139], v[136:139]
    s_add_u32 s53, s53, 131072
    buffer_load_dwordx4 a[244:247], v242, s[8:11], s53 offen sc1
    v_mfma_f32_16x16x32_bf16 v[168:171], v[20:23], a[140:143], v[168:171]
    ds_read_b64_tr_b16 v[20:21], v86 offset:40960
    ds_read_b64_tr_b16 v[22:23], v86 offset:45056
    v_mfma_f32_16x16x32_bf16 v[140:143], v[28:31], a[136:139], v[140:143]
    s_xor_b32 s53, s55, 3072
    buffer_load_dwordx4 a[248:251], v242, s[8:11], s53 offen sc1
    v_mfma_f32_16x16x32_bf16 v[172:175], v[28:31], a[140:143], v[172:175]
    s_waitcnt lgkmcnt(8)
    ds_read_b64_tr_b16 v[28:29], v87 offset:40960
    ds_read_b64_tr_b16 v[30:31], v87 offset:45056
    v_mfma_f32_16x16x32_bf16 v[144:147], v[36:39], a[136:139], v[144:147]
    v_mfma_f32_16x16x32_bf16 v[176:179], v[36:39], a[140:143], v[176:179]
    s_waitcnt lgkmcnt(8)
    ds_read_b64_tr_b16 v[36:37], v92 offset:40960
    ds_read_b64_tr_b16 v[38:39], v92 offset:45056
    v_mfma_f32_16x16x32_bf16 v[148:151], v[44:47], a[136:139], v[148:151]
    s_add_u32 s53, s53, 131072
    buffer_load_dwordx4 a[252:255], v242, s[8:11], s53 offen sc1
    v_mfma_f32_16x16x32_bf16 v[180:183], v[44:47], a[140:143], v[180:183]
    s_waitcnt vmcnt(24) lgkmcnt(2)
    ds_read_b64_tr_b16 v[44:45], v93 offset:40960
    ds_read_b64_tr_b16 v[46:47], v93 offset:45056
    v_mfma_f32_16x16x32_bf16 v[128:131], v[4:7], a[144:147], v[128:131]
    v_mfma_f32_16x16x32_bf16 v[160:163], v[4:7], a[148:151], v[160:163]
    ds_read_b64_tr_b16 v[4:5], v84 offset:49152
    ds_read_b64_tr_b16 v[6:7], v84 offset:53248
    v_mfma_f32_16x16x32_bf16 v[132:135], v[12:15], a[144:147], v[132:135]
    v_mfma_f32_16x16x32_bf16 v[164:167], v[12:15], a[148:151], v[164:167]
    ds_read_b64_tr_b16 v[12:13], v85 offset:49152
    ds_read_b64_tr_b16 v[14:15], v85 offset:53248
    v_mfma_f32_16x16x32_bf16 v[136:139], v[20:23], a[144:147], v[136:139]
    v_mfma_f32_16x16x32_bf16 v[168:171], v[20:23], a[148:151], v[168:171]
    ds_read_b64_tr_b16 v[20:21], v86 offset:49152
    ds_read_b64_tr_b16 v[22:23], v86 offset:53248
    v_mfma_f32_16x16x32_bf16 v[140:143], v[28:31], a[144:147], v[140:143]
    v_mfma_f32_16x16x32_bf16 v[172:175], v[28:31], a[148:151], v[172:175]
    s_waitcnt lgkmcnt(8)
    ds_read_b64_tr_b16 v[28:29], v87 offset:49152
    ds_read_b64_tr_b16 v[30:31], v87 offset:53248
    v_mfma_f32_16x16x32_bf16 v[144:147], v[36:39], a[144:147], v[144:147]
    v_mfma_f32_16x16x32_bf16 v[176:179], v[36:39], a[148:151], v[176:179]
    s_waitcnt lgkmcnt(8)
    ds_read_b64_tr_b16 v[36:37], v92 offset:49152
    ds_read_b64_tr_b16 v[38:39], v92 offset:53248
    v_mfma_f32_16x16x32_bf16 v[148:151], v[44:47], a[144:147], v[148:151]
    v_mfma_f32_16x16x32_bf16 v[180:183], v[44:47], a[148:151], v[180:183]
    s_waitcnt vmcnt(22) lgkmcnt(2)
    ds_read_b64_tr_b16 v[44:45], v93 offset:49152
    ds_read_b64_tr_b16 v[46:47], v93 offset:53248
    v_mfma_f32_16x16x32_bf16 v[128:131], v[4:7], a[208:211], v[128:131]
    v_mfma_f32_16x16x32_bf16 v[160:163], v[4:7], a[212:215], v[160:163]
    ds_read_b64_tr_b16 v[4:5], v84 offset:57344
    ds_read_b64_tr_b16 v[6:7], v84 offset:61440
    v_mfma_f32_16x16x32_bf16 v[132:135], v[12:15], a[208:211], v[132:135]
    v_mfma_f32_16x16x32_bf16 v[164:167], v[12:15], a[212:215], v[164:167]
    ds_read_b64_tr_b16 v[12:13], v85 offset:57344
    ds_read_b64_tr_b16 v[14:15], v85 offset:61440
    v_mfma_f32_16x16x32_bf16 v[136:139], v[20:23], a[208:211], v[136:139]
    v_mfma_f32_16x16x32_bf16 v[168:171], v[20:23], a[212:215], v[168:171]
    ds_read_b64_tr_b16 v[20:21], v86 offset:57344
    ds_read_b64_tr_b16 v[22:23], v86 offset:61440
    v_mfma_f32_16x16x32_bf16 v[140:143], v[28:31], a[208:211], v[140:143]
    v_mfma_f32_16x16x32_bf16 v[172:175], v[28:31], a[212:215], v[172:175]
    s_waitcnt lgkmcnt(8)
    ds_read_b64_tr_b16 v[28:29], v87 offset:57344
    ds_read_b64_tr_b16 v[30:31], v87 offset:61440
    v_mfma_f32_16x16x32_bf16 v[144:147], v[36:39], a[208:211], v[144:147]
    v_mfma_f32_16x16x32_bf16 v[176:179], v[36:39], a[212:215], v[176:179]
    s_waitcnt lgkmcnt(8)
    ds_read_b64_tr_b16 v[36:37], v92 offset:57344
    ds_read_b64_tr_b16 v[38:39], v92 offset:61440
    v_mfma_f32_16x16x32_bf16 v[148:151], v[44:47], a[208:211], v[148:151]
    v_mfma_f32_16x16x32_bf16 v[180:183], v[44:47], a[212:215], v[180:183]
    s_waitcnt vmcnt(12) lgkmcnt(2)
    s_barrier
    ds_read_b64_tr_b16 v[44:45], v93 offset:57344
    ds_read_b64_tr_b16 v[46:47], v93 offset:61440
    v_mfma_f32_16x16x32_bf16 v[128:131], v[4:7], a[216:219], v[128:131]
    v_mfma_f32_16x16x32_bf16 v[160:163], v[4:7], a[220:223], v[160:163]
    ds_read_b64_tr_b16 v[4:5], v68 offset:32768
    ds_read_b64_tr_b16 v[6:7], v68 offset:36864
    v_mfma_f32_16x16x32_bf16 v[132:135], v[12:15], a[216:219], v[132:135]
    v_mfma_f32_16x16x32_bf16 v[164:167], v[12:15], a[220:223], v[164:167]
    ds_read_b64_tr_b16 v[12:13], v69 offset:32768
    ds_read_b64_tr_b16 v[14:15], v69 offset:36864
    v_mfma_f32_16x16x32_bf16 v[136:139], v[20:23], a[216:219], v[136:139]
    v_mfma_f32_16x16x32_bf16 v[168:171], v[20:23], a[220:223], v[168:171]
    ds_read_b64_tr_b16 v[20:21], v70 offset:32768
    ds_read_b64_tr_b16 v[22:23], v70 offset:36864
    v_mfma_f32_16x16x32_bf16 v[140:143], v[28:31], a[216:219], v[140:143]
    v_mfma_f32_16x16x32_bf16 v[172:175], v[28:31], a[220:223], v[172:175]
    s_waitcnt lgkmcnt(8)
    ds_read_b64_tr_b16 v[28:29], v71 offset:32768
    ds_read_b64_tr_b16 v[30:31], v71 offset:36864
    v_mfma_f32_16x16x32_bf16 v[144:147], v[36:39], a[216:219], v[144:147]
    v_mfma_f32_16x16x32_bf16 v[176:179], v[36:39], a[220:223], v[176:179]
    s_waitcnt lgkmcnt(8)
    ds_read_b64_tr_b16 v[36:37], v76 offset:32768
    ds_read_b64_tr_b16 v[38:39], v76 offset:36864
    v_mfma_f32_16x16x32_bf16 v[148:151], v[44:47], a[216:219], v[148:151]
    v_mfma_f32_16x16x32_bf16 v[180:183], v[44:47], a[220:223], v[180:183]
    s_waitcnt vmcnt(6) lgkmcnt(2)
    ds_read_b64_tr_b16 v[44:45], v77 offset:32768
    ds_read_b64_tr_b16 v[46:47], v77 offset:36864
    v_mfma_f32_16x16x32_bf16 v[128:131], v[4:7], a[224:227], v[128:131]
    v_mfma_f32_16x16x32_bf16 v[160:163], v[4:7], a[228:231], v[160:163]
    ds_read_b64_tr_b16 v[4:5], v68 offset:40960
    ds_read_b64_tr_b16 v[6:7], v68 offset:45056
    v_mfma_f32_16x16x32_bf16 v[132:135], v[12:15], a[224:227], v[132:135]
    v_mfma_f32_16x16x32_bf16 v[164:167], v[12:15], a[228:231], v[164:167]
    ds_read_b64_tr_b16 v[12:13], v69 offset:40960
    ds_read_b64_tr_b16 v[14:15], v69 offset:45056
    v_mfma_f32_16x16x32_bf16 v[136:139], v[20:23], a[224:227], v[136:139]
    v_mfma_f32_16x16x32_bf16 v[168:171], v[20:23], a[228:231], v[168:171]
    ds_read_b64_tr_b16 v[20:21], v70 offset:40960
    ds_read_b64_tr_b16 v[22:23], v70 offset:45056
    v_mfma_f32_16x16x32_bf16 v[140:143], v[28:31], a[224:227], v[140:143]
    v_mfma_f32_16x16x32_bf16 v[172:175], v[28:31], a[228:231], v[172:175]
    s_waitcnt lgkmcnt(8)
    ds_read_b64_tr_b16 v[28:29], v71 offset:40960
    ds_read_b64_tr_b16 v[30:31], v71 offset:45056
    v_mfma_f32_16x16x32_bf16 v[144:147], v[36:39], a[224:227], v[144:147]
    v_mfma_f32_16x16x32_bf16 v[176:179], v[36:39], a[228:231], v[176:179]
    s_waitcnt lgkmcnt(8)
    ds_read_b64_tr_b16 v[36:37], v76 offset:40960
    ds_read_b64_tr_b16 v[38:39], v76 offset:45056
    v_mfma_f32_16x16x32_bf16 v[148:151], v[44:47], a[224:227], v[148:151]
    v_mfma_f32_16x16x32_bf16 v[180:183], v[44:47], a[228:231], v[180:183]
    s_waitcnt vmcnt(4) lgkmcnt(2)
    ds_read_b64_tr_b16 v[44:45], v77 offset:40960
    ds_read_b64_tr_b16 v[46:47], v77 offset:45056
    v_mfma_f32_16x16x32_bf16 v[128:131], v[4:7], a[232:235], v[128:131]
    v_mfma_f32_16x16x32_bf16 v[160:163], v[4:7], a[236:239], v[160:163]
    ds_read_b64_tr_b16 v[4:5], v68 offset:49152
    ds_read_b64_tr_b16 v[6:7], v68 offset:53248
    v_mfma_f32_16x16x32_bf16 v[132:135], v[12:15], a[232:235], v[132:135]
    v_mfma_f32_16x16x32_bf16 v[164:167], v[12:15], a[236:239], v[164:167]
    ds_read_b64_tr_b16 v[12:13], v69 offset:49152
    ds_read_b64_tr_b16 v[14:15], v69 offset:53248
    v_mfma_f32_16x16x32_bf16 v[136:139], v[20:23], a[232:235], v[136:139]
    v_mfma_f32_16x16x32_bf16 v[168:171], v[20:23], a[236:239], v[168:171]
    ds_read_b64_tr_b16 v[20:21], v70 offset:49152
    ds_read_b64_tr_b16 v[22:23], v70 offset:53248
    v_mfma_f32_16x16x32_bf16 v[140:143], v[28:31], a[232:235], v[140:143]
    v_mfma_f32_16x16x32_bf16 v[172:175], v[28:31], a[236:239], v[172:175]
    s_waitcnt lgkmcnt(8)
    ds_read_b64_tr_b16 v[28:29], v71 offset:49152
    ds_read_b64_tr_b16 v[30:31], v71 offset:53248
    v_mfma_f32_16x16x32_bf16 v[144:147], v[36:39], a[232:235], v[144:147]
    v_mfma_f32_16x16x32_bf16 v[176:179], v[36:39], a[236:239], v[176:179]
    s_waitcnt lgkmcnt(8)
    ds_read_b64_tr_b16 v[36:37], v76 offset:49152
    ds_read_b64_tr_b16 v[38:39], v76 offset:53248
    v_mfma_f32_16x16x32_bf16 v[148:151], v[44:47], a[232:235], v[148:151]
    v_mfma_f32_16x16x32_bf16 v[180:183], v[44:47], a[236:239], v[180:183]
    s_waitcnt vmcnt(2) lgkmcnt(2)
    ds_read_b64_tr_b16 v[44:45], v77 offset:49152
    ds_read_b64_tr_b16 v[46:47], v77 offset:53248
    v_mfma_f32_16x16x32_bf16 v[128:131], v[4:7], a[240:243], v[128:131]
    v_mfma_f32_16x16x32_bf16 v[160:163], v[4:7], a[244:247], v[160:163]
    ds_read_b64_tr_b16 v[4:5], v68 offset:57344
    ds_read_b64_tr_b16 v[6:7], v68 offset:61440
    v_mfma_f32_16x16x32_bf16 v[132:135], v[12:15], a[240:243], v[132:135]
    v_mfma_f32_16x16x32_bf16 v[164:167], v[12:15], a[244:247], v[164:167]
    ds_read_b64_tr_b16 v[12:13], v69 offset:57344
    ds_read_b64_tr_b16 v[14:15], v69 offset:61440
    v_mfma_f32_16x16x32_bf16 v[136:139], v[20:23], a[240:243], v[136:139]
    v_mfma_f32_16x16x32_bf16 v[168:171], v[20:23], a[244:247], v[168:171]
    ds_read_b64_tr_b16 v[20:21], v70 offset:57344
    ds_read_b64_tr_b16 v[22:23], v70 offset:61440
    v_mfma_f32_16x16x32_bf16 v[140:143], v[28:31], a[240:243], v[140:143]
    v_mfma_f32_16x16x32_bf16 v[172:175], v[28:31], a[244:247], v[172:175]
    s_waitcnt lgkmcnt(8)
    ds_read_b64_tr_b16 v[28:29], v71 offset:57344
    ds_read_b64_tr_b16 v[30:31], v71 offset:61440
    v_mfma_f32_16x16x32_bf16 v[144:147], v[36:39], a[240:243], v[144:147]
    v_mfma_f32_16x16x32_bf16 v[176:179], v[36:39], a[244:247], v[176:179]
    s_waitcnt lgkmcnt(8)
    ds_read_b64_tr_b16 v[36:37], v76 offset:57344
    ds_read_b64_tr_b16 v[38:39], v76 offset:61440
    v_mfma_f32_16x16x32_bf16 v[148:151], v[44:47], a[240:243], v[148:151]
    v_mfma_f32_16x16x32_bf16 v[180:183], v[44:47], a[244:247], v[180:183]
    s_waitcnt vmcnt(0) lgkmcnt(2)
    ds_read_b64_tr_b16 v[44:45], v77 offset:57344
    ds_read_b64_tr_b16 v[46:47], v77 offset:61440
    v_mfma_f32_16x16x32_bf16 v[128:131], v[4:7], a[248:251], v[128:131]
    v_mfma_f32_16x16x32_bf16 v[160:163], v[4:7], a[252:255], v[160:163]
    v_mfma_f32_16x16x32_bf16 v[132:135], v[12:15], a[248:251], v[132:135]
    v_mfma_f32_16x16x32_bf16 v[164:167], v[12:15], a[252:255], v[164:167]
    ds_read_b64_tr_b16 v[52:53], v78 offset:0
    ds_read_b64_tr_b16 v[54:55], v78 offset:4096
    v_mfma_f32_16x16x32_bf16 v[136:139], v[20:23], a[248:251], v[136:139]
    v_mfma_f32_16x16x32_bf16 v[168:171], v[20:23], a[252:255], v[168:171]
    ds_read_b64_tr_b16 v[60:61], v79 offset:0
    ds_read_b64_tr_b16 v[62:63], v79 offset:4096
    v_mfma_f32_16x16x32_bf16 v[140:143], v[28:31], a[248:251], v[140:143]
    v_mfma_f32_16x16x32_bf16 v[172:175], v[28:31], a[252:255], v[172:175]
    s_waitcnt lgkmcnt(6)
    ds_read_b64_tr_b16 v[208:209], v78 offset:8192
    ds_read_b64_tr_b16 v[210:211], v78 offset:12288
    v_mfma_f32_16x16x32_bf16 v[144:147], v[36:39], a[248:251], v[144:147]
    v_mfma_f32_16x16x32_bf16 v[176:179], v[36:39], a[252:255], v[176:179]
    s_waitcnt lgkmcnt(6)
    ds_read_b64_tr_b16 v[212:213], v79 offset:8192
    ds_read_b64_tr_b16 v[214:215], v79 offset:12288
    v_mfma_f32_16x16x32_bf16 v[148:151], v[44:47], a[248:251], v[148:151]
    v_mfma_f32_16x16x32_bf16 v[180:183], v[44:47], a[252:255], v[180:183]
    s_waitcnt lgkmcnt(4)
    v_mfma_f32_16x16x32_bf16 v[152:155], v[52:55], a[96:99], v[152:155]
    ds_read_b64_tr_b16 v[0:1], v78 offset:16384
    ds_read_b64_tr_b16 v[2:3], v78 offset:20480
    v_mfma_f32_16x16x32_bf16 v[184:187], v[52:55], a[100:103], v[184:187]
    v_mfma_f32_16x16x32_bf16 v[156:159], v[60:63], a[96:99], v[156:159]
    ds_read_b64_tr_b16 v[8:9], v79 offset:16384
    ds_read_b64_tr_b16 v[10:11], v79 offset:20480
    v_mfma_f32_16x16x32_bf16 v[188:191], v[60:63], a[100:103], v[188:191]
    s_waitcnt lgkmcnt(4)
    s_add_u32 s59, s75, 1
    s_and_b32 s59, s59, 3
    s_lshl_b32 s59, s59, 2
    s_add_u32 s59, s59, s75
    v_mfma_f32_16x16x32_bf16 v[152:155], v[208:211], a[104:107], v[152:155]
    ds_read_b64_tr_b16 v[52:53], v78 offset:24576
    ds_read_b64_tr_b16 v[54:55], v78 offset:28672
    s_lshl_b32 s59, s59, 13
    s_add_u32 s63, s56, s59
    v_cvt_pk_bf16_f32 v16, v128, v129
    v_mfma_f32_16x16x32_bf16 v[184:187], v[208:211], a[108:111], v[184:187]
    v_cvt_pk_bf16_f32 v17, v130, v131
    v_cvt_pk_bf16_f32 v18, v132, v133
    v_cvt_pk_bf16_f32 v19, v134, v135
    v_mfma_f32_16x16x32_bf16 v[156:159], v[212:215], a[104:107], v[156:159]
    ds_read_b64_tr_b16 v[60:61], v79 offset:24576
    ds_read_b64_tr_b16 v[62:63], v79 offset:28672
    buffer_store_dwordx4 v[16:19], v242, s[8:11], s63 offen offset:0 sc1
    v_cvt_pk_bf16_f32 v24, v160, v161
    v_mfma_f32_16x16x32_bf16 v[188:191], v[212:215], a[108:111], v[188:191]
    s_waitcnt lgkmcnt(4)
    v_cvt_pk_bf16_f32 v25, v162, v163
    v_cvt_pk_bf16_f32 v26, v164, v165
    v_cvt_pk_bf16_f32 v27, v166, v167
    v_mfma_f32_16x16x32_bf16 v[152:155], v[0:3], a[112:115], v[152:155]
    ds_read_b64_tr_b16 v[208:209], v110 offset:0
    ds_read_b64_tr_b16 v[210:211], v110 offset:4096
    buffer_store_dwordx4 v[24:27], v242, s[8:11], s63 offen offset:1024 sc1
    s_add_u32 s59, s75, 2
    v_mfma_f32_16x16x32_bf16 v[184:187], v[0:3], a[116:119], v[184:187]
    s_and_b32 s59, s59, 3
    s_lshl_b32 s59, s59, 2
    s_add_u32 s59, s59, s75
    s_lshl_b32 s59, s59, 13
    s_add_u32 s63, s56, s59
    v_mfma_f32_16x16x32_bf16 v[156:159], v[8:11], a[112:115], v[156:159]
    ds_read_b64_tr_b16 v[212:213], v111 offset:0
    ds_read_b64_tr_b16 v[214:215], v111 offset:4096
    v_cvt_pk_bf16_f32 v32, v136, v137
    v_cvt_pk_bf16_f32 v33, v138, v139
    v_cvt_pk_bf16_f32 v34, v140, v141
    v_mfma_f32_16x16x32_bf16 v[188:191], v[8:11], a[116:119], v[188:191]
    s_waitcnt lgkmcnt(4)
    v_cvt_pk_bf16_f32 v35, v142, v143
    v_mfma_f32_16x16x32_bf16 v[152:155], v[52:55], a[120:123], v[152:155]
    ds_read_b64_tr_b16 v[0:1], v110 offset:8192
    ds_read_b64_tr_b16 v[2:3], v110 offset:12288
    buffer_store_dwordx4 v[32:35], v242, s[8:11], s63 offen offset:0 sc1
    v_cvt_pk_bf16_f32 v40, v168, v169
    v_mfma_f32_16x16x32_bf16 v[184:187], v[52:55], a[124:127], v[184:187]
    v_cvt_pk_bf16_f32 v41, v170, v171
    v_cvt_pk_bf16_f32 v42, v172, v173
    v_cvt_pk_bf16_f32 v43, v174, v175
    v_mfma_f32_16x16x32_bf16 v[156:159], v[60:63], a[120:123], v[156:159]
    ds_read_b64_tr_b16 v[8:9], v111 offset:8192
    ds_read_b64_tr_b16 v[10:11], v111 offset:12288
    buffer_store_dwordx4 v[40:43], v242, s[8:11], s63 offen offset:1024 sc1
    s_add_u32 s59, s75, 3
    v_mfma_f32_16x16x32_bf16 v[188:191], v[60:63], a[124:127], v[188:191]
    s_waitcnt lgkmcnt(4)
    s_and_b32 s59, s59, 3
    s_lshl_b32 s59, s59, 2
    s_add_u32 s59, s59, s75
    s_lshl_b32 s59, s59, 13
    v_mfma_f32_16x16x32_bf16 v[152:155], v[208:211], a[152:155], v[152:155]
    ds_read_b64_tr_b16 v[52:53], v110 offset:16384
    ds_read_b64_tr_b16 v[54:55], v110 offset:20480
    s_add_u32 s63, s56, s59
    v_cvt_pk_bf16_f32 v48, v144, v145
    v_cvt_pk_bf16_f32 v49, v146, v147
    v_mfma_f32_16x16x32_bf16 v[184:187], v[208:211], a[156:159], v[184:187]
    v_cvt_pk_bf16_f32 v50, v148, v149
    v_cvt_pk_bf16_f32 v51, v150, v151
    v_mfma_f32_16x16x32_bf16 v[156:159], v[212:215], a[152:155], v[156:159]
    ds_read_b64_tr_b16 v[60:61], v111 offset:16384
    ds_read_b64_tr_b16 v[62:63], v111 offset:20480
    buffer_store_dwordx4 v[48:51], v242, s[8:11], s63 offen offset:0 sc1
    v_cvt_pk_bf16_f32 v56, v176, v177
    v_mfma_f32_16x16x32_bf16 v[188:191], v[212:215], a[156:159], v[188:191]
    s_waitcnt lgkmcnt(4)
    v_cvt_pk_bf16_f32 v57, v178, v179
    v_cvt_pk_bf16_f32 v58, v180, v181
    v_cvt_pk_bf16_f32 v59, v182, v183
    v_mfma_f32_16x16x32_bf16 v[152:155], v[0:3], a[160:163], v[152:155]
    ds_read_b64_tr_b16 v[208:209], v110 offset:24576
    ds_read_b64_tr_b16 v[210:211], v110 offset:28672
    buffer_store_dwordx4 v[56:59], v242, s[8:11], s63 offen offset:1024 sc1
    v_mfma_f32_16x16x32_bf16 v[184:187], v[0:3], a[164:167], v[184:187]
    v_mfma_f32_16x16x32_bf16 v[156:159], v[8:11], a[160:163], v[156:159]
    ds_read_b64_tr_b16 v[212:213], v111 offset:24576
    ds_read_b64_tr_b16 v[214:215], v111 offset:28672
    v_mfma_f32_16x16x32_bf16 v[188:191], v[8:11], a[164:167], v[188:191]
    s_waitcnt lgkmcnt(4)
    v_mfma_f32_16x16x32_bf16 v[152:155], v[52:55], a[168:171], v[152:155]
    ds_read_b64_tr_b16 v[0:1], v94 offset:0
    ds_read_b64_tr_b16 v[2:3], v94 offset:4096
    v_mfma_f32_16x16x32_bf16 v[184:187], v[52:55], a[172:175], v[184:187]
    v_mfma_f32_16x16x32_bf16 v[156:159], v[60:63], a[168:171], v[156:159]
    ds_read_b64_tr_b16 v[8:9], v95 offset:0
    ds_read_b64_tr_b16 v[10:11], v95 offset:4096
    v_mfma_f32_16x16x32_bf16 v[188:191], v[60:63], a[172:175], v[188:191]
    s_waitcnt lgkmcnt(4)
    v_mfma_f32_16x16x32_bf16 v[152:155], v[208:211], a[176:179], v[152:155]
    ds_read_b64_tr_b16 v[52:53], v94 offset:8192
    ds_read_b64_tr_b16 v[54:55], v94 offset:12288
    v_mfma_f32_16x16x32_bf16 v[184:187], v[208:211], a[180:183], v[184:187]
    v_mfma_f32_16x16x32_bf16 v[156:159], v[212:215], a[176:179], v[156:159]
    ds_read_b64_tr_b16 v[60:61], v95 offset:8192
    ds_read_b64_tr_b16 v[62:63], v95 offset:12288
    v_mfma_f32_16x16x32_bf16 v[188:191], v[212:215], a[180:183], v[188:191]
    s_waitcnt lgkmcnt(4)
    v_mfma_f32_16x16x32_bf16 v[152:155], v[0:3], a[184:187], v[152:155]
    ds_read_b64_tr_b16 v[208:209], v94 offset:16384
    ds_read_b64_tr_b16 v[210:211], v94 offset:20480
    v_mfma_f32_16x16x32_bf16 v[184:187], v[0:3], a[188:191], v[184:187]
    v_mfma_f32_16x16x32_bf16 v[156:159], v[8:11], a[184:187], v[156:159]
    ds_read_b64_tr_b16 v[212:213], v95 offset:16384
    ds_read_b64_tr_b16 v[214:215], v95 offset:20480
    v_mfma_f32_16x16x32_bf16 v[188:191], v[8:11], a[188:191], v[188:191]
    s_waitcnt lgkmcnt(4)
    v_mfma_f32_16x16x32_bf16 v[152:155], v[52:55], a[192:195], v[152:155]
    s_waitcnt vmcnt(0)
    buffer_store_dword v248, v249, s[8:11], s71 offen sc1
    ds_read_b64_tr_b16 v[0:1], v94 offset:24576
    ds_read_b64_tr_b16 v[2:3], v94 offset:28672
    v_mfma_f32_16x16x32_bf16 v[184:187], v[52:55], a[196:199], v[184:187]
    v_mfma_f32_16x16x32_bf16 v[156:159], v[60:63], a[192:195], v[156:159]
    ds_read_b64_tr_b16 v[8:9], v95 offset:24576
    ds_read_b64_tr_b16 v[10:11], v95 offset:28672
    v_mfma_f32_16x16x32_bf16 v[188:191], v[60:63], a[196:199], v[188:191]
    s_waitcnt lgkmcnt(4)
    v_mfma_f32_16x16x32_bf16 v[152:155], v[208:211], a[200:203], v[152:155]
    ds_read_b64_tr_b16 v[52:53], v94 offset:32768
    ds_read_b64_tr_b16 v[54:55], v94 offset:36864
    v_mfma_f32_16x16x32_bf16 v[184:187], v[208:211], a[204:207], v[184:187]
    v_mfma_f32_16x16x32_bf16 v[156:159], v[212:215], a[200:203], v[156:159]
    ds_read_b64_tr_b16 v[60:61], v95 offset:32768
    ds_read_b64_tr_b16 v[62:63], v95 offset:36864
    v_mfma_f32_16x16x32_bf16 v[188:191], v[212:215], a[204:207], v[188:191]
    s_waitcnt lgkmcnt(4)
    v_mfma_f32_16x16x32_bf16 v[152:155], v[0:3], a[128:131], v[152:155]
    ds_read_b64_tr_b16 v[208:209], v94 offset:40960
    ds_read_b64_tr_b16 v[210:211], v94 offset:45056
    v_mfma_f32_16x16x32_bf16 v[184:187], v[0:3], a[132:135], v[184:187]
    v_mfma_f32_16x16x32_bf16 v[156:159], v[8:11], a[128:131], v[156:159]
    ds_read_b64_tr_b16 v[212:213], v95 offset:40960
    ds_read_b64_tr_b16 v[214:215], v95 offset:45056
    v_mfma_f32_16x16x32_bf16 v[188:191], v[8:11], a[132:135], v[188:191]
    s_waitcnt lgkmcnt(4)
    v_mfma_f32_16x16x32_bf16 v[152:155], v[52:55], a[136:139], v[152:155]
    ds_read_b64_tr_b16 v[0:1], v94 offset:49152
    ds_read_b64_tr_b16 v[2:3], v94 offset:53248
    v_mfma_f32_16x16x32_bf16 v[184:187], v[52:55], a[140:143], v[184:187]
    v_mfma_f32_16x16x32_bf16 v[156:159], v[60:63], a[136:139], v[156:159]
    ds_read_b64_tr_b16 v[8:9], v95 offset:49152
    ds_read_b64_tr_b16 v[10:11], v95 offset:53248
    v_mfma_f32_16x16x32_bf16 v[188:191], v[60:63], a[140:143], v[188:191]
    s_waitcnt lgkmcnt(4)
    v_mfma_f32_16x16x32_bf16 v[152:155], v[208:211], a[144:147], v[152:155]
    ds_read_b64_tr_b16 v[52:53], v94 offset:57344
    ds_read_b64_tr_b16 v[54:55], v94 offset:61440
    v_mfma_f32_16x16x32_bf16 v[184:187], v[208:211], a[148:151], v[184:187]
    v_mfma_f32_16x16x32_bf16 v[156:159], v[212:215], a[144:147], v[156:159]
    ds_read_b64_tr_b16 v[60:61], v95 offset:57344
    ds_read_b64_tr_b16 v[62:63], v95 offset:61440
    v_mfma_f32_16x16x32_bf16 v[188:191], v[212:215], a[148:151], v[188:191]
    s_waitcnt lgkmcnt(4)
    v_mfma_f32_16x16x32_bf16 v[152:155], v[0:3], a[208:211], v[152:155]
    ds_read_b64_tr_b16 v[208:209], v78 offset:32768
    ds_read_b64_tr_b16 v[210:211], v78 offset:36864
    v_mfma_f32_16x16x32_bf16 v[184:187], v[0:3], a[212:215], v[184:187]
    v_mfma_f32_16x16x32_bf16 v[156:159], v[8:11], a[208:211], v[156:159]
    ds_read_b64_tr_b16 v[212:213], v79 offset:32768
    ds_read_b64_tr_b16 v[214:215], v79 offset:36864
    v_mfma_f32_16x16x32_bf16 v[188:191], v[8:11], a[212:215], v[188:191]
    s_waitcnt lgkmcnt(4)
    v_mfma_f32_16x16x32_bf16 v[152:155], v[52:55], a[216:219], v[152:155]
    ds_read_b64_tr_b16 v[0:1], v78 offset:40960
    ds_read_b64_tr_b16 v[2:3], v78 offset:45056
    v_mfma_f32_16x16x32_bf16 v[184:187], v[52:55], a[220:223], v[184:187]
    v_mfma_f32_16x16x32_bf16 v[156:159], v[60:63], a[216:219], v[156:159]
    ds_read_b64_tr_b16 v[8:9], v79 offset:40960
    ds_read_b64_tr_b16 v[10:11], v79 offset:45056
    v_mfma_f32_16x16x32_bf16 v[188:191], v[60:63], a[220:223], v[188:191]
    s_waitcnt lgkmcnt(4)
    v_mfma_f32_16x16x32_bf16 v[152:155], v[208:211], a[224:227], v[152:155]
    buffer_load_dword v248, v247, s[8:11], s72 offen sc1
    ds_read_b64_tr_b16 v[52:53], v78 offset:49152
    ds_read_b64_tr_b16 v[54:55], v78 offset:53248
    v_mfma_f32_16x16x32_bf16 v[184:187], v[208:211], a[228:231], v[184:187]
    v_mfma_f32_16x16x32_bf16 v[156:159], v[212:215], a[224:227], v[156:159]
    ds_read_b64_tr_b16 v[60:61], v79 offset:49152
    ds_read_b64_tr_b16 v[62:63], v79 offset:53248
    v_mfma_f32_16x16x32_bf16 v[188:191], v[212:215], a[228:231], v[188:191]
    s_waitcnt lgkmcnt(4)
    v_mfma_f32_16x16x32_bf16 v[152:155], v[0:3], a[232:235], v[152:155]
    ds_read_b64_tr_b16 v[208:209], v78 offset:57344
    ds_read_b64_tr_b16 v[210:211], v78 offset:61440
    v_mfma_f32_16x16x32_bf16 v[184:187], v[0:3], a[236:239], v[184:187]
    v_mfma_f32_16x16x32_bf16 v[156:159], v[8:11], a[232:235], v[156:159]
    ds_read_b64_tr_b16 v[212:213], v79 offset:57344
    ds_read_b64_tr_b16 v[214:215], v79 offset:61440
    v_mfma_f32_16x16x32_bf16 v[188:191], v[8:11], a[236:239], v[188:191]
    s_waitcnt lgkmcnt(4)
    v_mfma_f32_16x16x32_bf16 v[152:155], v[52:55], a[240:243], v[152:155]
    v_mfma_f32_16x16x32_bf16 v[184:187], v[52:55], a[244:247], v[184:187]
    v_mfma_f32_16x16x32_bf16 v[156:159], v[60:63], a[240:243], v[156:159]
    v_mfma_f32_16x16x32_bf16 v[188:191], v[60:63], a[244:247], v[188:191]
    s_waitcnt lgkmcnt(0)
    v_mfma_f32_16x16x32_bf16 v[152:155], v[208:211], a[248:251], v[152:155]
    v_mfma_f32_16x16x32_bf16 v[184:187], v[208:211], a[252:255], v[184:187]
    v_mfma_f32_16x16x32_bf16 v[156:159], v[212:215], a[248:251], v[156:159]
    v_mfma_f32_16x16x32_bf16 v[188:191], v[212:215], a[252:255], v[188:191]
    s_waitcnt vmcnt(0)
    v_cmp_ne_u32 vcc, s64, v248
    s_cbranch_vccnz h4_spin
h4_ok:
    s_lshl_b32 s59, s75, 15
    s_add_u32 s56, s56, s59
    s_add_u32 s59, s75, 1
    s_and_b32 s59, s59, 3
    s_lshl_b32 s59, s59, 13
    s_add_u32 s63, s56, s59
    buffer_load_dwordx4 v[96:99], v242, s[8:11], s63 offen offset:0 sc1
    buffer_load_dwordx4 v[100:103], v242, s[8:11], s63 offen offset:1024 sc1
    s_add_u32 s59, s75, 2
    s_and_b32 s59, s59, 3
    s_lshl_b32 s59, s59, 13
    s_add_u32 s63, s56, s59
    buffer_load_dwordx4 v[104:107], v242, s[8:11], s63 offen offset:0 sc1
    buffer_load_dwordx4 v[108:111], v242, s[8:11], s63 offen offset:1024 sc1
    s_add_u32 s59, s75, 3
    s_and_b32 s59, s59, 3
    s_lshl_b32 s59, s59, 13
    s_add_u32 s63, s56, s59
    buffer_load_dwordx4 v[112:115], v242, s[8:11], s63 offen offset:0 sc1
    buffer_load_dwordx4 v[116:119], v242, s[8:11], s63 offen offset:1024 sc1
    v_lshlrev_b32 v16, 16, v64
    v_and_b32 v17, 0xffff0000, v64
    v_lshlrev_b32 v18, 16, v65
    v_and_b32 v19, 0xffff0000, v65
    v_lshlrev_b32 v20, 16, v66
    v_and_b32 v21, 0xffff0000, v66
    v_lshlrev_b32 v22, 16, v67
    v_and_b32 v23, 0xffff0000, v67
    v_lshlrev_b32 v24, 16, v72
    v_and_b32 v25, 0xffff0000, v72
    v_lshlrev_b32 v26, 16, v73
    v_and_b32 v27, 0xffff0000, v73
    v_lshlrev_b32 v28, 16, v74
    v_and_b32 v29, 0xffff0000, v74
    v_lshlrev_b32 v30, 16, v75
    v_and_b32 v31, 0xffff0000, v75
    v_fmac_f32 v16, v152, v192
    v_fmac_f32 v17, v153, v193
    v_fmac_f32 v18, v154, v194
    v_fmac_f32 v19, v155, v195
    v_fmac_f32 v20, v156, v196
    v_fmac_f32 v21, v157, v197
    v_fmac_f32 v22, v158, v198
    v_fmac_f32 v23, v159, v199
    v_fmac_f32 v24, v184, v200
    v_fmac_f32 v25, v185, v201
    v_fmac_f32 v26, v186, v202
    v_fmac_f32 v27, v187, v203
    v_fmac_f32 v28, v188, v204
    v_fmac_f32 v29, v189, v205
    v_fmac_f32 v30, v190, v206
    v_fmac_f32 v31, v191, v207
    s_waitcnt vmcnt(4)
    v_lshlrev_b32 v32, 16, v96
    v_and_b32 v33, 0xffff0000, v96
    v_fmac_f32 v16, v32, v192
    v_fmac_f32 v17, v33, v193
    v_lshlrev_b32 v34, 16, v97
    v_and_b32 v35, 0xffff0000, v97
    v_fmac_f32 v18, v34, v194
    v_fmac_f32 v19, v35, v195
    v_lshlrev_b32 v32, 16, v98
    v_and_b32 v33, 0xffff0000, v98
    v_fmac_f32 v20, v32, v196
    v_fmac_f32 v21, v33, v197
    v_lshlrev_b32 v34, 16, v99
    v_and_b32 v35, 0xffff0000, v99
    v_fmac_f32 v22, v34, v198
    v_fmac_f32 v23, v35, v199
    v_lshlrev_b32 v32, 16, v100
    v_and_b32 v33, 0xffff0000, v100
    v_fmac_f32 v24, v32, v200
    v_fmac_f32 v25, v33, v201
    v_lshlrev_b32 v34, 16, v101
    v_and_b32 v35, 0xffff0000, v101
    v_fmac_f32 v26, v34, v202
    v_fmac_f32 v27, v35, v203
    v_lshlrev_b32 v32, 16, v102
    v_and_b32 v33, 0xffff0000, v102
    v_fmac_f32 v28, v32, v204
    v_fmac_f32 v29, v33, v205
    v_lshlrev_b32 v34, 16, v103
    v_and_b32 v35, 0xffff0000, v103
    v_fmac_f32 v30, v34, v206
    v_fmac_f32 v31, v35, v207
    s_waitcnt vmcnt(2)
    v_lshlrev_b32 v32, 16, v104
    v_and_b32 v33, 0xffff0000, v104
    v_fmac_f32 v16, v32, v192
    v_fmac_f32 v17, v33, v193
    v_lshlrev_b32 v34, 16, v105
    v_and_b32 v35, 0xffff0000, v105
    v_fmac_f32 v18, v34, v194
    v_fmac_f32 v19, v35, v195
    v_lshlrev_b32 v32, 16, v106
    v_and_b32 v33, 0xffff0000, v106
    v_fmac_f32 v20, v32, v196
    v_fmac_f32 v21, v33, v197
    v_lshlrev_b32 v34, 16, v107
    v_and_b32 v35, 0xffff0000, v107
    v_fmac_f32 v22, v34, v198
    v_fmac_f32 v23, v35, v199
    v_lshlrev_b32 v32, 16, v108
    v_and_b32 v33, 0xffff0000, v108
    v_fmac_f32 v24, v32, v200
    v_fmac_f32 v25, v33, v201
    v_lshlrev_b32 v34, 16, v109
    v_and_b32 v35, 0xffff0000, v109
    v_fmac_f32 v26, v34, v202
    v_fmac_f32 v27, v35, v203
    v_lshlrev_b32 v32, 16, v110
    v_and_b32 v33, 0xffff0000, v110
    v_fmac_f32 v28, v32, v204
    v_fmac_f32 v29, v33, v205
    v_lshlrev_b32 v34, 16, v111
    v_and_b32 v35, 0xffff0000, v111
    v_fmac_f32 v30, v34, v206
    v_fmac_f32 v31, v35, v207
    s_waitcnt vmcnt(0)
    v_lshlrev_b32 v32, 16, v112
    v_and_b32 v33, 0xffff0000, v112
    v_fmac_f32 v16, v32, v192
    v_fmac_f32 v17, v33, v193
    v_cvt_pk_bf16_f32 v40, v16, v17
    v_lshlrev_b32 v34, 16, v113
    v_and_b32 v35, 0xffff0000, v113
    v_fmac_f32 v18, v34, v194
    v_fmac_f32 v19, v35, v195
    v_cvt_pk_bf16_f32 v41, v18, v19
    s_add_u32 s83, s79, 0
    buffer_store_dwordx2 v[40:41], v255, s[40:43], s83 offen offset:0
    v_lshlrev_b32 v32, 16, v114
    v_and_b32 v33, 0xffff0000, v114
    v_fmac_f32 v20, v32, v196
    v_fmac_f32 v21, v33, v197
    v_cvt_pk_bf16_f32 v42, v20, v21
    v_lshlrev_b32 v34, 16, v115
    v_and_b32 v35, 0xffff0000, v115
    v_fmac_f32 v22, v34, v198
    v_fmac_f32 v23, v35, v199
    v_cvt_pk_bf16_f32 v43, v22, v23
    buffer_store_dwordx2 v[42:43], v255, s[40:43], s83 offen offset:32
    v_lshlrev_b32 v32, 16, v116
    v_and_b32 v33, 0xffff0000, v116
    v_fmac_f32 v24, v32, v200
    v_fmac_f32 v25, v33, v201
    v_cvt_pk_bf16_f32 v44, v24, v25
    v_lshlrev_b32 v34, 16, v117
    v_and_b32 v35, 0xffff0000, v117
    v_fmac_f32 v26, v34, v202
    v_fmac_f32 v27, v35, v203
    v_cvt_pk_bf16_f32 v45, v26, v27
    s_add_u32 s83, s79, 16384
    buffer_store_dwordx2 v[44:45], v255, s[40:43], s83 offen offset:0
    v_lshlrev_b32 v32, 16, v118
    v_and_b32 v33, 0xffff0000, v118
    v_fmac_f32 v28, v32, v204
    v_fmac_f32 v29, v33, v205
    v_cvt_pk_bf16_f32 v46, v28, v29
    v_lshlrev_b32 v34, 16, v119
    v_and_b32 v35, 0xffff0000, v119
    v_fmac_f32 v30, v34, v206
    v_fmac_f32 v31, v35, v207
    v_cvt_pk_bf16_f32 v47, v30, v31
    buffer_store_dwordx2 v[46:47], v255, s[40:43], s83 offen offset:32
    s_waitcnt vmcnt(0)
k_end:
    s_endpgm
h1_spin:
    s_mov_b32 s80, 40000
h1_l:
    buffer_load_dword v61, v60, s[8:11], s66 offen sc1
    s_waitcnt vmcnt(0)
    v_cmp_ne_u32 vcc, s64, v61
    s_cbranch_vccz h1_ok
    s_sub_u32 s80, s80, 1
    s_cmp_lg_u32 s80, 0
    s_cbranch_scc1 h1_l
    s_branch h1_ok
h2_spin:
    s_mov_b32 s80, 40000
h2_l:
    s_sleep 1
    buffer_load_dword v213, v212, s[8:11], s68 offen sc1
    s_waitcnt vmcnt(0)
    v_cmp_ne_u32 vcc, s64, v213
    s_cbranch_vccz h2_ok
    s_sub_u32 s80, s80, 1
    s_cmp_lg_u32 s80, 0
    s_cbranch_scc1 h2_l
    s_branch h2_ok
h3_spin:
    s_mov_b32 s80, 40000
h3_l:
    buffer_load_dword v212, v247, s[8:11], s70 offen sc1
    s_waitcnt vmcnt(0)
    v_cmp_ne_u32 vcc, s64, v212
    s_cbranch_vccz h3_ok
    s_sub_u32 s80, s80, 1
    s_cmp_lg_u32 s80, 0
    s_cbranch_scc1 h3_l
    s_branch h3_ok
h4_spin:
    s_mov_b32 s80, 40000
h4_l:
    buffer_load_dword v248, v247, s[8:11], s72 offen sc1
    s_waitcnt vmcnt(0)
    v_cmp_ne_u32 vcc, s64, v248
    s_cbranch_vccz h4_ok
    s_sub_u32 s80, s80, 1
    s_cmp_lg_u32 s80, 0
    s_cbranch_scc1 h4_l
    s_branch h4_ok
restart:
    s_waitcnt vmcnt(0) lgkmcnt(0)
    s_nop 15
    s_barrier
    s_mov_b32 s1, 1
    s_branch pass_entry
maxpass:
    s_waitcnt vmcnt(0) lgkmcnt(0)
    s_nop 15
    s_barrier
    v_mov_b32 v243, 0
    v_mov_b32 v244, 0
    v_mov_b32 v245, 0
    v_mov_b32 v246, 0
    s_add_u32 m0, s57, 98304
    s_mov_b32 s56, 0
mp_loop:
    buffer_load_dwordx4 v236, s[20:23], s56 offen offset:0 lds
    buffer_load_dwordx4 v237, s[20:23], s56 offen offset:1024 lds
    buffer_load_dwordx4 v238, s[20:23], s56 offen offset:2048 lds
    buffer_load_dwordx4 v239, s[20:23], s56 offen offset:3072 lds
    s_waitcnt vmcnt(0)
    s_barrier
    ds_read_b128 a[64:67], v232 offset:0
    ds_read_b128 a[68:71], v233 offset:0
    ds_read_b128 a[72:75], v234 offset:0
    ds_read_b128 a[76:79], v235 offset:0
    ds_read_b128 a[80:83], v232 offset:4096
    ds_read_b128 a[84:87], v233 offset:4096
    ds_read_b128 a[88:91], v234 offset:4096
    ds_read_b128 a[92:95], v235 offset:4096
    s_waitcnt lgkmcnt(0)
    v_mfma_f32_16x16x32_bf16 v[160:163], a[64:67], a[0:3], v[192:195]
    v_mfma_f32_16x16x32_bf16 v[160:163], a[68:71], a[4:7], v[160:163]
    v_mfma_f32_16x16x32_bf16 v[160:163], a[72:75], a[8:11], v[160:163]
    v_mfma_f32_16x16x32_bf16 v[160:163], a[76:79], a[12:15], v[160:163]
    v_mfma_f32_16x16x32_bf16 v[164:167], a[80:83], a[0:3], v[192:195]
    v_mfma_f32_16x16x32_bf16 v[164:167], a[84:87], a[4:7], v[164:167]
    v_mfma_f32_16x16x32_bf16 v[164:167], a[88:91], a[8:11], v[164:167]
    v_mfma_f32_16x16x32_bf16 v[164:167], a[92:95], a[12:15], v[164:167]
    v_mfma_f32_16x16x32_bf16 v[168:171], a[64:67], a[16:19], v[196:199]
    v_mfma_f32_16x16x32_bf16 v[168:171], a[68:71], a[20:23], v[168:171]
    v_mfma_f32_16x16x32_bf16 v[168:171], a[72:75], a[24:27], v[168:171]
    v_mfma_f32_16x16x32_bf16 v[168:171], a[76:79], a[28:31], v[168:171]
    v_mfma_f32_16x16x32_bf16 v[172:175], a[80:83], a[16:19], v[196:199]
    v_mfma_f32_16x16x32_bf16 v[172:175], a[84:87], a[20:23], v[172:175]
    v_mfma_f32_16x16x32_bf16 v[172:175], a[88:91], a[24:27], v[172:175]
    v_mfma_f32_16x16x32_bf16 v[172:175], a[92:95], a[28:31], v[172:175]
    v_mfma_f32_16x16x32_bf16 v[176:179], a[64:67], a[32:35], v[200:203]
    v_mfma_f32_16x16x32_bf16 v[176:179], a[68:71], a[36:39], v[176:179]
    v_mfma_f32_16x16x32_bf16 v[176:179], a[72:75], a[40:43], v[176:179]
    v_mfma_f32_16x16x32_bf16 v[176:179], a[76:79], a[44:47], v[176:179]
    v_mfma_f32_16x16x32_bf16 v[180:183], a[80:83], a[32:35], v[200:203]
    v_mfma_f32_16x16x32_bf16 v[180:183], a[84:87], a[36:39], v[180:183]
    v_mfma_f32_16x16x32_bf16 v[180:183], a[88:91], a[40:43], v[180:183]
    v_mfma_f32_16x16x32_bf16 v[180:183], a[92:95], a[44:47], v[180:183]
    v_mfma_f32_16x16x32_bf16 v[184:187], a[64:67], a[48:51], v[204:207]
    v_mfma_f32_16x16x32_bf16 v[184:187], a[68:71], a[52:55], v[184:187]
    v_mfma_f32_16x16x32_bf16 v[184:187], a[72:75], a[56:59], v[184:187]
    v_mfma_f32_16x16x32_bf16 v[184:187], a[76:79], a[60:63], v[184:187]
    v_mfma_f32_16x16x32_bf16 v[188:191], a[80:83], a[48:51], v[204:207]
    v_mfma_f32_16x16x32_bf16 v[188:191], a[84:87], a[52:55], v[188:191]
    v_mfma_f32_16x16x32_bf16 v[188:191], a[88:91], a[56:59], v[188:191]
    v_mfma_f32_16x16x32_bf16 v[188:191], a[92:95], a[60:63], v[188:191]
    s_nop 7
    v_max3_f32 v243, v243, v160, v161
    v_max3_f32 v243, v243, v162, v163
    v_max3_f32 v243, v243, v164, v165
    v_max3_f32 v243, v243, v166, v167
    v_max3_f32 v244, v244, v168, v169
    v_max3_f32 v244, v244, v170, v171
    v_max3_f32 v244, v244, v172, v173
    v_max3_f32 v244, v244, v174, v175
    v_max3_f32 v245, v245, v176, v177
    v_max3_f32 v245, v245, v178, v179
    v_max3_f32 v245, v245, v180, v181
    v_max3_f32 v245, v245, v182, v183
    v_max3_f32 v246, v246, v184, v185
    v_max3_f32 v246, v246, v186, v187
    v_max3_f32 v246, v246, v188, v189
    v_max3_f32 v246, v246, v190, v191
    s_nop 3
    ds_read_b128 a[64:67], v232 offset:8192
    ds_read_b128 a[68:71], v233 offset:8192
    ds_read_b128 a[72:75], v234 offset:8192
    ds_read_b128 a[76:79], v235 offset:8192
    ds_read_b128 a[80:83], v232 offset:12288
    ds_read_b128 a[84:87], v233 offset:12288
    ds_read_b128 a[88:91], v234 offset:12288
    ds_read_b128 a[92:95], v235 offset:12288
    s_waitcnt lgkmcnt(0)
    v_mfma_f32_16x16x32_bf16 v[160:163], a[64:67], a[0:3], v[192:195]
    v_mfma_f32_16x16x32_bf16 v[160:163], a[68:71], a[4:7], v[160:163]
    v_mfma_f32_16x16x32_bf16 v[160:163], a[72:75], a[8:11], v[160:163]
    v_mfma_f32_16x16x32_bf16 v[160:163], a[76:79], a[12:15], v[160:163]
    v_mfma_f32_16x16x32_bf16 v[164:167], a[80:83], a[0:3], v[192:195]
    v_mfma_f32_16x16x32_bf16 v[164:167], a[84:87], a[4:7], v[164:167]
    v_mfma_f32_16x16x32_bf16 v[164:167], a[88:91], a[8:11], v[164:167]
    v_mfma_f32_16x16x32_bf16 v[164:167], a[92:95], a[12:15], v[164:167]
    v_mfma_f32_16x16x32_bf16 v[168:171], a[64:67], a[16:19], v[196:199]
    v_mfma_f32_16x16x32_bf16 v[168:171], a[68:71], a[20:23], v[168:171]
    v_mfma_f32_16x16x32_bf16 v[168:171], a[72:75], a[24:27], v[168:171]
    v_mfma_f32_16x16x32_bf16 v[168:171], a[76:79], a[28:31], v[168:171]
    v_mfma_f32_16x16x32_bf16 v[172:175], a[80:83], a[16:19], v[196:199]
    v_mfma_f32_16x16x32_bf16 v[172:175], a[84:87], a[20:23], v[172:175]
    v_mfma_f32_16x16x32_bf16 v[172:175], a[88:91], a[24:27], v[172:175]
    v_mfma_f32_16x16x32_bf16 v[172:175], a[92:95], a[28:31], v[172:175]
    v_mfma_f32_16x16x32_bf16 v[176:179], a[64:67], a[32:35], v[200:203]
    v_mfma_f32_16x16x32_bf16 v[176:179], a[68:71], a[36:39], v[176:179]
    v_mfma_f32_16x16x32_bf16 v[176:179], a[72:75], a[40:43], v[176:179]
    v_mfma_f32_16x16x32_bf16 v[176:179], a[76:79], a[44:47], v[176:179]
    v_mfma_f32_16x16x32_bf16 v[180:183], a[80:83], a[32:35], v[200:203]
    v_mfma_f32_16x16x32_bf16 v[180:183], a[84:87], a[36:39], v[180:183]
    v_mfma_f32_16x16x32_bf16 v[180:183], a[88:91], a[40:43], v[180:183]
    v_mfma_f32_16x16x32_bf16 v[180:183], a[92:95], a[44:47], v[180:183]
    v_mfma_f32_16x16x32_bf16 v[184:187], a[64:67], a[48:51], v[204:207]
    v_mfma_f32_16x16x32_bf16 v[184:187], a[68:71], a[52:55], v[184:187]
    v_mfma_f32_16x16x32_bf16 v[184:187], a[72:75], a[56:59], v[184:187]
    v_mfma_f32_16x16x32_bf16 v[184:187], a[76:79], a[60:63], v[184:187]
    v_mfma_f32_16x16x32_bf16 v[188:191], a[80:83], a[48:51], v[204:207]
    v_mfma_f32_16x16x32_bf16 v[188:191], a[84:87], a[52:55], v[188:191]
    v_mfma_f32_16x16x32_bf16 v[188:191], a[88:91], a[56:59], v[188:191]
    v_mfma_f32_16x16x32_bf16 v[188:191], a[92:95], a[60:63], v[188:191]
    s_nop 7
    v_max3_f32 v243, v243, v160, v161
    v_max3_f32 v243, v243, v162, v163
    v_max3_f32 v243, v243, v164, v165
    v_max3_f32 v243, v243, v166, v167
    v_max3_f32 v244, v244, v168, v169
    v_max3_f32 v244, v244, v170, v171
    v_max3_f32 v244, v244, v172, v173
    v_max3_f32 v244, v244, v174, v175
    v_max3_f32 v245, v245, v176, v177
    v_max3_f32 v245, v245, v178, v179
    v_max3_f32 v245, v245, v180, v181
    v_max3_f32 v245, v245, v182, v183
    v_max3_f32 v246, v246, v184, v185
    v_max3_f32 v246, v246, v186, v187
    v_max3_f32 v246, v246, v188, v189
    v_max3_f32 v246, v246, v190, v191
    s_nop 3
    s_barrier
    s_add_u32 s56, s56, 16384
    s_cmp_lt_u32 s56, 131072
    s_cbranch_scc1 mp_loop
    v_mov_b32 v249, v243
    s_nop 1
    v_permlane16_swap_b32 v243, v249
    v_max_f32 v243, v243, v249
    v_mov_b32 v249, v243
    s_nop 1
    v_permlane32_swap_b32 v243, v249
    v_max_f32 v243, v243, v249
    v_sub_f32 v243, v243, v192
    v_mov_b32 v249, v244
    s_nop 1
    v_permlane16_swap_b32 v244, v249
    v_max_f32 v244, v244, v249
    v_mov_b32 v249, v244
    s_nop 1
    v_permlane32_swap_b32 v244, v249
    v_max_f32 v244, v244, v249
    v_sub_f32 v244, v244, v196
    v_mov_b32 v249, v245
    s_nop 1
    v_permlane16_swap_b32 v245, v249
    v_max_f32 v245, v245, v249
    v_mov_b32 v249, v245
    s_nop 1
    v_permlane32_swap_b32 v245, v249
    v_max_f32 v245, v245, v249
    v_sub_f32 v245, v245, v200
    v_mov_b32 v249, v246
    s_nop 1
    v_permlane16_swap_b32 v246, v249
    v_max_f32 v246, v246, v249
    v_mov_b32 v249, v246
    s_nop 1
    v_permlane32_swap_b32 v246, v249
    v_max_f32 v246, v246, v249
    v_sub_f32 v246, v246, v204
    s_mov_b32 s1, 0
    s_mov_b64 s[60:61], -1
    s_branch pass_entry
code_end:
.section .rodata,"a"
.p2align 6
.amdhsa_kernel recurrent_scan__sliding_block_cached__dense_activation_squared_relu__prompt_kernel
  .amdhsa_next_free_vgpr 512
  .amdhsa_next_free_sgpr 102
  .amdhsa_accum_offset 256
  .amdhsa_group_segment_fixed_size 0
  .amdhsa_kernarg_size 104
  .amdhsa_user_sgpr_count 2
  .amdhsa_user_sgpr_kernarg_segment_ptr 1
  .amdhsa_system_sgpr_workgroup_id_x 1
.end_amdhsa_kernel
```
